```python
import torch

def _softmax(x, axis=-1):
    return torch.softmax(x, dim=axis)
def _gelu(x):
    return torch.nn.functional.gelu(x, approximate="tanh")
def _silu(x):
    return torch.nn.functional.silu(x)
def _sigmoid(x):
    return torch.sigmoid(x)
def _layernorm(x, axis=-1, eps=1e-5):
    m = x.mean(dim=axis, keepdim=True)
    v = x.var(dim=axis, keepdim=True, unbiased=False)
    return (x - m) / torch.sqrt(v + eps)
def _scatter_add(tgt, idx, src, axis=0):
    return tgt.clone().index_add_(axis, idx, src)
def _segment_sum(src, seg, n):
    out = torch.zeros((n,) + src.shape[1:], dtype=src.dtype)
    return out.index_add_(0, seg, src)
def _pad(x, pw):
    flat = tuple(v for pair in reversed(pw) for v in pair)
    return torch.nn.functional.pad(x, flat)

kernel_name = 'sequential_preLN__linear_attn_block__glu_gated_geglu__prompt'

def setup_inputs():

    _w = (lambda a: (lambda t: t.to(torch.bfloat16) if t.is_floating_point() else t)(torch.as_tensor(a)))
    def _A_setup():
        B, S, D = 1, 2048, 1024
        return {
            "x": _w((lambda *s: torch.randn(*s, dtype=torch.bfloat16) * 0.05)(B, S, D)),
            "wqkv": _w((lambda *s: torch.randn(*s, dtype=torch.bfloat16) * 0.05)(D, 3 * D)),
            "wo": _w((lambda *s: torch.randn(*s, dtype=torch.bfloat16) * 0.05)(D, D)),
        }
    _A_in = _A_setup()

    def _B_setup():
        B, S, Dm, Df = 1, 2048, 1024, 3584
        return {
            "x": _w((lambda *s: torch.randn(*s, dtype=torch.bfloat16) * 0.05)(B, S, Dm)),
            "w_gate": _w((lambda *s: torch.randn(*s, dtype=torch.bfloat16) * 0.4)(Dm, Df) * (Dm ** -0.5)),
            "w_up": _w((lambda *s: torch.randn(*s, dtype=torch.bfloat16) * 0.4)(Dm, Df) * (Dm ** -0.5)),
            "w_down": _w((lambda *s: torch.randn(*s, dtype=torch.bfloat16) * 0.4)(Df, Dm) * (Df ** -0.5)),
        }
    _B_in = _B_setup()

    return {
        "A_x": _A_in["x"],
        "A_wqkv": _A_in["wqkv"],
        "A_wo": _A_in["wo"],
        "B_x": _B_in["x"],
        "B_w_gate": _B_in["w_gate"],
        "B_w_up": _B_in["w_up"],
        "B_w_down": _B_in["w_down"],
    }

def reference(A_x, A_wqkv, A_wo, B_x, B_w_gate, B_w_up, B_w_down):
    def _A_ref(x, wqkv, wo):
        B, S, D = x.shape
        H = 32; Dh = D // H
        qkv = (lambda x, *d: x.permute(*d))((x @ wqkv).reshape(B, S, 3, H, Dh), 2, 0, 3, 1, 4)
        q, k, v = qkv[0], qkv[1], qkv[2]
        phi = lambda t: torch.where(t > 0, t + 1, torch.exp(t)) + 1e-6
        pq, pk = phi(q), phi(k)
        kv = torch.einsum("bhsd,bhse->bhde", pk, v)
        z = torch.einsum("bhsd->bhd", pk)
        num = torch.einsum("bhqd,bhde->bhqe", pq, kv)
        den = torch.einsum("bhqd,bhd->bhq", pq, z)[..., None] + 1e-6
        o = num / den
        return (lambda x, *d: x.permute(*d))(o, 0, 2, 1, 3).reshape(B, S, D) @ wo

    def _B_ref(x, w_gate, w_up, w_down):
        g = torch.einsum("bsd,df->bsf", x, w_gate)
        u = torch.einsum("bsd,df->bsf", x, w_up)
        h = _gelu(g) * u
        return torch.einsum("bsf,fd->bsd", h, w_down)

    x = A_x
    h = x + _A_ref(_layernorm(x, axis=-1), A_wqkv, A_wo)
    h2 = h + _B_ref(_layernorm(h, axis=-1), B_w_gate, B_w_up, B_w_down)
    return h2
```

```asm
; @launch kernel=ln1_kernel grid=(512,1,1) block=(256,1,1) lds=0
; @launch kernel=gemm1_kernel grid=(256,1,1) block=(576,1,1) lds=163840
; @launch kernel=gemm2_kernel grid=(256,1,1) block=(512,1,1) lds=163840
; @launch kernel=gemm3_kernel grid=(256,1,1) block=(512,1,1) lds=163840
; @launch kernel=gemm4_kernel grid=(256,1,1) block=(512,1,1) lds=147456
.amdgcn_target "amdgcn-amd-amdhsa--gfx950"
.text
.globl ln1_kernel
.p2align 8
.type ln1_kernel,@function
ln1_kernel:
    s_cmp_ge_u32 s2, 512
    s_cbranch_scc1 L_end_1
    s_load_dwordx2 s[4:5], s[0:1], 72
    s_load_dwordx2 s[6:7], s[0:1], 0
    v_lshrrev_b32 v1, 6, v0
    v_and_b32 v2, 63, v0
    s_lshl_b32 s3, s2, 2
    v_add_u32 v1, s3, v1
    v_lshlrev_b32 v1, 11, v1
    v_lshl_add_u32 v1, v2, 4, v1
    s_waitcnt lgkmcnt(0)
    s_mov_b32 s8, s6
    s_mov_b32 s9, s7
    s_mov_b32 s10, 0x400000
    s_mov_b32 s11, 0x00020000
    s_mov_b32 s12, s4
    s_mov_b32 s13, s5
    s_mov_b32 s14, 0x400000
    s_mov_b32 s15, 0x00020000
    buffer_load_dwordx4 v[4:7], v1, s[8:11], 0 offen
    buffer_load_dwordx4 v[8:11], v1, s[8:11], 0 offen offset:1024
    s_load_dwordx4 s[40:43], s[0:1], 8
    v_lshlrev_b32 v3, 6, v0
    s_lshl_b32 s3, s2, 14
    v_add_u32 v3, s3, v3
    s_waitcnt lgkmcnt(0)
    s_mov_b32 s52, s40
    s_mov_b32 s53, s41
    s_mov_b32 s54, 0x600000
    s_mov_b32 s55, 0x00020000
    s_mov_b32 s56, s42
    s_mov_b32 s57, s43
    s_mov_b32 s58, 0x200000
    s_mov_b32 s59, 0x00020000
    buffer_load_dword v40, v3, s[52:55], 0 offen
    v_subrev_u32 v3, 0x600000, v3
    buffer_load_dword v41, v3, s[56:59], 0 offen
    s_cmp_ge_u32 s2, 55
    s_cbranch_scc1 L_nz_3
    s_add_u32 s16, s4, 0x800000
    s_addc_u32 s17, s5, 0
    s_mov_b32 s18, 0x37000
    s_mov_b32 s19, 0x00020000
    s_lshl_b32 s3, s2, 12
    v_lshlrev_b32 v3, 4, v0
    v_add_u32 v3, s3, v3
    v_mov_b32 v12, 0
    v_mov_b32 v13, 0
    v_mov_b32 v14, 0
    v_mov_b32 v15, 0
    buffer_store_dwordx4 v[12:15], v3, s[16:19], 0 offen
L_nz_3:
    s_waitcnt vmcnt(2)
    v_lshlrev_b32 v16, 16, v4
    v_and_b32 v17, 0xffff0000, v4
    v_lshlrev_b32 v18, 16, v5
    v_and_b32 v19, 0xffff0000, v5
    v_lshlrev_b32 v20, 16, v6
    v_and_b32 v21, 0xffff0000, v6
    v_lshlrev_b32 v22, 16, v7
    v_and_b32 v23, 0xffff0000, v7
    v_lshlrev_b32 v24, 16, v8
    v_and_b32 v25, 0xffff0000, v8
    v_lshlrev_b32 v26, 16, v9
    v_and_b32 v27, 0xffff0000, v9
    v_lshlrev_b32 v28, 16, v10
    v_and_b32 v29, 0xffff0000, v10
    v_lshlrev_b32 v30, 16, v11
    v_and_b32 v31, 0xffff0000, v11
    v_add_f32 v32, v16, v17
    v_add_f32 v32, v32, v18
    v_add_f32 v32, v32, v19
    v_add_f32 v32, v32, v20
    v_add_f32 v32, v32, v21
    v_add_f32 v32, v32, v22
    v_add_f32 v32, v32, v23
    v_add_f32 v32, v32, v24
    v_add_f32 v32, v32, v25
    v_add_f32 v32, v32, v26
    v_add_f32 v32, v32, v27
    v_add_f32 v32, v32, v28
    v_add_f32 v32, v32, v29
    v_add_f32 v32, v32, v30
    v_add_f32 v32, v32, v31
    s_nop 1
    v_add_f32_dpp v33, v32, v32 quad_perm:[1,0,3,2] row_mask:0xf bank_mask:0xf
    s_nop 1
    v_add_f32_dpp v32, v33, v33 quad_perm:[2,3,0,1] row_mask:0xf bank_mask:0xf
    s_nop 1
    v_add_f32_dpp v33, v32, v32 row_half_mirror row_mask:0xf bank_mask:0xf
    s_nop 1
    v_add_f32_dpp v32, v33, v33 row_mirror row_mask:0xf bank_mask:0xf
    s_nop 1
    v_readlane_b32 s20, v32, 0
    v_readlane_b32 s21, v32, 16
    v_readlane_b32 s22, v32, 32
    v_readlane_b32 s23, v32, 48
    s_nop 1
    v_mov_b32 v32, s20
    v_add_f32 v32, s21, v32
    v_add_f32 v32, s22, v32
    v_add_f32 v32, s23, v32
    v_mul_f32 v32, 0x3a800000, v32
    v_sub_f32 v34, v16, v32
    v_mul_f32 v35, v34, v34
    v_sub_f32 v34, v17, v32
    v_fmac_f32 v35, v34, v34
    v_sub_f32 v34, v18, v32
    v_fmac_f32 v35, v34, v34
    v_sub_f32 v34, v19, v32
    v_fmac_f32 v35, v34, v34
    v_sub_f32 v34, v20, v32
    v_fmac_f32 v35, v34, v34
    v_sub_f32 v34, v21, v32
    v_fmac_f32 v35, v34, v34
    v_sub_f32 v34, v22, v32
    v_fmac_f32 v35, v34, v34
    v_sub_f32 v34, v23, v32
    v_fmac_f32 v35, v34, v34
    v_sub_f32 v34, v24, v32
    v_fmac_f32 v35, v34, v34
    v_sub_f32 v34, v25, v32
    v_fmac_f32 v35, v34, v34
    v_sub_f32 v34, v26, v32
    v_fmac_f32 v35, v34, v34
    v_sub_f32 v34, v27, v32
    v_fmac_f32 v35, v34, v34
    v_sub_f32 v34, v28, v32
    v_fmac_f32 v35, v34, v34
    v_sub_f32 v34, v29, v32
    v_fmac_f32 v35, v34, v34
    v_sub_f32 v34, v30, v32
    v_fmac_f32 v35, v34, v34
    v_sub_f32 v34, v31, v32
    v_fmac_f32 v35, v34, v34
    s_nop 1
    v_add_f32_dpp v33, v35, v35 quad_perm:[1,0,3,2] row_mask:0xf bank_mask:0xf
    s_nop 1
    v_add_f32_dpp v35, v33, v33 quad_perm:[2,3,0,1] row_mask:0xf bank_mask:0xf
    s_nop 1
    v_add_f32_dpp v33, v35, v35 row_half_mirror row_mask:0xf bank_mask:0xf
    s_nop 1
    v_add_f32_dpp v35, v33, v33 row_mirror row_mask:0xf bank_mask:0xf
    s_nop 1
    v_readlane_b32 s20, v35, 0
    v_readlane_b32 s21, v35, 16
    v_readlane_b32 s22, v35, 32
    v_readlane_b32 s23, v35, 48
    s_nop 1
    v_mov_b32 v35, s20
    v_add_f32 v35, s21, v35
    v_add_f32 v35, s22, v35
    v_add_f32 v35, s23, v35
    v_mul_f32 v35, 0x3a800000, v35
    v_cvt_pk_bf16_f32 v36, v32, v35
    v_lshlrev_b32 v32, 16, v36
    v_and_b32 v35, 0xffff0000, v36
    v_add_f32 v35, 0x3727c5ac, v35
    v_cvt_pk_bf16_f32 v36, v35, v35
    v_lshlrev_b32 v35, 16, v36
    v_sqrt_f32 v35, v35
    s_nop 0
    v_cvt_pk_bf16_f32 v36, v35, v35
    v_lshlrev_b32 v35, 16, v36
    v_rcp_f32 v35, v35
    v_sub_f32 v16, v16, v32
    v_sub_f32 v17, v17, v32
    v_sub_f32 v18, v18, v32
    v_sub_f32 v19, v19, v32
    v_sub_f32 v20, v20, v32
    v_sub_f32 v21, v21, v32
    v_sub_f32 v22, v22, v32
    v_sub_f32 v23, v23, v32
    v_sub_f32 v24, v24, v32
    v_sub_f32 v25, v25, v32
    v_sub_f32 v26, v26, v32
    v_sub_f32 v27, v27, v32
    v_sub_f32 v28, v28, v32
    v_sub_f32 v29, v29, v32
    v_sub_f32 v30, v30, v32
    v_sub_f32 v31, v31, v32
    v_cvt_pk_bf16_f32 v4, v16, v17
    v_cvt_pk_bf16_f32 v5, v18, v19
    v_cvt_pk_bf16_f32 v6, v20, v21
    v_cvt_pk_bf16_f32 v7, v22, v23
    v_cvt_pk_bf16_f32 v8, v24, v25
    v_cvt_pk_bf16_f32 v9, v26, v27
    v_cvt_pk_bf16_f32 v10, v28, v29
    v_cvt_pk_bf16_f32 v11, v30, v31
    v_lshlrev_b32 v16, 16, v4
    v_and_b32 v17, 0xffff0000, v4
    v_lshlrev_b32 v18, 16, v5
    v_and_b32 v19, 0xffff0000, v5
    v_lshlrev_b32 v20, 16, v6
    v_and_b32 v21, 0xffff0000, v6
    v_lshlrev_b32 v22, 16, v7
    v_and_b32 v23, 0xffff0000, v7
    v_lshlrev_b32 v24, 16, v8
    v_and_b32 v25, 0xffff0000, v8
    v_lshlrev_b32 v26, 16, v9
    v_and_b32 v27, 0xffff0000, v9
    v_lshlrev_b32 v28, 16, v10
    v_and_b32 v29, 0xffff0000, v10
    v_lshlrev_b32 v30, 16, v11
    v_and_b32 v31, 0xffff0000, v11
    v_mul_f32 v16, v16, v35
    v_mul_f32 v17, v17, v35
    v_mul_f32 v18, v18, v35
    v_mul_f32 v19, v19, v35
    v_mul_f32 v20, v20, v35
    v_mul_f32 v21, v21, v35
    v_mul_f32 v22, v22, v35
    v_mul_f32 v23, v23, v35
    v_mul_f32 v24, v24, v35
    v_mul_f32 v25, v25, v35
    v_mul_f32 v26, v26, v35
    v_mul_f32 v27, v27, v35
    v_mul_f32 v28, v28, v35
    v_mul_f32 v29, v29, v35
    v_mul_f32 v30, v30, v35
    v_mul_f32 v31, v31, v35
    v_cvt_pk_bf16_f32 v4, v16, v17
    v_cvt_pk_bf16_f32 v5, v18, v19
    v_cvt_pk_bf16_f32 v6, v20, v21
    v_cvt_pk_bf16_f32 v7, v22, v23
    v_cvt_pk_bf16_f32 v8, v24, v25
    v_cvt_pk_bf16_f32 v9, v26, v27
    v_cvt_pk_bf16_f32 v10, v28, v29
    v_cvt_pk_bf16_f32 v11, v30, v31
    buffer_store_dwordx4 v[4:7], v1, s[12:15], 0 offen
    buffer_store_dwordx4 v[8:11], v1, s[12:15], 0 offen offset:1024
L_end_1:
    s_endpgm
.globl gemm1_kernel
.p2align 8
.type gemm1_kernel,@function
gemm1_kernel:
    s_cmp_ge_u32 s2, 256
    s_cbranch_scc1 L_end_4
    s_load_dwordx2 s[4:5], s[0:1], 72
    s_load_dwordx2 s[6:7], s[0:1], 8
    s_load_dwordx2 s[82:83], s[0:1], 32
    s_load_dwordx2 s[84:85], s[0:1], 40
    v_lshrrev_b32 v1, 6, v0
    v_and_b32 v0, 63, v0
    s_nop 0
    v_readfirstlane_b32 s28, v1
    v_and_b32 v1, 15, v0
    v_lshrrev_b32 v2, 4, v0
    s_and_b32 s42, s2, 7
    s_lshr_b32 s43, s2, 3
    s_and_b32 s29, s42, 1
    s_lshl_b32 s29, s29, 3
    s_and_b32 s44, s43, 7
    s_add_u32 s29, s29, s44
    s_lshr_b32 s30, s42, 1
    s_lshl_b32 s30, s30, 2
    s_lshr_b32 s44, s43, 3
    s_add_u32 s30, s30, s44
    s_and_b32 s38, s28, 1
    s_bfe_u32 s39, s28, 0x10001
    s_lshr_b32 s40, s28, 2
    s_cmp_ge_u32 s28, 8
    s_cbranch_scc1 L_helper_5
    v_lshrrev_b32 v16, 3, v0
    v_and_b32 v17, 7, v0
    v_xor_b32 v17, v17, v16
    s_mov_b32 s42, 0
    s_mul_i32 s43, s38, 16
    s_add_u32 s42, s42, s43
    s_mul_i32 s43, s39, 32
    s_add_u32 s42, s42, s43
    s_mul_i32 s43, s40, 64
    s_add_u32 s42, s42, s43
    s_mul_i32 s43, s29, 128
    s_add_u32 s42, s42, s43
    v_add_u32 v16, s42, v16
    s_mov_b32 s43, 2048
    v_mul_lo_u32 v16, v16, s43
    v_lshl_add_u32 v3, v17, 4, v16
    v_add_u32 v4, 0x4000, v3
    s_mov_b32 s36, 0
    s_mul_i32 s42, s38, 2048
    s_add_u32 s36, s36, s42
    s_mul_i32 s42, s39, 4096
    s_add_u32 s36, s36, s42
    s_mul_i32 s42, s40, 8192
    s_add_u32 s36, s36, s42
    s_mul_i32 s44, s30, 128
    s_mov_b32 s45, 6144
    v_lshrrev_b32 v16, 3, v0
    v_bfe_u32 v18, v0, 4, 1
    v_lshlrev_b32 v18, 1, v18
    v_and_b32 v17, 7, v0
    v_xor_b32 v17, v17, v18
    v_mul_lo_u32 v16, v16, s45
    s_mov_b32 s42, 0
    s_mul_i32 s43, s38, 49152
    s_add_u32 s42, s42, s43
    s_mul_i32 s43, s39, 98304
    s_add_u32 s42, s42, s43
    s_mul_i32 s43, s40, 196608
    s_add_u32 s42, s42, s43
    s_add_u32 s42, s42, s44
    v_add_u32 v16, s42, v16
    s_lshl_b32 s43, s38, 2
    s_xor_b32 s43, s43, 0
    v_xor_b32 v18, s43, v17
    v_lshl_add_u32 v18, v18, 4, v16
    v_add_u32 v5, 0x0, v18
    s_lshl_b32 s43, s38, 2
    s_xor_b32 s43, s43, 0
    v_xor_b32 v18, s43, v17
    v_lshl_add_u32 v18, v18, 4, v16
    v_add_u32 v6, 0x800, v18
    s_lshl_b32 s43, s38, 2
    s_xor_b32 s43, s43, 0
    v_xor_b32 v18, s43, v17
    v_lshl_add_u32 v18, v18, 4, v16
    v_add_u32 v7, 0x1000, v18
    s_mov_b32 s37, 65536
    s_mul_i32 s42, s38, 3072
    s_add_u32 s37, s37, s42
    s_mul_i32 s42, s39, 6144
    s_add_u32 s37, s37, s42
    s_mul_i32 s42, s40, 12288
    s_add_u32 s37, s37, s42
    s_waitcnt lgkmcnt(0)
    s_mov_b32 s8, s4
    s_mov_b32 s9, s5
    s_mov_b32 s10, 0x400000
    s_mov_b32 s11, 0x00020000
    s_mov_b32 s12, s6
    s_mov_b32 s13, s7
    s_mov_b32 s14, 0x600000
    s_mov_b32 s15, 0x00020000
    s_mov_b32 s32, 0
    s_mov_b32 s33, 0
    s_mov_b32 s35, 0
    s_mov_b32 s96, 0
    s_add_u32 s42, s35, s36
    s_add_u32 m0, s42, 0
    s_nop 0
    buffer_load_dwordx4 v3, s[8:11], s32 offen lds
    s_add_u32 s42, s35, s36
    s_add_u32 m0, s42, 1024
    s_nop 0
    buffer_load_dwordx4 v4, s[8:11], s32 offen lds
    s_add_u32 s32, s32, 128
    s_add_u32 s35, s35, 16384
    s_add_u32 s42, s96, s37
    s_add_u32 m0, s42, 0
    s_nop 0
    buffer_load_dwordx4 v5, s[12:15], s33 offen lds
    s_add_u32 s42, s96, s37
    s_add_u32 m0, s42, 1024
    s_nop 0
    buffer_load_dwordx4 v6, s[12:15], s33 offen lds
    s_add_u32 s42, s96, s37
    s_add_u32 m0, s42, 2048
    s_nop 0
    buffer_load_dwordx4 v7, s[12:15], s33 offen lds
    s_add_u32 s33, s33, 393216
    s_add_u32 s96, s96, 24576
    s_add_u32 s42, s35, s36
    s_add_u32 m0, s42, 0
    s_nop 0
    buffer_load_dwordx4 v3, s[8:11], s32 offen lds
    s_add_u32 s42, s35, s36
    s_add_u32 m0, s42, 1024
    s_nop 0
    buffer_load_dwordx4 v4, s[8:11], s32 offen lds
    s_add_u32 s32, s32, 128
    s_add_u32 s35, s35, 16384
    s_add_u32 s42, s96, s37
    s_add_u32 m0, s42, 0
    s_nop 0
    buffer_load_dwordx4 v5, s[12:15], s33 offen lds
    s_add_u32 s42, s96, s37
    s_add_u32 m0, s42, 1024
    s_nop 0
    buffer_load_dwordx4 v6, s[12:15], s33 offen lds
    s_add_u32 s42, s96, s37
    s_add_u32 m0, s42, 2048
    s_nop 0
    buffer_load_dwordx4 v7, s[12:15], s33 offen lds
    s_add_u32 s33, s33, 393216
    s_add_u32 s96, s96, 24576
    s_add_u32 s42, s35, s36
    s_add_u32 m0, s42, 0
    s_nop 0
    buffer_load_dwordx4 v3, s[8:11], s32 offen lds
    s_add_u32 s42, s35, s36
    s_add_u32 m0, s42, 1024
    s_nop 0
    buffer_load_dwordx4 v4, s[8:11], s32 offen lds
    s_add_u32 s32, s32, 128
    s_add_u32 s35, s35, 16384
    s_add_u32 s42, s96, s37
    s_add_u32 m0, s42, 0
    s_nop 0
    buffer_load_dwordx4 v5, s[12:15], s33 offen lds
    s_add_u32 s42, s96, s37
    s_add_u32 m0, s42, 1024
    s_nop 0
    buffer_load_dwordx4 v6, s[12:15], s33 offen lds
    s_add_u32 s42, s96, s37
    s_add_u32 m0, s42, 2048
    s_nop 0
    buffer_load_dwordx4 v7, s[12:15], s33 offen lds
    s_add_u32 s33, s33, 393216
    s_add_u32 s96, s96, 24576
    s_add_u32 s16, s4, 0x400000
    s_addc_u32 s17, s5, 0
    s_mov_b32 s18, 0x400000
    s_mov_b32 s19, 0x00020000
    s_add_u32 s20, s4, 0x800000
    s_addc_u32 s21, s5, 0
    s_mov_b32 s22, 0x21000
    s_mov_b32 s23, 0x00020000
    v_and_b32 v16, 7, v0
    v_xor_b32 v16, v16, v2
    v_lshlrev_b32 v16, 4, v16
    v_lshl_add_u32 v16, v1, 7, v16
    s_mov_b32 s42, 0
    s_mul_i32 s43, s38, 4096
    s_add_u32 s42, s42, s43
    s_mul_i32 s43, s40, 8192
    s_add_u32 s42, s42, s43
    v_add_u32 v8, s42, v16
    v_xor_b32 v9, 64, v8
    s_mov_b32 s42, 3072
    v_mul_lo_u32 v16, v2, s42
    v_lshrrev_b32 v18, 2, v1
    v_lshl_add_u32 v16, v18, 7, v16
    v_bfe_u32 v17, v0, 3, 2
    s_mov_b32 s42, 0
    s_mul_i32 s43, s39, 2
    s_add_u32 s42, s42, s43
    v_xor_b32 v17, s42, v17
    v_lshl_add_u32 v16, v17, 5, v16
    v_bfe_u32 v18, v0, 1, 1
    v_lshl_add_u32 v16, v18, 4, v16
    v_and_b32 v18, 1, v0
    v_lshl_add_u32 v16, v18, 3, v16
    s_mov_b32 s42, 65536
    v_add_u32 v10, s42, v16
    v_xor_b32 v11, 32, v10
    s_mov_b32 s34, 0
    s_mov_b32 s41, 0
    v_add_u32 v12, s34, v8
    v_add_u32 v13, s34, v9
    v_add_u32 v14, s41, v10
    v_add_u32 v15, s41, v11
    s_waitcnt vmcnt(10) lgkmcnt(0)
    s_barrier
    ds_read_b128 a[0:3], v12 offset:0
    ds_read_b128 a[4:7], v12 offset:2048
    ds_read_b64_tr_b16 a[8:9], v14 offset:0
    ds_read_b64_tr_b16 a[10:11], v14 offset:512
    ds_read_b64_tr_b16 a[12:13], v15 offset:0
    ds_read_b64_tr_b16 a[14:15], v15 offset:512
    ds_read_b64_tr_b16 a[16:17], v14 offset:1024
    ds_read_b64_tr_b16 a[18:19], v14 offset:1536
    ds_read_b64_tr_b16 a[20:21], v15 offset:1024
    ds_read_b64_tr_b16 a[22:23], v15 offset:1536
    ds_read_b64_tr_b16 a[24:25], v14 offset:2048
    ds_read_b64_tr_b16 a[26:27], v14 offset:2560
    ds_read_b64_tr_b16 a[28:29], v15 offset:2048
    ds_read_b64_tr_b16 a[30:31], v15 offset:2560
    s_add_u32 s42, s35, s36
    s_add_u32 m0, s42, 0
    s_nop 0
    buffer_load_dwordx4 v3, s[8:11], s32 offen lds
    s_add_u32 s42, s35, s36
    s_add_u32 m0, s42, 1024
    s_nop 0
    buffer_load_dwordx4 v4, s[8:11], s32 offen lds
    s_add_u32 s32, s32, 128
    s_add_u32 s42, s96, s37
    s_add_u32 m0, s42, 0
    s_nop 0
    buffer_load_dwordx4 v5, s[12:15], s33 offen lds
    s_add_u32 s42, s96, s37
    s_add_u32 m0, s42, 1024
    s_nop 0
    buffer_load_dwordx4 v6, s[12:15], s33 offen lds
    s_add_u32 s42, s96, s37
    s_add_u32 m0, s42, 2048
    s_nop 0
    buffer_load_dwordx4 v7, s[12:15], s33 offen lds
    s_add_u32 s33, s33, 393216
    s_waitcnt lgkmcnt(0)
    v_mfma_f32_16x16x32_bf16 v[28:31], a[8:11], a[0:3], 0
    ds_read_b128 a[32:35], v13 offset:0
    ds_read_b128 a[36:39], v13 offset:2048
    v_mfma_f32_16x16x32_bf16 v[32:35], a[8:11], a[4:7], 0
    ds_read_b64_tr_b16 a[40:41], v14 offset:12288
    v_mfma_f32_16x16x32_bf16 v[36:39], a[12:15], a[0:3], 0
    ds_read_b64_tr_b16 a[42:43], v14 offset:12800
    ds_read_b64_tr_b16 a[44:45], v15 offset:12288
    v_mfma_f32_16x16x32_bf16 v[40:43], a[12:15], a[4:7], 0
    ds_read_b64_tr_b16 a[46:47], v15 offset:12800
    v_mfma_f32_16x16x32_bf16 v[44:47], a[0:3], a[16:19], 0
    ds_read_b64_tr_b16 a[48:49], v14 offset:13312
    v_mfma_f32_16x16x32_bf16 v[48:51], a[4:7], a[16:19], 0
    ds_read_b64_tr_b16 a[50:51], v14 offset:13824
    ds_read_b64_tr_b16 a[52:53], v15 offset:13312
    v_mfma_f32_16x16x32_bf16 v[52:55], a[0:3], a[20:23], 0
    ds_read_b64_tr_b16 a[54:55], v15 offset:13824
    v_mfma_f32_16x16x32_bf16 v[56:59], a[4:7], a[20:23], 0
    ds_read_b64_tr_b16 a[56:57], v14 offset:14336
    ds_read_b64_tr_b16 a[58:59], v14 offset:14848
    v_mfma_f32_16x16x32_bf16 v[60:63], a[0:3], a[24:27], 0
    ds_read_b64_tr_b16 a[60:61], v15 offset:14336
    v_mfma_f32_16x16x32_bf16 v[64:67], a[4:7], a[24:27], 0
    ds_read_b64_tr_b16 a[62:63], v15 offset:14848
    v_mfma_f32_16x16x32_bf16 v[68:71], a[0:3], a[28:31], 0
    v_mfma_f32_16x16x32_bf16 v[72:75], a[4:7], a[28:31], 0
    s_waitcnt lgkmcnt(0)
    s_mov_b32 s35, s34
    s_add_u32 s34, s34, 16384
    s_cmp_eq_u32 s34, 65536
    s_cselect_b32 s34, 0, s34
    v_add_u32 v12, s34, v8
    v_add_u32 v13, s34, v9
    s_mov_b32 s96, s41
    s_add_u32 s41, s41, 24576
    s_cmp_eq_u32 s41, 98304
    s_cselect_b32 s41, 0, s41
    v_add_u32 v14, s41, v10
    v_add_u32 v15, s41, v11
    s_waitcnt vmcnt(10)
    s_barrier
    v_mfma_f32_16x16x32_bf16 v[28:31], a[40:43], a[32:35], v[28:31]
    ds_read_b128 a[0:3], v12 offset:0
    ds_read_b128 a[4:7], v12 offset:2048
    ds_read_b64_tr_b16 a[8:9], v14 offset:0
    v_mfma_f32_16x16x32_bf16 v[32:35], a[40:43], a[36:39], v[32:35]
    ds_read_b64_tr_b16 a[10:11], v14 offset:512
    ds_read_b64_tr_b16 a[12:13], v15 offset:0
    v_mfma_f32_16x16x32_bf16 v[36:39], a[44:47], a[32:35], v[36:39]
    ds_read_b64_tr_b16 a[14:15], v15 offset:512
    ds_read_b64_tr_b16 a[16:17], v14 offset:1024
    v_mfma_f32_16x16x32_bf16 v[40:43], a[44:47], a[36:39], v[40:43]
    ds_read_b64_tr_b16 a[18:19], v14 offset:1536
    ds_read_b64_tr_b16 a[20:21], v15 offset:1024
    v_mfma_f32_16x16x32_bf16 v[44:47], a[32:35], a[48:51], v[44:47]
    ds_read_b64_tr_b16 a[22:23], v15 offset:1536
    ds_read_b64_tr_b16 a[24:25], v14 offset:2048
    v_mfma_f32_16x16x32_bf16 v[48:51], a[36:39], a[48:51], v[48:51]
    ds_read_b64_tr_b16 a[26:27], v14 offset:2560
    ds_read_b64_tr_b16 a[28:29], v15 offset:2048
    v_mfma_f32_16x16x32_bf16 v[52:55], a[32:35], a[52:55], v[52:55]
    ds_read_b64_tr_b16 a[30:31], v15 offset:2560
    s_add_u32 s42, s96, s37
    s_add_u32 m0, s42, 0
    s_nop 0
    buffer_load_dwordx4 v5, s[12:15], s33 offen lds
    v_mfma_f32_16x16x32_bf16 v[56:59], a[36:39], a[52:55], v[56:59]
    s_add_u32 s42, s96, s37
    s_add_u32 m0, s42, 1024
    s_nop 0
    buffer_load_dwordx4 v6, s[12:15], s33 offen lds
    s_add_u32 s42, s96, s37
    s_add_u32 m0, s42, 2048
    s_nop 0
    buffer_load_dwordx4 v7, s[12:15], s33 offen lds
    v_mfma_f32_16x16x32_bf16 v[60:63], a[32:35], a[56:59], v[60:63]
    s_add_u32 s33, s33, 393216
    s_add_u32 s42, s35, s36
    s_add_u32 m0, s42, 0
    s_nop 0
    buffer_load_dwordx4 v3, s[8:11], s32 offen lds
    v_mfma_f32_16x16x32_bf16 v[64:67], a[36:39], a[56:59], v[64:67]
    s_add_u32 s42, s35, s36
    s_add_u32 m0, s42, 1024
    s_nop 0
    buffer_load_dwordx4 v4, s[8:11], s32 offen lds
    s_add_u32 s32, s32, 128
    v_mfma_f32_16x16x32_bf16 v[68:71], a[32:35], a[60:63], v[68:71]
    v_mfma_f32_16x16x32_bf16 v[72:75], a[36:39], a[60:63], v[72:75]
    s_waitcnt lgkmcnt(0)
    s_mov_b32 s31, 11
L_loop_6:
    v_mfma_f32_16x16x32_bf16 v[28:31], a[8:11], a[0:3], v[28:31]
    ds_read_b128 a[32:35], v13 offset:0
    ds_read_b128 a[36:39], v13 offset:2048
    v_mfma_f32_16x16x32_bf16 v[32:35], a[8:11], a[4:7], v[32:35]
    ds_read_b64_tr_b16 a[40:41], v14 offset:12288
    v_mfma_f32_16x16x32_bf16 v[36:39], a[12:15], a[0:3], v[36:39]
    ds_read_b64_tr_b16 a[42:43], v14 offset:12800
    ds_read_b64_tr_b16 a[44:45], v15 offset:12288
    v_mfma_f32_16x16x32_bf16 v[40:43], a[12:15], a[4:7], v[40:43]
    ds_read_b64_tr_b16 a[46:47], v15 offset:12800
    v_mfma_f32_16x16x32_bf16 v[44:47], a[0:3], a[16:19], v[44:47]
    ds_read_b64_tr_b16 a[48:49], v14 offset:13312
    v_mfma_f32_16x16x32_bf16 v[48:51], a[4:7], a[16:19], v[48:51]
    ds_read_b64_tr_b16 a[50:51], v14 offset:13824
    ds_read_b64_tr_b16 a[52:53], v15 offset:13312
    v_mfma_f32_16x16x32_bf16 v[52:55], a[0:3], a[20:23], v[52:55]
    ds_read_b64_tr_b16 a[54:55], v15 offset:13824
    v_mfma_f32_16x16x32_bf16 v[56:59], a[4:7], a[20:23], v[56:59]
    ds_read_b64_tr_b16 a[56:57], v14 offset:14336
    ds_read_b64_tr_b16 a[58:59], v14 offset:14848
    v_mfma_f32_16x16x32_bf16 v[60:63], a[0:3], a[24:27], v[60:63]
    ds_read_b64_tr_b16 a[60:61], v15 offset:14336
    v_mfma_f32_16x16x32_bf16 v[64:67], a[4:7], a[24:27], v[64:67]
    ds_read_b64_tr_b16 a[62:63], v15 offset:14848
    v_mfma_f32_16x16x32_bf16 v[68:71], a[0:3], a[28:31], v[68:71]
    v_mfma_f32_16x16x32_bf16 v[72:75], a[4:7], a[28:31], v[72:75]
    s_waitcnt lgkmcnt(0)
    s_mov_b32 s35, s34
    s_add_u32 s34, s34, 16384
    s_cmp_eq_u32 s34, 65536
    s_cselect_b32 s34, 0, s34
    v_add_u32 v12, s34, v8
    v_add_u32 v13, s34, v9
    s_mov_b32 s96, s41
    s_add_u32 s41, s41, 24576
    s_cmp_eq_u32 s41, 98304
    s_cselect_b32 s41, 0, s41
    v_add_u32 v14, s41, v10
    v_add_u32 v15, s41, v11
    s_waitcnt vmcnt(10)
    s_barrier
    v_mfma_f32_16x16x32_bf16 v[28:31], a[40:43], a[32:35], v[28:31]
    ds_read_b128 a[0:3], v12 offset:0
    ds_read_b128 a[4:7], v12 offset:2048
    ds_read_b64_tr_b16 a[8:9], v14 offset:0
    v_mfma_f32_16x16x32_bf16 v[32:35], a[40:43], a[36:39], v[32:35]
    ds_read_b64_tr_b16 a[10:11], v14 offset:512
    ds_read_b64_tr_b16 a[12:13], v15 offset:0
    v_mfma_f32_16x16x32_bf16 v[36:39], a[44:47], a[32:35], v[36:39]
    ds_read_b64_tr_b16 a[14:15], v15 offset:512
    ds_read_b64_tr_b16 a[16:17], v14 offset:1024
    v_mfma_f32_16x16x32_bf16 v[40:43], a[44:47], a[36:39], v[40:43]
    ds_read_b64_tr_b16 a[18:19], v14 offset:1536
    ds_read_b64_tr_b16 a[20:21], v15 offset:1024
    v_mfma_f32_16x16x32_bf16 v[44:47], a[32:35], a[48:51], v[44:47]
    ds_read_b64_tr_b16 a[22:23], v15 offset:1536
    ds_read_b64_tr_b16 a[24:25], v14 offset:2048
    v_mfma_f32_16x16x32_bf16 v[48:51], a[36:39], a[48:51], v[48:51]
    ds_read_b64_tr_b16 a[26:27], v14 offset:2560
    ds_read_b64_tr_b16 a[28:29], v15 offset:2048
    v_mfma_f32_16x16x32_bf16 v[52:55], a[32:35], a[52:55], v[52:55]
    ds_read_b64_tr_b16 a[30:31], v15 offset:2560
    s_add_u32 s42, s96, s37
    s_add_u32 m0, s42, 0
    s_nop 0
    buffer_load_dwordx4 v5, s[12:15], s33 offen lds
    v_mfma_f32_16x16x32_bf16 v[56:59], a[36:39], a[52:55], v[56:59]
    s_add_u32 s42, s96, s37
    s_add_u32 m0, s42, 1024
    s_nop 0
    buffer_load_dwordx4 v6, s[12:15], s33 offen lds
    s_add_u32 s42, s96, s37
    s_add_u32 m0, s42, 2048
    s_nop 0
    buffer_load_dwordx4 v7, s[12:15], s33 offen lds
    v_mfma_f32_16x16x32_bf16 v[60:63], a[32:35], a[56:59], v[60:63]
    s_add_u32 s33, s33, 393216
    s_add_u32 s42, s35, s36
    s_add_u32 m0, s42, 0
    s_nop 0
    buffer_load_dwordx4 v3, s[8:11], s32 offen lds
    v_mfma_f32_16x16x32_bf16 v[64:67], a[36:39], a[56:59], v[64:67]
    s_add_u32 s42, s35, s36
    s_add_u32 m0, s42, 1024
    s_nop 0
    buffer_load_dwordx4 v4, s[8:11], s32 offen lds
    s_add_u32 s32, s32, 128
    v_mfma_f32_16x16x32_bf16 v[68:71], a[32:35], a[60:63], v[68:71]
    v_mfma_f32_16x16x32_bf16 v[72:75], a[36:39], a[60:63], v[72:75]
    s_waitcnt lgkmcnt(0)
    s_sub_u32 s31, s31, 1
    s_cmp_lg_u32 s31, 0
    s_cbranch_scc1 L_loop_6
    v_mfma_f32_16x16x32_bf16 v[28:31], a[8:11], a[0:3], v[28:31]
    ds_read_b128 a[32:35], v13 offset:0
    ds_read_b128 a[36:39], v13 offset:2048
    v_mfma_f32_16x16x32_bf16 v[32:35], a[8:11], a[4:7], v[32:35]
    ds_read_b64_tr_b16 a[40:41], v14 offset:12288
    v_mfma_f32_16x16x32_bf16 v[36:39], a[12:15], a[0:3], v[36:39]
    ds_read_b64_tr_b16 a[42:43], v14 offset:12800
    ds_read_b64_tr_b16 a[44:45], v15 offset:12288
    v_mfma_f32_16x16x32_bf16 v[40:43], a[12:15], a[4:7], v[40:43]
    ds_read_b64_tr_b16 a[46:47], v15 offset:12800
    v_mfma_f32_16x16x32_bf16 v[44:47], a[0:3], a[16:19], v[44:47]
    ds_read_b64_tr_b16 a[48:49], v14 offset:13312
    v_mfma_f32_16x16x32_bf16 v[48:51], a[4:7], a[16:19], v[48:51]
    ds_read_b64_tr_b16 a[50:51], v14 offset:13824
    ds_read_b64_tr_b16 a[52:53], v15 offset:13312
    v_mfma_f32_16x16x32_bf16 v[52:55], a[0:3], a[20:23], v[52:55]
    ds_read_b64_tr_b16 a[54:55], v15 offset:13824
    v_mfma_f32_16x16x32_bf16 v[56:59], a[4:7], a[20:23], v[56:59]
    ds_read_b64_tr_b16 a[56:57], v14 offset:14336
    ds_read_b64_tr_b16 a[58:59], v14 offset:14848
    v_mfma_f32_16x16x32_bf16 v[60:63], a[0:3], a[24:27], v[60:63]
    ds_read_b64_tr_b16 a[60:61], v15 offset:14336
    v_mfma_f32_16x16x32_bf16 v[64:67], a[4:7], a[24:27], v[64:67]
    ds_read_b64_tr_b16 a[62:63], v15 offset:14848
    v_mfma_f32_16x16x32_bf16 v[68:71], a[0:3], a[28:31], v[68:71]
    v_mfma_f32_16x16x32_bf16 v[72:75], a[4:7], a[28:31], v[72:75]
    s_waitcnt lgkmcnt(0)
    s_mov_b32 s35, s34
    s_add_u32 s34, s34, 16384
    s_cmp_eq_u32 s34, 65536
    s_cselect_b32 s34, 0, s34
    v_add_u32 v12, s34, v8
    v_add_u32 v13, s34, v9
    s_mov_b32 s96, s41
    s_add_u32 s41, s41, 24576
    s_cmp_eq_u32 s41, 98304
    s_cselect_b32 s41, 0, s41
    v_add_u32 v14, s41, v10
    v_add_u32 v15, s41, v11
    s_waitcnt vmcnt(10)
    s_barrier
    v_mfma_f32_16x16x32_bf16 v[28:31], a[40:43], a[32:35], v[28:31]
    ds_read_b128 a[0:3], v12 offset:0
    ds_read_b128 a[4:7], v12 offset:2048
    v_mfma_f32_16x16x32_bf16 v[32:35], a[40:43], a[36:39], v[32:35]
    ds_read_b64_tr_b16 a[8:9], v14 offset:0
    v_mfma_f32_16x16x32_bf16 v[36:39], a[44:47], a[32:35], v[36:39]
    ds_read_b64_tr_b16 a[10:11], v14 offset:512
    ds_read_b64_tr_b16 a[12:13], v15 offset:0
    v_mfma_f32_16x16x32_bf16 v[40:43], a[44:47], a[36:39], v[40:43]
    ds_read_b64_tr_b16 a[14:15], v15 offset:512
    v_mfma_f32_16x16x32_bf16 v[44:47], a[32:35], a[48:51], v[44:47]
    ds_read_b64_tr_b16 a[16:17], v14 offset:1024
    v_mfma_f32_16x16x32_bf16 v[48:51], a[36:39], a[48:51], v[48:51]
    ds_read_b64_tr_b16 a[18:19], v14 offset:1536
    ds_read_b64_tr_b16 a[20:21], v15 offset:1024
    v_mfma_f32_16x16x32_bf16 v[52:55], a[32:35], a[52:55], v[52:55]
    ds_read_b64_tr_b16 a[22:23], v15 offset:1536
    v_mfma_f32_16x16x32_bf16 v[56:59], a[36:39], a[52:55], v[56:59]
    ds_read_b64_tr_b16 a[24:25], v14 offset:2048
    ds_read_b64_tr_b16 a[26:27], v14 offset:2560
    v_mfma_f32_16x16x32_bf16 v[60:63], a[32:35], a[56:59], v[60:63]
    ds_read_b64_tr_b16 a[28:29], v15 offset:2048
    v_mfma_f32_16x16x32_bf16 v[64:67], a[36:39], a[56:59], v[64:67]
    ds_read_b64_tr_b16 a[30:31], v15 offset:2560
    v_mfma_f32_16x16x32_bf16 v[68:71], a[32:35], a[60:63], v[68:71]
    v_mfma_f32_16x16x32_bf16 v[72:75], a[36:39], a[60:63], v[72:75]
    s_waitcnt lgkmcnt(0)
    v_mfma_f32_16x16x32_bf16 v[28:31], a[8:11], a[0:3], v[28:31]
    ds_read_b128 a[32:35], v13 offset:0
    ds_read_b128 a[36:39], v13 offset:2048
    v_mfma_f32_16x16x32_bf16 v[32:35], a[8:11], a[4:7], v[32:35]
    ds_read_b64_tr_b16 a[40:41], v14 offset:12288
    v_mfma_f32_16x16x32_bf16 v[36:39], a[12:15], a[0:3], v[36:39]
    ds_read_b64_tr_b16 a[42:43], v14 offset:12800
    ds_read_b64_tr_b16 a[44:45], v15 offset:12288
    v_mfma_f32_16x16x32_bf16 v[40:43], a[12:15], a[4:7], v[40:43]
    ds_read_b64_tr_b16 a[46:47], v15 offset:12800
    v_mfma_f32_16x16x32_bf16 v[44:47], a[0:3], a[16:19], v[44:47]
    ds_read_b64_tr_b16 a[48:49], v14 offset:13312
    v_mfma_f32_16x16x32_bf16 v[48:51], a[4:7], a[16:19], v[48:51]
    ds_read_b64_tr_b16 a[50:51], v14 offset:13824
    ds_read_b64_tr_b16 a[52:53], v15 offset:13312
    v_mfma_f32_16x16x32_bf16 v[52:55], a[0:3], a[20:23], v[52:55]
    ds_read_b64_tr_b16 a[54:55], v15 offset:13824
    v_mfma_f32_16x16x32_bf16 v[56:59], a[4:7], a[20:23], v[56:59]
    ds_read_b64_tr_b16 a[56:57], v14 offset:14336
    ds_read_b64_tr_b16 a[58:59], v14 offset:14848
    v_mfma_f32_16x16x32_bf16 v[60:63], a[0:3], a[24:27], v[60:63]
    ds_read_b64_tr_b16 a[60:61], v15 offset:14336
    v_mfma_f32_16x16x32_bf16 v[64:67], a[4:7], a[24:27], v[64:67]
    ds_read_b64_tr_b16 a[62:63], v15 offset:14848
    v_mfma_f32_16x16x32_bf16 v[68:71], a[0:3], a[28:31], v[68:71]
    v_mfma_f32_16x16x32_bf16 v[72:75], a[4:7], a[28:31], v[72:75]
    s_waitcnt lgkmcnt(0)
    s_mov_b32 s35, s34
    s_add_u32 s34, s34, 16384
    s_cmp_eq_u32 s34, 65536
    s_cselect_b32 s34, 0, s34
    v_add_u32 v12, s34, v8
    v_add_u32 v13, s34, v9
    s_mov_b32 s96, s41
    s_add_u32 s41, s41, 24576
    s_cmp_eq_u32 s41, 98304
    s_cselect_b32 s41, 0, s41
    v_add_u32 v14, s41, v10
    v_add_u32 v15, s41, v11
    s_waitcnt vmcnt(5)
    s_barrier
    v_mfma_f32_16x16x32_bf16 v[28:31], a[40:43], a[32:35], v[28:31]
    ds_read_b128 a[0:3], v12 offset:0
    ds_read_b128 a[4:7], v12 offset:2048
    v_mfma_f32_16x16x32_bf16 v[32:35], a[40:43], a[36:39], v[32:35]
    ds_read_b64_tr_b16 a[8:9], v14 offset:0
    v_mfma_f32_16x16x32_bf16 v[36:39], a[44:47], a[32:35], v[36:39]
    ds_read_b64_tr_b16 a[10:11], v14 offset:512
    ds_read_b64_tr_b16 a[12:13], v15 offset:0
    v_mfma_f32_16x16x32_bf16 v[40:43], a[44:47], a[36:39], v[40:43]
    ds_read_b64_tr_b16 a[14:15], v15 offset:512
    v_mfma_f32_16x16x32_bf16 v[44:47], a[32:35], a[48:51], v[44:47]
    ds_read_b64_tr_b16 a[16:17], v14 offset:1024
    v_mfma_f32_16x16x32_bf16 v[48:51], a[36:39], a[48:51], v[48:51]
    ds_read_b64_tr_b16 a[18:19], v14 offset:1536
    ds_read_b64_tr_b16 a[20:21], v15 offset:1024
    v_mfma_f32_16x16x32_bf16 v[52:55], a[32:35], a[52:55], v[52:55]
    ds_read_b64_tr_b16 a[22:23], v15 offset:1536
    v_mfma_f32_16x16x32_bf16 v[56:59], a[36:39], a[52:55], v[56:59]
    ds_read_b64_tr_b16 a[24:25], v14 offset:2048
    ds_read_b64_tr_b16 a[26:27], v14 offset:2560
    v_mfma_f32_16x16x32_bf16 v[60:63], a[32:35], a[56:59], v[60:63]
    ds_read_b64_tr_b16 a[28:29], v15 offset:2048
    v_mfma_f32_16x16x32_bf16 v[64:67], a[36:39], a[56:59], v[64:67]
    ds_read_b64_tr_b16 a[30:31], v15 offset:2560
    v_mfma_f32_16x16x32_bf16 v[68:71], a[32:35], a[60:63], v[68:71]
    v_mfma_f32_16x16x32_bf16 v[72:75], a[36:39], a[60:63], v[72:75]
    s_waitcnt lgkmcnt(0)
    v_mfma_f32_16x16x32_bf16 v[28:31], a[8:11], a[0:3], v[28:31]
    ds_read_b128 a[32:35], v13 offset:0
    ds_read_b128 a[36:39], v13 offset:2048
    v_mfma_f32_16x16x32_bf16 v[32:35], a[8:11], a[4:7], v[32:35]
    ds_read_b64_tr_b16 a[40:41], v14 offset:12288
    v_mfma_f32_16x16x32_bf16 v[36:39], a[12:15], a[0:3], v[36:39]
    ds_read_b64_tr_b16 a[42:43], v14 offset:12800
    ds_read_b64_tr_b16 a[44:45], v15 offset:12288
    v_mfma_f32_16x16x32_bf16 v[40:43], a[12:15], a[4:7], v[40:43]
    ds_read_b64_tr_b16 a[46:47], v15 offset:12800
    v_mfma_f32_16x16x32_bf16 v[44:47], a[0:3], a[16:19], v[44:47]
    ds_read_b64_tr_b16 a[48:49], v14 offset:13312
    v_mfma_f32_16x16x32_bf16 v[48:51], a[4:7], a[16:19], v[48:51]
    ds_read_b64_tr_b16 a[50:51], v14 offset:13824
    ds_read_b64_tr_b16 a[52:53], v15 offset:13312
    v_mfma_f32_16x16x32_bf16 v[52:55], a[0:3], a[20:23], v[52:55]
    ds_read_b64_tr_b16 a[54:55], v15 offset:13824
    v_mfma_f32_16x16x32_bf16 v[56:59], a[4:7], a[20:23], v[56:59]
    ds_read_b64_tr_b16 a[56:57], v14 offset:14336
    ds_read_b64_tr_b16 a[58:59], v14 offset:14848
    v_mfma_f32_16x16x32_bf16 v[60:63], a[0:3], a[24:27], v[60:63]
    ds_read_b64_tr_b16 a[60:61], v15 offset:14336
    v_mfma_f32_16x16x32_bf16 v[64:67], a[4:7], a[24:27], v[64:67]
    ds_read_b64_tr_b16 a[62:63], v15 offset:14848
    v_mfma_f32_16x16x32_bf16 v[68:71], a[0:3], a[28:31], v[68:71]
    v_mfma_f32_16x16x32_bf16 v[72:75], a[4:7], a[28:31], v[72:75]
    s_waitcnt lgkmcnt(0)
    s_mov_b32 s35, s34
    s_add_u32 s34, s34, 16384
    s_cmp_eq_u32 s34, 65536
    s_cselect_b32 s34, 0, s34
    v_add_u32 v12, s34, v8
    v_add_u32 v13, s34, v9
    s_mov_b32 s96, s41
    s_add_u32 s41, s41, 24576
    s_cmp_eq_u32 s41, 98304
    s_cselect_b32 s41, 0, s41
    v_add_u32 v14, s41, v10
    v_add_u32 v15, s41, v11
    s_waitcnt vmcnt(0)
    s_barrier
    v_mfma_f32_16x16x32_bf16 v[28:31], a[40:43], a[32:35], v[28:31]
    ds_read_b128 a[0:3], v12 offset:0
    ds_read_b128 a[4:7], v12 offset:2048
    v_mfma_f32_16x16x32_bf16 v[32:35], a[40:43], a[36:39], v[32:35]
    ds_read_b64_tr_b16 a[8:9], v14 offset:0
    v_mfma_f32_16x16x32_bf16 v[36:39], a[44:47], a[32:35], v[36:39]
    ds_read_b64_tr_b16 a[10:11], v14 offset:512
    ds_read_b64_tr_b16 a[12:13], v15 offset:0
    v_mfma_f32_16x16x32_bf16 v[40:43], a[44:47], a[36:39], v[40:43]
    ds_read_b64_tr_b16 a[14:15], v15 offset:512
    v_mfma_f32_16x16x32_bf16 v[44:47], a[32:35], a[48:51], v[44:47]
    ds_read_b64_tr_b16 a[16:17], v14 offset:1024
    v_mfma_f32_16x16x32_bf16 v[48:51], a[36:39], a[48:51], v[48:51]
    ds_read_b64_tr_b16 a[18:19], v14 offset:1536
    ds_read_b64_tr_b16 a[20:21], v15 offset:1024
    v_mfma_f32_16x16x32_bf16 v[52:55], a[32:35], a[52:55], v[52:55]
    ds_read_b64_tr_b16 a[22:23], v15 offset:1536
    v_mfma_f32_16x16x32_bf16 v[56:59], a[36:39], a[52:55], v[56:59]
    ds_read_b64_tr_b16 a[24:25], v14 offset:2048
    ds_read_b64_tr_b16 a[26:27], v14 offset:2560
    v_mfma_f32_16x16x32_bf16 v[60:63], a[32:35], a[56:59], v[60:63]
    ds_read_b64_tr_b16 a[28:29], v15 offset:2048
    v_mfma_f32_16x16x32_bf16 v[64:67], a[36:39], a[56:59], v[64:67]
    ds_read_b64_tr_b16 a[30:31], v15 offset:2560
    v_mfma_f32_16x16x32_bf16 v[68:71], a[32:35], a[60:63], v[68:71]
    v_mfma_f32_16x16x32_bf16 v[72:75], a[36:39], a[60:63], v[72:75]
    s_waitcnt lgkmcnt(0)
    v_mfma_f32_16x16x32_bf16 v[28:31], a[8:11], a[0:3], v[28:31]
    ds_read_b128 a[32:35], v13 offset:0
    ds_read_b128 a[36:39], v13 offset:2048
    v_mfma_f32_16x16x32_bf16 v[32:35], a[8:11], a[4:7], v[32:35]
    ds_read_b64_tr_b16 a[40:41], v14 offset:12288
    v_mfma_f32_16x16x32_bf16 v[36:39], a[12:15], a[0:3], v[36:39]
    ds_read_b64_tr_b16 a[42:43], v14 offset:12800
    ds_read_b64_tr_b16 a[44:45], v15 offset:12288
    v_mfma_f32_16x16x32_bf16 v[40:43], a[12:15], a[4:7], v[40:43]
    ds_read_b64_tr_b16 a[46:47], v15 offset:12800
    v_mfma_f32_16x16x32_bf16 v[44:47], a[0:3], a[16:19], v[44:47]
    ds_read_b64_tr_b16 a[48:49], v14 offset:13312
    v_mfma_f32_16x16x32_bf16 v[48:51], a[4:7], a[16:19], v[48:51]
    ds_read_b64_tr_b16 a[50:51], v14 offset:13824
    ds_read_b64_tr_b16 a[52:53], v15 offset:13312
    v_mfma_f32_16x16x32_bf16 v[52:55], a[0:3], a[20:23], v[52:55]
    ds_read_b64_tr_b16 a[54:55], v15 offset:13824
    v_mfma_f32_16x16x32_bf16 v[56:59], a[4:7], a[20:23], v[56:59]
    ds_read_b64_tr_b16 a[56:57], v14 offset:14336
    ds_read_b64_tr_b16 a[58:59], v14 offset:14848
    v_mfma_f32_16x16x32_bf16 v[60:63], a[0:3], a[24:27], v[60:63]
    ds_read_b64_tr_b16 a[60:61], v15 offset:14336
    v_mfma_f32_16x16x32_bf16 v[64:67], a[4:7], a[24:27], v[64:67]
    ds_read_b64_tr_b16 a[62:63], v15 offset:14848
    v_mfma_f32_16x16x32_bf16 v[68:71], a[0:3], a[28:31], v[68:71]
    v_mfma_f32_16x16x32_bf16 v[72:75], a[4:7], a[28:31], v[72:75]
    s_waitcnt lgkmcnt(0)
    v_mfma_f32_16x16x32_bf16 v[28:31], a[40:43], a[32:35], v[28:31]
    v_mfma_f32_16x16x32_bf16 v[32:35], a[40:43], a[36:39], v[32:35]
    v_mfma_f32_16x16x32_bf16 v[36:39], a[44:47], a[32:35], v[36:39]
    v_mfma_f32_16x16x32_bf16 v[40:43], a[44:47], a[36:39], v[40:43]
    v_mfma_f32_16x16x32_bf16 v[44:47], a[32:35], a[48:51], v[44:47]
    v_mfma_f32_16x16x32_bf16 v[48:51], a[36:39], a[48:51], v[48:51]
    v_mfma_f32_16x16x32_bf16 v[52:55], a[32:35], a[52:55], v[52:55]
    v_mfma_f32_16x16x32_bf16 v[56:59], a[36:39], a[52:55], v[56:59]
    v_mfma_f32_16x16x32_bf16 v[60:63], a[32:35], a[56:59], v[60:63]
    v_mfma_f32_16x16x32_bf16 v[64:67], a[36:39], a[56:59], v[64:67]
    v_mfma_f32_16x16x32_bf16 v[68:71], a[32:35], a[60:63], v[68:71]
    v_mfma_f32_16x16x32_bf16 v[72:75], a[36:39], a[60:63], v[72:75]
    s_nop 7
    s_mov_b32 s42, 0
    s_mul_i32 s43, s38, 65536
    s_add_u32 s42, s42, s43
    s_mul_i32 s43, s40, 131072
    s_add_u32 s42, s42, s43
    s_lshl_b32 s43, s29, 18
    s_add_u32 s42, s42, s43
    s_lshl_b32 s43, s30, 7
    s_add_u32 s42, s42, s43
    s_lshl_b32 s43, s39, 6
    s_add_u32 s42, s42, s43
    s_add_u32 s43, s42, 32768
    v_lshlrev_b32 v8, 11, v1
    v_lshl_add_u32 v8, v2, 3, v8
    v_cvt_pk_bf16_f32 v4, v44, v45
    v_cvt_pk_bf16_f32 v5, v46, v47
    v_lshlrev_b32 v44, 16, v4
    v_and_b32 v45, 0xffff0000, v4
    v_lshlrev_b32 v46, 16, v5
    v_and_b32 v47, 0xffff0000, v5
    v_min_f32 v4, 0, v44
    v_min_f32 v5, 0, v45
    v_min_f32 v6, 0, v46
    v_min_f32 v7, 0, v47
    v_mul_f32 v4, 0x3fb8aa3b, v4
    v_mul_f32 v5, 0x3fb8aa3b, v5
    v_mul_f32 v6, 0x3fb8aa3b, v6
    v_mul_f32 v7, 0x3fb8aa3b, v7
    v_exp_f32 v4, v4
    v_exp_f32 v5, v5
    v_exp_f32 v6, v6
    v_exp_f32 v7, v7
    v_max_f32 v44, 0, v44
    v_max_f32 v45, 0, v45
    v_max_f32 v46, 0, v46
    v_max_f32 v47, 0, v47
    v_add_f32 v44, v44, v4
    v_add_f32 v45, v45, v5
    v_add_f32 v46, v46, v6
    v_add_f32 v47, v47, v7
    v_add_f32 v44, 0x358637bd, v44
    v_add_f32 v45, 0x358637bd, v45
    v_add_f32 v46, 0x358637bd, v46
    v_add_f32 v47, 0x358637bd, v47
    v_cvt_pk_bf16_f32 v76, v44, v45
    v_cvt_pk_bf16_f32 v77, v46, v47
    v_cvt_pk_bf16_f32 v4, v52, v53
    v_cvt_pk_bf16_f32 v5, v54, v55
    v_lshlrev_b32 v52, 16, v4
    v_and_b32 v53, 0xffff0000, v4
    v_lshlrev_b32 v54, 16, v5
    v_and_b32 v55, 0xffff0000, v5
    v_min_f32 v4, 0, v52
    v_min_f32 v5, 0, v53
    v_min_f32 v6, 0, v54
    v_min_f32 v7, 0, v55
    v_mul_f32 v4, 0x3fb8aa3b, v4
    v_mul_f32 v5, 0x3fb8aa3b, v5
    v_mul_f32 v6, 0x3fb8aa3b, v6
    v_mul_f32 v7, 0x3fb8aa3b, v7
    v_exp_f32 v4, v4
    v_exp_f32 v5, v5
    v_exp_f32 v6, v6
    v_exp_f32 v7, v7
    v_max_f32 v52, 0, v52
    v_max_f32 v53, 0, v53
    v_max_f32 v54, 0, v54
    v_max_f32 v55, 0, v55
    v_add_f32 v52, v52, v4
    v_add_f32 v53, v53, v5
    v_add_f32 v54, v54, v6
    v_add_f32 v55, v55, v7
    v_add_f32 v52, 0x358637bd, v52
    v_add_f32 v53, 0x358637bd, v53
    v_add_f32 v54, 0x358637bd, v54
    v_add_f32 v55, 0x358637bd, v55
    v_cvt_pk_bf16_f32 v80, v52, v53
    v_cvt_pk_bf16_f32 v81, v54, v55
    v_cvt_pk_bf16_f32 v84, v60, v61
    v_cvt_pk_bf16_f32 v85, v62, v63
    v_cvt_pk_bf16_f32 v88, v68, v69
    v_cvt_pk_bf16_f32 v89, v70, v71
    v_cvt_pk_bf16_f32 v4, v48, v49
    v_cvt_pk_bf16_f32 v5, v50, v51
    v_lshlrev_b32 v48, 16, v4
    v_and_b32 v49, 0xffff0000, v4
    v_lshlrev_b32 v50, 16, v5
    v_and_b32 v51, 0xffff0000, v5
    v_min_f32 v4, 0, v48
    v_min_f32 v5, 0, v49
    v_min_f32 v6, 0, v50
    v_min_f32 v7, 0, v51
    v_mul_f32 v4, 0x3fb8aa3b, v4
    v_mul_f32 v5, 0x3fb8aa3b, v5
    v_mul_f32 v6, 0x3fb8aa3b, v6
    v_mul_f32 v7, 0x3fb8aa3b, v7
    v_exp_f32 v4, v4
    v_exp_f32 v5, v5
    v_exp_f32 v6, v6
    v_exp_f32 v7, v7
    v_max_f32 v48, 0, v48
    v_max_f32 v49, 0, v49
    v_max_f32 v50, 0, v50
    v_max_f32 v51, 0, v51
    v_add_f32 v48, v48, v4
    v_add_f32 v49, v49, v5
    v_add_f32 v50, v50, v6
    v_add_f32 v51, v51, v7
    v_add_f32 v48, 0x358637bd, v48
    v_add_f32 v49, 0x358637bd, v49
    v_add_f32 v50, 0x358637bd, v50
    v_add_f32 v51, 0x358637bd, v51
    v_cvt_pk_bf16_f32 v78, v48, v49
    v_cvt_pk_bf16_f32 v79, v50, v51
    v_cvt_pk_bf16_f32 v4, v56, v57
    v_cvt_pk_bf16_f32 v5, v58, v59
    v_lshlrev_b32 v56, 16, v4
    v_and_b32 v57, 0xffff0000, v4
    v_lshlrev_b32 v58, 16, v5
    v_and_b32 v59, 0xffff0000, v5
    v_min_f32 v4, 0, v56
    v_min_f32 v5, 0, v57
    v_min_f32 v6, 0, v58
    v_min_f32 v7, 0, v59
    v_mul_f32 v4, 0x3fb8aa3b, v4
    v_mul_f32 v5, 0x3fb8aa3b, v5
    v_mul_f32 v6, 0x3fb8aa3b, v6
    v_mul_f32 v7, 0x3fb8aa3b, v7
    v_exp_f32 v4, v4
    v_exp_f32 v5, v5
    v_exp_f32 v6, v6
    v_exp_f32 v7, v7
    v_max_f32 v56, 0, v56
    v_max_f32 v57, 0, v57
    v_max_f32 v58, 0, v58
    v_max_f32 v59, 0, v59
    v_add_f32 v56, v56, v4
    v_add_f32 v57, v57, v5
    v_add_f32 v58, v58, v6
    v_add_f32 v59, v59, v7
    v_add_f32 v56, 0x358637bd, v56
    v_add_f32 v57, 0x358637bd, v57
    v_add_f32 v58, 0x358637bd, v58
    v_add_f32 v59, 0x358637bd, v59
    v_cvt_pk_bf16_f32 v82, v56, v57
    v_cvt_pk_bf16_f32 v83, v58, v59
    v_cvt_pk_bf16_f32 v86, v64, v65
    v_cvt_pk_bf16_f32 v87, v66, v67
    v_cvt_pk_bf16_f32 v90, v72, v73
    v_cvt_pk_bf16_f32 v91, v74, v75
    v_mov_b32 v92, 0x3f803f80
    v_mov_b32 v93, 0x3f803f80
    v_mov_b32 v94, 0x3f803f80
    v_mov_b32 v95, 0x3f803f80
    s_nop 1
    v_mfma_f32_16x16x32_bf16 v[44:47], v[84:87], v[76:79], 0
    v_mfma_f32_16x16x32_bf16 v[48:51], v[84:87], v[80:83], 0
    v_mfma_f32_16x16x32_bf16 v[52:55], v[88:91], v[76:79], 0
    v_mfma_f32_16x16x32_bf16 v[56:59], v[88:91], v[80:83], 0
    v_mfma_f32_16x16x32_bf16 v[60:63], v[92:95], v[76:79], 0
    v_mfma_f32_16x16x32_bf16 v[64:67], v[92:95], v[80:83], 0
    v_cvt_pk_bf16_f32 v4, v28, v29
    v_cvt_pk_bf16_f32 v5, v30, v31
    v_lshlrev_b32 v28, 16, v4
    v_and_b32 v29, 0xffff0000, v4
    v_lshlrev_b32 v30, 16, v5
    v_and_b32 v31, 0xffff0000, v5
    v_min_f32 v4, 0, v28
    v_min_f32 v5, 0, v29
    v_min_f32 v6, 0, v30
    v_min_f32 v7, 0, v31
    v_mul_f32 v4, 0x3fb8aa3b, v4
    v_mul_f32 v5, 0x3fb8aa3b, v5
    v_mul_f32 v6, 0x3fb8aa3b, v6
    v_mul_f32 v7, 0x3fb8aa3b, v7
    v_exp_f32 v4, v4
    v_exp_f32 v5, v5
    v_exp_f32 v6, v6
    v_exp_f32 v7, v7
    v_max_f32 v28, 0, v28
    v_max_f32 v29, 0, v29
    v_max_f32 v30, 0, v30
    v_max_f32 v31, 0, v31
    v_add_f32 v28, v28, v4
    v_add_f32 v29, v29, v5
    v_add_f32 v30, v30, v6
    v_add_f32 v31, v31, v7
    v_add_f32 v28, 0x358637bd, v28
    v_add_f32 v29, 0x358637bd, v29
    v_add_f32 v30, 0x358637bd, v30
    v_add_f32 v31, 0x358637bd, v31
    v_cvt_pk_bf16_f32 v28, v28, v29
    v_cvt_pk_bf16_f32 v29, v30, v31
    buffer_store_dwordx2 v[28:29], v8, s[16:19], s42 offen offset:0
    v_cvt_pk_bf16_f32 v4, v36, v37
    v_cvt_pk_bf16_f32 v5, v38, v39
    v_lshlrev_b32 v36, 16, v4
    v_and_b32 v37, 0xffff0000, v4
    v_lshlrev_b32 v38, 16, v5
    v_and_b32 v39, 0xffff0000, v5
    v_min_f32 v4, 0, v36
    v_min_f32 v5, 0, v37
    v_min_f32 v6, 0, v38
    v_min_f32 v7, 0, v39
    v_mul_f32 v4, 0x3fb8aa3b, v4
    v_mul_f32 v5, 0x3fb8aa3b, v5
    v_mul_f32 v6, 0x3fb8aa3b, v6
    v_mul_f32 v7, 0x3fb8aa3b, v7
    v_exp_f32 v4, v4
    v_exp_f32 v5, v5
    v_exp_f32 v6, v6
    v_exp_f32 v7, v7
    v_max_f32 v36, 0, v36
    v_max_f32 v37, 0, v37
    v_max_f32 v38, 0, v38
    v_max_f32 v39, 0, v39
    v_add_f32 v36, v36, v4
    v_add_f32 v37, v37, v5
    v_add_f32 v38, v38, v6
    v_add_f32 v39, v39, v7
    v_add_f32 v36, 0x358637bd, v36
    v_add_f32 v37, 0x358637bd, v37
    v_add_f32 v38, 0x358637bd, v38
    v_add_f32 v39, 0x358637bd, v39
    v_cvt_pk_bf16_f32 v36, v36, v37
    v_cvt_pk_bf16_f32 v37, v38, v39
    buffer_store_dwordx2 v[36:37], v8, s[16:19], s42 offen offset:32
    v_cvt_pk_bf16_f32 v4, v32, v33
    v_cvt_pk_bf16_f32 v5, v34, v35
    v_lshlrev_b32 v32, 16, v4
    v_and_b32 v33, 0xffff0000, v4
    v_lshlrev_b32 v34, 16, v5
    v_and_b32 v35, 0xffff0000, v5
    v_min_f32 v4, 0, v32
    v_min_f32 v5, 0, v33
    v_min_f32 v6, 0, v34
    v_min_f32 v7, 0, v35
    v_mul_f32 v4, 0x3fb8aa3b, v4
    v_mul_f32 v5, 0x3fb8aa3b, v5
    v_mul_f32 v6, 0x3fb8aa3b, v6
    v_mul_f32 v7, 0x3fb8aa3b, v7
    v_exp_f32 v4, v4
    v_exp_f32 v5, v5
    v_exp_f32 v6, v6
    v_exp_f32 v7, v7
    v_max_f32 v32, 0, v32
    v_max_f32 v33, 0, v33
    v_max_f32 v34, 0, v34
    v_max_f32 v35, 0, v35
    v_add_f32 v32, v32, v4
    v_add_f32 v33, v33, v5
    v_add_f32 v34, v34, v6
    v_add_f32 v35, v35, v7
    v_add_f32 v32, 0x358637bd, v32
    v_add_f32 v33, 0x358637bd, v33
    v_add_f32 v34, 0x358637bd, v34
    v_add_f32 v35, 0x358637bd, v35
    v_cvt_pk_bf16_f32 v32, v32, v33
    v_cvt_pk_bf16_f32 v33, v34, v35
    buffer_store_dwordx2 v[32:33], v8, s[16:19], s43 offen offset:0
    v_cvt_pk_bf16_f32 v4, v40, v41
    v_cvt_pk_bf16_f32 v5, v42, v43
    v_lshlrev_b32 v40, 16, v4
    v_and_b32 v41, 0xffff0000, v4
    v_lshlrev_b32 v42, 16, v5
    v_and_b32 v43, 0xffff0000, v5
    v_min_f32 v4, 0, v40
    v_min_f32 v5, 0, v41
    v_min_f32 v6, 0, v42
    v_min_f32 v7, 0, v43
    v_mul_f32 v4, 0x3fb8aa3b, v4
    v_mul_f32 v5, 0x3fb8aa3b, v5
    v_mul_f32 v6, 0x3fb8aa3b, v6
    v_mul_f32 v7, 0x3fb8aa3b, v7
    v_exp_f32 v4, v4
    v_exp_f32 v5, v5
    v_exp_f32 v6, v6
    v_exp_f32 v7, v7
    v_max_f32 v40, 0, v40
    v_max_f32 v41, 0, v41
    v_max_f32 v42, 0, v42
    v_max_f32 v43, 0, v43
    v_add_f32 v40, v40, v4
    v_add_f32 v41, v41, v5
    v_add_f32 v42, v42, v6
    v_add_f32 v43, v43, v7
    v_add_f32 v40, 0x358637bd, v40
    v_add_f32 v41, 0x358637bd, v41
    v_add_f32 v42, 0x358637bd, v42
    v_add_f32 v43, 0x358637bd, v43
    v_cvt_pk_bf16_f32 v40, v40, v41
    v_cvt_pk_bf16_f32 v41, v42, v43
    buffer_store_dwordx2 v[40:41], v8, s[16:19], s43 offen offset:32
    s_barrier
    s_mul_i32 s44, s28, 5120
    v_lshlrev_b32 v9, 4, v0
    v_add_u32 v9, s44, v9
    ds_write_b128 v9, v[44:47] offset:0
    ds_write_b128 v9, v[48:51] offset:1024
    ds_write_b128 v9, v[52:55] offset:2048
    ds_write_b128 v9, v[56:59] offset:3072
    v_mov_b32 v61, v64
    ds_write_b64 v9, v[60:61] offset:4096
    s_waitcnt lgkmcnt(0)
    s_barrier
    s_mov_b32 s44, 0
    s_mul_i32 s45, s38, 64
    s_add_u32 s44, s44, s45
    s_mul_i32 s45, s39, 10240
    s_add_u32 s44, s44, s45
    s_mul_i32 s45, s40, 2048
    s_add_u32 s44, s44, s45
    v_lshlrev_b32 v9, 8, v2
    v_and_b32 v10, 3, v0
    v_lshl_add_u32 v9, v10, 4, v9
    v_bfe_u32 v10, v0, 2, 2
    v_lshl_add_u32 v9, v10, 2, v9
    v_add_u32 v9, s44, v9
    ds_read_b32 v44, v9 offset:0
    ds_read_b32 v48, v9 offset:5120
    ds_read_b32 v52, v9 offset:20480
    ds_read_b32 v56, v9 offset:25600
    ds_read_b32 v45, v9 offset:128
    ds_read_b32 v49, v9 offset:5248
    ds_read_b32 v53, v9 offset:20608
    ds_read_b32 v57, v9 offset:25728
    ds_read_b32 v46, v9 offset:1024
    ds_read_b32 v50, v9 offset:6144
    ds_read_b32 v54, v9 offset:21504
    ds_read_b32 v58, v9 offset:26624
    ds_read_b32 v47, v9 offset:1152
    ds_read_b32 v51, v9 offset:6272
    ds_read_b32 v55, v9 offset:21632
    ds_read_b32 v59, v9 offset:26752
    s_mov_b32 s45, 4096
    s_mul_i32 s46, s39, 10240
    s_add_u32 s45, s45, s46
    v_lshlrev_b32 v10, 4, v0
    v_add_u32 v10, s45, v10
    ds_read_b64 v[60:61], v10 offset:0
    ds_read_b64 v[62:63], v10 offset:5120
    ds_read_b64 v[64:65], v10 offset:20480
    ds_read_b64 v[66:67], v10 offset:25600
    s_lshl_b32 s42, s30, 1
    s_add_u32 s42, s42, s39
    s_lshl_b32 s43, s42, 12
    s_mov_b32 s46, 0
    s_mul_i32 s47, s38, 1024
    s_add_u32 s46, s46, s47
    s_mul_i32 s47, s40, 2048
    s_add_u32 s46, s46, s47
    s_add_u32 s43, s43, s46
    s_lshl_b32 s44, s42, 7
    s_add_u32 s44, s44, 131072
    v_lshlrev_b32 v8, 2, v0
    v_lshlrev_b32 v9, 2, v1
    s_waitcnt lgkmcnt(0)
    v_add_f32 v44, v44, v48
    v_add_f32 v52, v52, v56
    v_add_f32 v45, v45, v49
    v_add_f32 v53, v53, v57
    v_add_f32 v46, v46, v50
    v_add_f32 v54, v54, v58
    v_add_f32 v47, v47, v51
    v_add_f32 v55, v55, v59
    v_add_f32 v44, v44, v52
    v_add_f32 v45, v45, v53
    v_add_f32 v46, v46, v54
    v_add_f32 v47, v47, v55
    buffer_atomic_add_f32 v44, v8, s[20:23], s43 offen offset:0
    buffer_atomic_add_f32 v45, v8, s[20:23], s43 offen offset:256
    buffer_atomic_add_f32 v46, v8, s[20:23], s43 offen offset:512
    buffer_atomic_add_f32 v47, v8, s[20:23], s43 offen offset:768
    s_or_b32 s45, s38, s40
    s_cmp_lg_u32 s45, 0
    s_cbranch_scc1 L_noz_7
    v_add_f32 v60, v60, v62
    v_add_f32 v64, v64, v66
    v_add_f32 v61, v61, v63
    v_add_f32 v65, v65, v67
    v_add_f32 v60, v60, v64
    v_add_f32 v61, v61, v65
    s_mov_b64 exec, 0xffff
    buffer_atomic_add_f32 v60, v9, s[20:23], s44 offen offset:0
    buffer_atomic_add_f32 v61, v9, s[20:23], s44 offen offset:64
    s_mov_b64 exec, -1
L_noz_7:
    s_branch L_end_4
L_helper_5:
    s_waitcnt lgkmcnt(0)
    s_cmp_ge_u32 s2, 224
    s_cbranch_scc1 L_hidle_8
    s_lshr_b32 s40, s2, 1
    s_and_b32 s41, s2, 1
    s_cmp_ge_u32 s40, 56
    s_cselect_b32 s82, s84, s82
    s_cselect_b32 s83, s85, s83
    s_cselect_b32 s42, 56, 0
    s_sub_u32 s42, s40, s42
    s_mov_b32 s8, s82
    s_mov_b32 s9, s83
    s_mov_b32 s10, 0x700000
    s_mov_b32 s11, 0x00020000
    s_add_u32 s12, s4, 0x830000
    s_addc_u32 s13, s5, 0
    s_mov_b32 s14, 0x7000
    s_mov_b32 s15, 0x00020000
    v_and_b32 v3, 7, v0
    v_lshrrev_b32 v4, 3, v0
    s_mov_b32 s43, 7168
    v_mul_lo_u32 v4, v4, s43
    v_lshl_add_u32 v4, v3, 4, v4
    s_lshl_b32 s43, s42, 7
    s_mul_i32 s44, s41, 3670016
    s_add_u32 s43, s43, s44
    v_mov_b32 v8, 0
    v_mov_b32 v9, 0
    v_mov_b32 v10, 0
    v_mov_b32 v11, 0
    v_mov_b32 v12, 0
    v_mov_b32 v13, 0
    v_mov_b32 v14, 0
    v_mov_b32 v15, 0
    buffer_load_dwordx4 v[16:19], v4, s[8:11], s43 offen
    s_add_u32 s43, s43, 57344
    buffer_load_dwordx4 v[20:23], v4, s[8:11], s43 offen
    s_add_u32 s43, s43, 57344
    buffer_load_dwordx4 v[24:27], v4, s[8:11], s43 offen
    s_add_u32 s43, s43, 57344
    buffer_load_dwordx4 v[28:31], v4, s[8:11], s43 offen
    s_add_u32 s43, s43, 57344
    buffer_load_dwordx4 v[32:35], v4, s[8:11], s43 offen
    s_add_u32 s43, s43, 57344
    buffer_load_dwordx4 v[36:39], v4, s[8:11], s43 offen
    s_add_u32 s43, s43, 57344
    buffer_load_dwordx4 v[40:43], v4, s[8:11], s43 offen
    s_add_u32 s43, s43, 57344
    buffer_load_dwordx4 v[44:47], v4, s[8:11], s43 offen
    s_add_u32 s43, s43, 57344
    s_barrier
    buffer_load_dwordx4 v[48:51], v4, s[8:11], s43 offen
    s_add_u32 s43, s43, 57344
    buffer_load_dwordx4 v[52:55], v4, s[8:11], s43 offen
    s_add_u32 s43, s43, 57344
    buffer_load_dwordx4 v[56:59], v4, s[8:11], s43 offen
    s_add_u32 s43, s43, 57344
    buffer_load_dwordx4 v[60:63], v4, s[8:11], s43 offen
    s_add_u32 s43, s43, 57344
    buffer_load_dwordx4 v[64:67], v4, s[8:11], s43 offen
    s_add_u32 s43, s43, 57344
    buffer_load_dwordx4 v[68:71], v4, s[8:11], s43 offen
    s_add_u32 s43, s43, 57344
    buffer_load_dwordx4 v[72:75], v4, s[8:11], s43 offen
    s_add_u32 s43, s43, 57344
    buffer_load_dwordx4 v[76:79], v4, s[8:11], s43 offen
    s_add_u32 s43, s43, 57344
    s_barrier
    s_waitcnt vmcnt(8)
    v_lshlrev_b32 v5, 16, v16
    v_and_b32 v6, 0xffff0000, v16
    v_add_f32 v8, v8, v5
    v_add_f32 v9, v9, v6
    v_lshlrev_b32 v5, 16, v17
    v_and_b32 v6, 0xffff0000, v17
    v_add_f32 v10, v10, v5
    v_add_f32 v11, v11, v6
    v_lshlrev_b32 v5, 16, v18
    v_and_b32 v6, 0xffff0000, v18
    v_add_f32 v12, v12, v5
    v_add_f32 v13, v13, v6
    v_lshlrev_b32 v5, 16, v19
    v_and_b32 v6, 0xffff0000, v19
    v_add_f32 v14, v14, v5
    v_add_f32 v15, v15, v6
    v_lshlrev_b32 v5, 16, v20
    v_and_b32 v6, 0xffff0000, v20
    v_add_f32 v8, v8, v5
    v_add_f32 v9, v9, v6
    v_lshlrev_b32 v5, 16, v21
    v_and_b32 v6, 0xffff0000, v21
    v_add_f32 v10, v10, v5
    v_add_f32 v11, v11, v6
    v_lshlrev_b32 v5, 16, v22
    v_and_b32 v6, 0xffff0000, v22
    v_add_f32 v12, v12, v5
    v_add_f32 v13, v13, v6
    v_lshlrev_b32 v5, 16, v23
    v_and_b32 v6, 0xffff0000, v23
    v_add_f32 v14, v14, v5
    v_add_f32 v15, v15, v6
    v_lshlrev_b32 v5, 16, v24
    v_and_b32 v6, 0xffff0000, v24
    v_add_f32 v8, v8, v5
    v_add_f32 v9, v9, v6
    v_lshlrev_b32 v5, 16, v25
    v_and_b32 v6, 0xffff0000, v25
    v_add_f32 v10, v10, v5
    v_add_f32 v11, v11, v6
    v_lshlrev_b32 v5, 16, v26
    v_and_b32 v6, 0xffff0000, v26
    v_add_f32 v12, v12, v5
    v_add_f32 v13, v13, v6
    v_lshlrev_b32 v5, 16, v27
    v_and_b32 v6, 0xffff0000, v27
    v_add_f32 v14, v14, v5
    v_add_f32 v15, v15, v6
    v_lshlrev_b32 v5, 16, v28
    v_and_b32 v6, 0xffff0000, v28
    v_add_f32 v8, v8, v5
    v_add_f32 v9, v9, v6
    v_lshlrev_b32 v5, 16, v29
    v_and_b32 v6, 0xffff0000, v29
    v_add_f32 v10, v10, v5
    v_add_f32 v11, v11, v6
    v_lshlrev_b32 v5, 16, v30
    v_and_b32 v6, 0xffff0000, v30
    v_add_f32 v12, v12, v5
    v_add_f32 v13, v13, v6
    v_lshlrev_b32 v5, 16, v31
    v_and_b32 v6, 0xffff0000, v31
    v_add_f32 v14, v14, v5
    v_add_f32 v15, v15, v6
    v_lshlrev_b32 v5, 16, v32
    v_and_b32 v6, 0xffff0000, v32
    v_add_f32 v8, v8, v5
    v_add_f32 v9, v9, v6
    v_lshlrev_b32 v5, 16, v33
    v_and_b32 v6, 0xffff0000, v33
    v_add_f32 v10, v10, v5
    v_add_f32 v11, v11, v6
    v_lshlrev_b32 v5, 16, v34
    v_and_b32 v6, 0xffff0000, v34
    v_add_f32 v12, v12, v5
    v_add_f32 v13, v13, v6
    v_lshlrev_b32 v5, 16, v35
    v_and_b32 v6, 0xffff0000, v35
    v_add_f32 v14, v14, v5
    v_add_f32 v15, v15, v6
    v_lshlrev_b32 v5, 16, v36
    v_and_b32 v6, 0xffff0000, v36
    v_add_f32 v8, v8, v5
    v_add_f32 v9, v9, v6
    v_lshlrev_b32 v5, 16, v37
    v_and_b32 v6, 0xffff0000, v37
    v_add_f32 v10, v10, v5
    v_add_f32 v11, v11, v6
    v_lshlrev_b32 v5, 16, v38
    v_and_b32 v6, 0xffff0000, v38
    v_add_f32 v12, v12, v5
    v_add_f32 v13, v13, v6
    v_lshlrev_b32 v5, 16, v39
    v_and_b32 v6, 0xffff0000, v39
    v_add_f32 v14, v14, v5
    v_add_f32 v15, v15, v6
    v_lshlrev_b32 v5, 16, v40
    v_and_b32 v6, 0xffff0000, v40
    v_add_f32 v8, v8, v5
    v_add_f32 v9, v9, v6
    v_lshlrev_b32 v5, 16, v41
    v_and_b32 v6, 0xffff0000, v41
    v_add_f32 v10, v10, v5
    v_add_f32 v11, v11, v6
    v_lshlrev_b32 v5, 16, v42
    v_and_b32 v6, 0xffff0000, v42
    v_add_f32 v12, v12, v5
    v_add_f32 v13, v13, v6
    v_lshlrev_b32 v5, 16, v43
    v_and_b32 v6, 0xffff0000, v43
    v_add_f32 v14, v14, v5
    v_add_f32 v15, v15, v6
    v_lshlrev_b32 v5, 16, v44
    v_and_b32 v6, 0xffff0000, v44
    v_add_f32 v8, v8, v5
    v_add_f32 v9, v9, v6
    v_lshlrev_b32 v5, 16, v45
    v_and_b32 v6, 0xffff0000, v45
    v_add_f32 v10, v10, v5
    v_add_f32 v11, v11, v6
    v_lshlrev_b32 v5, 16, v46
    v_and_b32 v6, 0xffff0000, v46
    v_add_f32 v12, v12, v5
    v_add_f32 v13, v13, v6
    v_lshlrev_b32 v5, 16, v47
    v_and_b32 v6, 0xffff0000, v47
    v_add_f32 v14, v14, v5
    v_add_f32 v15, v15, v6
    s_barrier
    buffer_load_dwordx4 v[16:19], v4, s[8:11], s43 offen
    s_add_u32 s43, s43, 57344
    buffer_load_dwordx4 v[20:23], v4, s[8:11], s43 offen
    s_add_u32 s43, s43, 57344
    buffer_load_dwordx4 v[24:27], v4, s[8:11], s43 offen
    s_add_u32 s43, s43, 57344
    buffer_load_dwordx4 v[28:31], v4, s[8:11], s43 offen
    s_add_u32 s43, s43, 57344
    buffer_load_dwordx4 v[32:35], v4, s[8:11], s43 offen
    s_add_u32 s43, s43, 57344
    buffer_load_dwordx4 v[36:39], v4, s[8:11], s43 offen
    s_add_u32 s43, s43, 57344
    buffer_load_dwordx4 v[40:43], v4, s[8:11], s43 offen
    s_add_u32 s43, s43, 57344
    buffer_load_dwordx4 v[44:47], v4, s[8:11], s43 offen
    s_add_u32 s43, s43, 57344
    s_barrier
    s_waitcnt vmcnt(8)
    v_lshlrev_b32 v5, 16, v48
    v_and_b32 v6, 0xffff0000, v48
    v_add_f32 v8, v8, v5
    v_add_f32 v9, v9, v6
    v_lshlrev_b32 v5, 16, v49
    v_and_b32 v6, 0xffff0000, v49
    v_add_f32 v10, v10, v5
    v_add_f32 v11, v11, v6
    v_lshlrev_b32 v5, 16, v50
    v_and_b32 v6, 0xffff0000, v50
    v_add_f32 v12, v12, v5
    v_add_f32 v13, v13, v6
    v_lshlrev_b32 v5, 16, v51
    v_and_b32 v6, 0xffff0000, v51
    v_add_f32 v14, v14, v5
    v_add_f32 v15, v15, v6
    v_lshlrev_b32 v5, 16, v52
    v_and_b32 v6, 0xffff0000, v52
    v_add_f32 v8, v8, v5
    v_add_f32 v9, v9, v6
    v_lshlrev_b32 v5, 16, v53
    v_and_b32 v6, 0xffff0000, v53
    v_add_f32 v10, v10, v5
    v_add_f32 v11, v11, v6
    v_lshlrev_b32 v5, 16, v54
    v_and_b32 v6, 0xffff0000, v54
    v_add_f32 v12, v12, v5
    v_add_f32 v13, v13, v6
    v_lshlrev_b32 v5, 16, v55
    v_and_b32 v6, 0xffff0000, v55
    v_add_f32 v14, v14, v5
    v_add_f32 v15, v15, v6
    v_lshlrev_b32 v5, 16, v56
    v_and_b32 v6, 0xffff0000, v56
    v_add_f32 v8, v8, v5
    v_add_f32 v9, v9, v6
    v_lshlrev_b32 v5, 16, v57
    v_and_b32 v6, 0xffff0000, v57
    v_add_f32 v10, v10, v5
    v_add_f32 v11, v11, v6
    v_lshlrev_b32 v5, 16, v58
    v_and_b32 v6, 0xffff0000, v58
    v_add_f32 v12, v12, v5
    v_add_f32 v13, v13, v6
    v_lshlrev_b32 v5, 16, v59
    v_and_b32 v6, 0xffff0000, v59
    v_add_f32 v14, v14, v5
    v_add_f32 v15, v15, v6
    v_lshlrev_b32 v5, 16, v60
    v_and_b32 v6, 0xffff0000, v60
    v_add_f32 v8, v8, v5
    v_add_f32 v9, v9, v6
    v_lshlrev_b32 v5, 16, v61
    v_and_b32 v6, 0xffff0000, v61
    v_add_f32 v10, v10, v5
    v_add_f32 v11, v11, v6
    v_lshlrev_b32 v5, 16, v62
    v_and_b32 v6, 0xffff0000, v62
    v_add_f32 v12, v12, v5
    v_add_f32 v13, v13, v6
    v_lshlrev_b32 v5, 16, v63
    v_and_b32 v6, 0xffff0000, v63
    v_add_f32 v14, v14, v5
    v_add_f32 v15, v15, v6
    v_lshlrev_b32 v5, 16, v64
    v_and_b32 v6, 0xffff0000, v64
    v_add_f32 v8, v8, v5
    v_add_f32 v9, v9, v6
    v_lshlrev_b32 v5, 16, v65
    v_and_b32 v6, 0xffff0000, v65
    v_add_f32 v10, v10, v5
    v_add_f32 v11, v11, v6
    v_lshlrev_b32 v5, 16, v66
    v_and_b32 v6, 0xffff0000, v66
    v_add_f32 v12, v12, v5
    v_add_f32 v13, v13, v6
    v_lshlrev_b32 v5, 16, v67
    v_and_b32 v6, 0xffff0000, v67
    v_add_f32 v14, v14, v5
    v_add_f32 v15, v15, v6
    v_lshlrev_b32 v5, 16, v68
    v_and_b32 v6, 0xffff0000, v68
    v_add_f32 v8, v8, v5
    v_add_f32 v9, v9, v6
    v_lshlrev_b32 v5, 16, v69
    v_and_b32 v6, 0xffff0000, v69
    v_add_f32 v10, v10, v5
    v_add_f32 v11, v11, v6
    v_lshlrev_b32 v5, 16, v70
    v_and_b32 v6, 0xffff0000, v70
    v_add_f32 v12, v12, v5
    v_add_f32 v13, v13, v6
    v_lshlrev_b32 v5, 16, v71
    v_and_b32 v6, 0xffff0000, v71
    v_add_f32 v14, v14, v5
    v_add_f32 v15, v15, v6
    v_lshlrev_b32 v5, 16, v72
    v_and_b32 v6, 0xffff0000, v72
    v_add_f32 v8, v8, v5
    v_add_f32 v9, v9, v6
    v_lshlrev_b32 v5, 16, v73
    v_and_b32 v6, 0xffff0000, v73
    v_add_f32 v10, v10, v5
    v_add_f32 v11, v11, v6
    v_lshlrev_b32 v5, 16, v74
    v_and_b32 v6, 0xffff0000, v74
    v_add_f32 v12, v12, v5
    v_add_f32 v13, v13, v6
    v_lshlrev_b32 v5, 16, v75
    v_and_b32 v6, 0xffff0000, v75
    v_add_f32 v14, v14, v5
    v_add_f32 v15, v15, v6
    v_lshlrev_b32 v5, 16, v76
    v_and_b32 v6, 0xffff0000, v76
    v_add_f32 v8, v8, v5
    v_add_f32 v9, v9, v6
    v_lshlrev_b32 v5, 16, v77
    v_and_b32 v6, 0xffff0000, v77
    v_add_f32 v10, v10, v5
    v_add_f32 v11, v11, v6
    v_lshlrev_b32 v5, 16, v78
    v_and_b32 v6, 0xffff0000, v78
    v_add_f32 v12, v12, v5
    v_add_f32 v13, v13, v6
    v_lshlrev_b32 v5, 16, v79
    v_and_b32 v6, 0xffff0000, v79
    v_add_f32 v14, v14, v5
    v_add_f32 v15, v15, v6
    s_barrier
    buffer_load_dwordx4 v[48:51], v4, s[8:11], s43 offen
    s_add_u32 s43, s43, 57344
    buffer_load_dwordx4 v[52:55], v4, s[8:11], s43 offen
    s_add_u32 s43, s43, 57344
    buffer_load_dwordx4 v[56:59], v4, s[8:11], s43 offen
    s_add_u32 s43, s43, 57344
    buffer_load_dwordx4 v[60:63], v4, s[8:11], s43 offen
    s_add_u32 s43, s43, 57344
    buffer_load_dwordx4 v[64:67], v4, s[8:11], s43 offen
    s_add_u32 s43, s43, 57344
    buffer_load_dwordx4 v[68:71], v4, s[8:11], s43 offen
    s_add_u32 s43, s43, 57344
    buffer_load_dwordx4 v[72:75], v4, s[8:11], s43 offen
    s_add_u32 s43, s43, 57344
    buffer_load_dwordx4 v[76:79], v4, s[8:11], s43 offen
    s_add_u32 s43, s43, 57344
    s_barrier
    s_waitcnt vmcnt(8)
    v_lshlrev_b32 v5, 16, v16
    v_and_b32 v6, 0xffff0000, v16
    v_add_f32 v8, v8, v5
    v_add_f32 v9, v9, v6
    v_lshlrev_b32 v5, 16, v17
    v_and_b32 v6, 0xffff0000, v17
    v_add_f32 v10, v10, v5
    v_add_f32 v11, v11, v6
    v_lshlrev_b32 v5, 16, v18
    v_and_b32 v6, 0xffff0000, v18
    v_add_f32 v12, v12, v5
    v_add_f32 v13, v13, v6
    v_lshlrev_b32 v5, 16, v19
    v_and_b32 v6, 0xffff0000, v19
    v_add_f32 v14, v14, v5
    v_add_f32 v15, v15, v6
    v_lshlrev_b32 v5, 16, v20
    v_and_b32 v6, 0xffff0000, v20
    v_add_f32 v8, v8, v5
    v_add_f32 v9, v9, v6
    v_lshlrev_b32 v5, 16, v21
    v_and_b32 v6, 0xffff0000, v21
    v_add_f32 v10, v10, v5
    v_add_f32 v11, v11, v6
    v_lshlrev_b32 v5, 16, v22
    v_and_b32 v6, 0xffff0000, v22
    v_add_f32 v12, v12, v5
    v_add_f32 v13, v13, v6
    v_lshlrev_b32 v5, 16, v23
    v_and_b32 v6, 0xffff0000, v23
    v_add_f32 v14, v14, v5
    v_add_f32 v15, v15, v6
    v_lshlrev_b32 v5, 16, v24
    v_and_b32 v6, 0xffff0000, v24
    v_add_f32 v8, v8, v5
    v_add_f32 v9, v9, v6
    v_lshlrev_b32 v5, 16, v25
    v_and_b32 v6, 0xffff0000, v25
    v_add_f32 v10, v10, v5
    v_add_f32 v11, v11, v6
    v_lshlrev_b32 v5, 16, v26
    v_and_b32 v6, 0xffff0000, v26
    v_add_f32 v12, v12, v5
    v_add_f32 v13, v13, v6
    v_lshlrev_b32 v5, 16, v27
    v_and_b32 v6, 0xffff0000, v27
    v_add_f32 v14, v14, v5
    v_add_f32 v15, v15, v6
    v_lshlrev_b32 v5, 16, v28
    v_and_b32 v6, 0xffff0000, v28
    v_add_f32 v8, v8, v5
    v_add_f32 v9, v9, v6
    v_lshlrev_b32 v5, 16, v29
    v_and_b32 v6, 0xffff0000, v29
    v_add_f32 v10, v10, v5
    v_add_f32 v11, v11, v6
    v_lshlrev_b32 v5, 16, v30
    v_and_b32 v6, 0xffff0000, v30
    v_add_f32 v12, v12, v5
    v_add_f32 v13, v13, v6
    v_lshlrev_b32 v5, 16, v31
    v_and_b32 v6, 0xffff0000, v31
    v_add_f32 v14, v14, v5
    v_add_f32 v15, v15, v6
    v_lshlrev_b32 v5, 16, v32
    v_and_b32 v6, 0xffff0000, v32
    v_add_f32 v8, v8, v5
    v_add_f32 v9, v9, v6
    v_lshlrev_b32 v5, 16, v33
    v_and_b32 v6, 0xffff0000, v33
    v_add_f32 v10, v10, v5
    v_add_f32 v11, v11, v6
    v_lshlrev_b32 v5, 16, v34
    v_and_b32 v6, 0xffff0000, v34
    v_add_f32 v12, v12, v5
    v_add_f32 v13, v13, v6
    v_lshlrev_b32 v5, 16, v35
    v_and_b32 v6, 0xffff0000, v35
    v_add_f32 v14, v14, v5
    v_add_f32 v15, v15, v6
    v_lshlrev_b32 v5, 16, v36
    v_and_b32 v6, 0xffff0000, v36
    v_add_f32 v8, v8, v5
    v_add_f32 v9, v9, v6
    v_lshlrev_b32 v5, 16, v37
    v_and_b32 v6, 0xffff0000, v37
    v_add_f32 v10, v10, v5
    v_add_f32 v11, v11, v6
    v_lshlrev_b32 v5, 16, v38
    v_and_b32 v6, 0xffff0000, v38
    v_add_f32 v12, v12, v5
    v_add_f32 v13, v13, v6
    v_lshlrev_b32 v5, 16, v39
    v_and_b32 v6, 0xffff0000, v39
    v_add_f32 v14, v14, v5
    v_add_f32 v15, v15, v6
    v_lshlrev_b32 v5, 16, v40
    v_and_b32 v6, 0xffff0000, v40
    v_add_f32 v8, v8, v5
    v_add_f32 v9, v9, v6
    v_lshlrev_b32 v5, 16, v41
    v_and_b32 v6, 0xffff0000, v41
    v_add_f32 v10, v10, v5
    v_add_f32 v11, v11, v6
    v_lshlrev_b32 v5, 16, v42
    v_and_b32 v6, 0xffff0000, v42
    v_add_f32 v12, v12, v5
    v_add_f32 v13, v13, v6
    v_lshlrev_b32 v5, 16, v43
    v_and_b32 v6, 0xffff0000, v43
    v_add_f32 v14, v14, v5
    v_add_f32 v15, v15, v6
    v_lshlrev_b32 v5, 16, v44
    v_and_b32 v6, 0xffff0000, v44
    v_add_f32 v8, v8, v5
    v_add_f32 v9, v9, v6
    v_lshlrev_b32 v5, 16, v45
    v_and_b32 v6, 0xffff0000, v45
    v_add_f32 v10, v10, v5
    v_add_f32 v11, v11, v6
    v_lshlrev_b32 v5, 16, v46
    v_and_b32 v6, 0xffff0000, v46
    v_add_f32 v12, v12, v5
    v_add_f32 v13, v13, v6
    v_lshlrev_b32 v5, 16, v47
    v_and_b32 v6, 0xffff0000, v47
    v_add_f32 v14, v14, v5
    v_add_f32 v15, v15, v6
    s_barrier
    buffer_load_dwordx4 v[16:19], v4, s[8:11], s43 offen
    s_add_u32 s43, s43, 57344
    buffer_load_dwordx4 v[20:23], v4, s[8:11], s43 offen
    s_add_u32 s43, s43, 57344
    buffer_load_dwordx4 v[24:27], v4, s[8:11], s43 offen
    s_add_u32 s43, s43, 57344
    buffer_load_dwordx4 v[28:31], v4, s[8:11], s43 offen
    s_add_u32 s43, s43, 57344
    buffer_load_dwordx4 v[32:35], v4, s[8:11], s43 offen
    s_add_u32 s43, s43, 57344
    buffer_load_dwordx4 v[36:39], v4, s[8:11], s43 offen
    s_add_u32 s43, s43, 57344
    buffer_load_dwordx4 v[40:43], v4, s[8:11], s43 offen
    s_add_u32 s43, s43, 57344
    buffer_load_dwordx4 v[44:47], v4, s[8:11], s43 offen
    s_add_u32 s43, s43, 57344
    s_barrier
    s_waitcnt vmcnt(8)
    v_lshlrev_b32 v5, 16, v48
    v_and_b32 v6, 0xffff0000, v48
    v_add_f32 v8, v8, v5
    v_add_f32 v9, v9, v6
    v_lshlrev_b32 v5, 16, v49
    v_and_b32 v6, 0xffff0000, v49
    v_add_f32 v10, v10, v5
    v_add_f32 v11, v11, v6
    v_lshlrev_b32 v5, 16, v50
    v_and_b32 v6, 0xffff0000, v50
    v_add_f32 v12, v12, v5
    v_add_f32 v13, v13, v6
    v_lshlrev_b32 v5, 16, v51
    v_and_b32 v6, 0xffff0000, v51
    v_add_f32 v14, v14, v5
    v_add_f32 v15, v15, v6
    v_lshlrev_b32 v5, 16, v52
    v_and_b32 v6, 0xffff0000, v52
    v_add_f32 v8, v8, v5
    v_add_f32 v9, v9, v6
    v_lshlrev_b32 v5, 16, v53
    v_and_b32 v6, 0xffff0000, v53
    v_add_f32 v10, v10, v5
    v_add_f32 v11, v11, v6
    v_lshlrev_b32 v5, 16, v54
    v_and_b32 v6, 0xffff0000, v54
    v_add_f32 v12, v12, v5
    v_add_f32 v13, v13, v6
    v_lshlrev_b32 v5, 16, v55
    v_and_b32 v6, 0xffff0000, v55
    v_add_f32 v14, v14, v5
    v_add_f32 v15, v15, v6
    v_lshlrev_b32 v5, 16, v56
    v_and_b32 v6, 0xffff0000, v56
    v_add_f32 v8, v8, v5
    v_add_f32 v9, v9, v6
    v_lshlrev_b32 v5, 16, v57
    v_and_b32 v6, 0xffff0000, v57
    v_add_f32 v10, v10, v5
    v_add_f32 v11, v11, v6
    v_lshlrev_b32 v5, 16, v58
    v_and_b32 v6, 0xffff0000, v58
    v_add_f32 v12, v12, v5
    v_add_f32 v13, v13, v6
    v_lshlrev_b32 v5, 16, v59
    v_and_b32 v6, 0xffff0000, v59
    v_add_f32 v14, v14, v5
    v_add_f32 v15, v15, v6
    v_lshlrev_b32 v5, 16, v60
    v_and_b32 v6, 0xffff0000, v60
    v_add_f32 v8, v8, v5
    v_add_f32 v9, v9, v6
    v_lshlrev_b32 v5, 16, v61
    v_and_b32 v6, 0xffff0000, v61
    v_add_f32 v10, v10, v5
    v_add_f32 v11, v11, v6
    v_lshlrev_b32 v5, 16, v62
    v_and_b32 v6, 0xffff0000, v62
    v_add_f32 v12, v12, v5
    v_add_f32 v13, v13, v6
    v_lshlrev_b32 v5, 16, v63
    v_and_b32 v6, 0xffff0000, v63
    v_add_f32 v14, v14, v5
    v_add_f32 v15, v15, v6
    v_lshlrev_b32 v5, 16, v64
    v_and_b32 v6, 0xffff0000, v64
    v_add_f32 v8, v8, v5
    v_add_f32 v9, v9, v6
    v_lshlrev_b32 v5, 16, v65
    v_and_b32 v6, 0xffff0000, v65
    v_add_f32 v10, v10, v5
    v_add_f32 v11, v11, v6
    v_lshlrev_b32 v5, 16, v66
    v_and_b32 v6, 0xffff0000, v66
    v_add_f32 v12, v12, v5
    v_add_f32 v13, v13, v6
    v_lshlrev_b32 v5, 16, v67
    v_and_b32 v6, 0xffff0000, v67
    v_add_f32 v14, v14, v5
    v_add_f32 v15, v15, v6
    v_lshlrev_b32 v5, 16, v68
    v_and_b32 v6, 0xffff0000, v68
    v_add_f32 v8, v8, v5
    v_add_f32 v9, v9, v6
    v_lshlrev_b32 v5, 16, v69
    v_and_b32 v6, 0xffff0000, v69
    v_add_f32 v10, v10, v5
    v_add_f32 v11, v11, v6
    v_lshlrev_b32 v5, 16, v70
    v_and_b32 v6, 0xffff0000, v70
    v_add_f32 v12, v12, v5
    v_add_f32 v13, v13, v6
    v_lshlrev_b32 v5, 16, v71
    v_and_b32 v6, 0xffff0000, v71
    v_add_f32 v14, v14, v5
    v_add_f32 v15, v15, v6
    v_lshlrev_b32 v5, 16, v72
    v_and_b32 v6, 0xffff0000, v72
    v_add_f32 v8, v8, v5
    v_add_f32 v9, v9, v6
    v_lshlrev_b32 v5, 16, v73
    v_and_b32 v6, 0xffff0000, v73
    v_add_f32 v10, v10, v5
    v_add_f32 v11, v11, v6
    v_lshlrev_b32 v5, 16, v74
    v_and_b32 v6, 0xffff0000, v74
    v_add_f32 v12, v12, v5
    v_add_f32 v13, v13, v6
    v_lshlrev_b32 v5, 16, v75
    v_and_b32 v6, 0xffff0000, v75
    v_add_f32 v14, v14, v5
    v_add_f32 v15, v15, v6
    v_lshlrev_b32 v5, 16, v76
    v_and_b32 v6, 0xffff0000, v76
    v_add_f32 v8, v8, v5
    v_add_f32 v9, v9, v6
    v_lshlrev_b32 v5, 16, v77
    v_and_b32 v6, 0xffff0000, v77
    v_add_f32 v10, v10, v5
    v_add_f32 v11, v11, v6
    v_lshlrev_b32 v5, 16, v78
    v_and_b32 v6, 0xffff0000, v78
    v_add_f32 v12, v12, v5
    v_add_f32 v13, v13, v6
    v_lshlrev_b32 v5, 16, v79
    v_and_b32 v6, 0xffff0000, v79
    v_add_f32 v14, v14, v5
    v_add_f32 v15, v15, v6
    s_barrier
    buffer_load_dwordx4 v[48:51], v4, s[8:11], s43 offen
    s_add_u32 s43, s43, 57344
    buffer_load_dwordx4 v[52:55], v4, s[8:11], s43 offen
    s_add_u32 s43, s43, 57344
    buffer_load_dwordx4 v[56:59], v4, s[8:11], s43 offen
    s_add_u32 s43, s43, 57344
    buffer_load_dwordx4 v[60:63], v4, s[8:11], s43 offen
    s_add_u32 s43, s43, 57344
    buffer_load_dwordx4 v[64:67], v4, s[8:11], s43 offen
    s_add_u32 s43, s43, 57344
    buffer_load_dwordx4 v[68:71], v4, s[8:11], s43 offen
    s_add_u32 s43, s43, 57344
    buffer_load_dwordx4 v[72:75], v4, s[8:11], s43 offen
    s_add_u32 s43, s43, 57344
    buffer_load_dwordx4 v[76:79], v4, s[8:11], s43 offen
    s_add_u32 s43, s43, 57344
    s_barrier
    s_waitcnt vmcnt(8)
    v_lshlrev_b32 v5, 16, v16
    v_and_b32 v6, 0xffff0000, v16
    v_add_f32 v8, v8, v5
    v_add_f32 v9, v9, v6
    v_lshlrev_b32 v5, 16, v17
    v_and_b32 v6, 0xffff0000, v17
    v_add_f32 v10, v10, v5
    v_add_f32 v11, v11, v6
    v_lshlrev_b32 v5, 16, v18
    v_and_b32 v6, 0xffff0000, v18
    v_add_f32 v12, v12, v5
    v_add_f32 v13, v13, v6
    v_lshlrev_b32 v5, 16, v19
    v_and_b32 v6, 0xffff0000, v19
    v_add_f32 v14, v14, v5
    v_add_f32 v15, v15, v6
    v_lshlrev_b32 v5, 16, v20
    v_and_b32 v6, 0xffff0000, v20
    v_add_f32 v8, v8, v5
    v_add_f32 v9, v9, v6
    v_lshlrev_b32 v5, 16, v21
    v_and_b32 v6, 0xffff0000, v21
    v_add_f32 v10, v10, v5
    v_add_f32 v11, v11, v6
    v_lshlrev_b32 v5, 16, v22
    v_and_b32 v6, 0xffff0000, v22
    v_add_f32 v12, v12, v5
    v_add_f32 v13, v13, v6
    v_lshlrev_b32 v5, 16, v23
    v_and_b32 v6, 0xffff0000, v23
    v_add_f32 v14, v14, v5
    v_add_f32 v15, v15, v6
    v_lshlrev_b32 v5, 16, v24
    v_and_b32 v6, 0xffff0000, v24
    v_add_f32 v8, v8, v5
    v_add_f32 v9, v9, v6
    v_lshlrev_b32 v5, 16, v25
    v_and_b32 v6, 0xffff0000, v25
    v_add_f32 v10, v10, v5
    v_add_f32 v11, v11, v6
    v_lshlrev_b32 v5, 16, v26
    v_and_b32 v6, 0xffff0000, v26
    v_add_f32 v12, v12, v5
    v_add_f32 v13, v13, v6
    v_lshlrev_b32 v5, 16, v27
    v_and_b32 v6, 0xffff0000, v27
    v_add_f32 v14, v14, v5
    v_add_f32 v15, v15, v6
    v_lshlrev_b32 v5, 16, v28
    v_and_b32 v6, 0xffff0000, v28
    v_add_f32 v8, v8, v5
    v_add_f32 v9, v9, v6
    v_lshlrev_b32 v5, 16, v29
    v_and_b32 v6, 0xffff0000, v29
    v_add_f32 v10, v10, v5
    v_add_f32 v11, v11, v6
    v_lshlrev_b32 v5, 16, v30
    v_and_b32 v6, 0xffff0000, v30
    v_add_f32 v12, v12, v5
    v_add_f32 v13, v13, v6
    v_lshlrev_b32 v5, 16, v31
    v_and_b32 v6, 0xffff0000, v31
    v_add_f32 v14, v14, v5
    v_add_f32 v15, v15, v6
    v_lshlrev_b32 v5, 16, v32
    v_and_b32 v6, 0xffff0000, v32
    v_add_f32 v8, v8, v5
    v_add_f32 v9, v9, v6
    v_lshlrev_b32 v5, 16, v33
    v_and_b32 v6, 0xffff0000, v33
    v_add_f32 v10, v10, v5
    v_add_f32 v11, v11, v6
    v_lshlrev_b32 v5, 16, v34
    v_and_b32 v6, 0xffff0000, v34
    v_add_f32 v12, v12, v5
    v_add_f32 v13, v13, v6
    v_lshlrev_b32 v5, 16, v35
    v_and_b32 v6, 0xffff0000, v35
    v_add_f32 v14, v14, v5
    v_add_f32 v15, v15, v6
    v_lshlrev_b32 v5, 16, v36
    v_and_b32 v6, 0xffff0000, v36
    v_add_f32 v8, v8, v5
    v_add_f32 v9, v9, v6
    v_lshlrev_b32 v5, 16, v37
    v_and_b32 v6, 0xffff0000, v37
    v_add_f32 v10, v10, v5
    v_add_f32 v11, v11, v6
    v_lshlrev_b32 v5, 16, v38
    v_and_b32 v6, 0xffff0000, v38
    v_add_f32 v12, v12, v5
    v_add_f32 v13, v13, v6
    v_lshlrev_b32 v5, 16, v39
    v_and_b32 v6, 0xffff0000, v39
    v_add_f32 v14, v14, v5
    v_add_f32 v15, v15, v6
    v_lshlrev_b32 v5, 16, v40
    v_and_b32 v6, 0xffff0000, v40
    v_add_f32 v8, v8, v5
    v_add_f32 v9, v9, v6
    v_lshlrev_b32 v5, 16, v41
    v_and_b32 v6, 0xffff0000, v41
    v_add_f32 v10, v10, v5
    v_add_f32 v11, v11, v6
    v_lshlrev_b32 v5, 16, v42
    v_and_b32 v6, 0xffff0000, v42
    v_add_f32 v12, v12, v5
    v_add_f32 v13, v13, v6
    v_lshlrev_b32 v5, 16, v43
    v_and_b32 v6, 0xffff0000, v43
    v_add_f32 v14, v14, v5
    v_add_f32 v15, v15, v6
    v_lshlrev_b32 v5, 16, v44
    v_and_b32 v6, 0xffff0000, v44
    v_add_f32 v8, v8, v5
    v_add_f32 v9, v9, v6
    v_lshlrev_b32 v5, 16, v45
    v_and_b32 v6, 0xffff0000, v45
    v_add_f32 v10, v10, v5
    v_add_f32 v11, v11, v6
    v_lshlrev_b32 v5, 16, v46
    v_and_b32 v6, 0xffff0000, v46
    v_add_f32 v12, v12, v5
    v_add_f32 v13, v13, v6
    v_lshlrev_b32 v5, 16, v47
    v_and_b32 v6, 0xffff0000, v47
    v_add_f32 v14, v14, v5
    v_add_f32 v15, v15, v6
    s_barrier
    buffer_load_dwordx4 v[16:19], v4, s[8:11], s43 offen
    s_add_u32 s43, s43, 57344
    buffer_load_dwordx4 v[20:23], v4, s[8:11], s43 offen
    s_add_u32 s43, s43, 57344
    buffer_load_dwordx4 v[24:27], v4, s[8:11], s43 offen
    s_add_u32 s43, s43, 57344
    buffer_load_dwordx4 v[28:31], v4, s[8:11], s43 offen
    s_add_u32 s43, s43, 57344
    buffer_load_dwordx4 v[32:35], v4, s[8:11], s43 offen
    s_add_u32 s43, s43, 57344
    buffer_load_dwordx4 v[36:39], v4, s[8:11], s43 offen
    s_add_u32 s43, s43, 57344
    buffer_load_dwordx4 v[40:43], v4, s[8:11], s43 offen
    s_add_u32 s43, s43, 57344
    buffer_load_dwordx4 v[44:47], v4, s[8:11], s43 offen
    s_add_u32 s43, s43, 57344
    s_barrier
    s_waitcnt vmcnt(8)
    v_lshlrev_b32 v5, 16, v48
    v_and_b32 v6, 0xffff0000, v48
    v_add_f32 v8, v8, v5
    v_add_f32 v9, v9, v6
    v_lshlrev_b32 v5, 16, v49
    v_and_b32 v6, 0xffff0000, v49
    v_add_f32 v10, v10, v5
    v_add_f32 v11, v11, v6
    v_lshlrev_b32 v5, 16, v50
    v_and_b32 v6, 0xffff0000, v50
    v_add_f32 v12, v12, v5
    v_add_f32 v13, v13, v6
    v_lshlrev_b32 v5, 16, v51
    v_and_b32 v6, 0xffff0000, v51
    v_add_f32 v14, v14, v5
    v_add_f32 v15, v15, v6
    v_lshlrev_b32 v5, 16, v52
    v_and_b32 v6, 0xffff0000, v52
    v_add_f32 v8, v8, v5
    v_add_f32 v9, v9, v6
    v_lshlrev_b32 v5, 16, v53
    v_and_b32 v6, 0xffff0000, v53
    v_add_f32 v10, v10, v5
    v_add_f32 v11, v11, v6
    v_lshlrev_b32 v5, 16, v54
    v_and_b32 v6, 0xffff0000, v54
    v_add_f32 v12, v12, v5
    v_add_f32 v13, v13, v6
    v_lshlrev_b32 v5, 16, v55
    v_and_b32 v6, 0xffff0000, v55
    v_add_f32 v14, v14, v5
    v_add_f32 v15, v15, v6
    v_lshlrev_b32 v5, 16, v56
    v_and_b32 v6, 0xffff0000, v56
    v_add_f32 v8, v8, v5
    v_add_f32 v9, v9, v6
    v_lshlrev_b32 v5, 16, v57
    v_and_b32 v6, 0xffff0000, v57
    v_add_f32 v10, v10, v5
    v_add_f32 v11, v11, v6
    v_lshlrev_b32 v5, 16, v58
    v_and_b32 v6, 0xffff0000, v58
    v_add_f32 v12, v12, v5
    v_add_f32 v13, v13, v6
    v_lshlrev_b32 v5, 16, v59
    v_and_b32 v6, 0xffff0000, v59
    v_add_f32 v14, v14, v5
    v_add_f32 v15, v15, v6
    v_lshlrev_b32 v5, 16, v60
    v_and_b32 v6, 0xffff0000, v60
    v_add_f32 v8, v8, v5
    v_add_f32 v9, v9, v6
    v_lshlrev_b32 v5, 16, v61
    v_and_b32 v6, 0xffff0000, v61
    v_add_f32 v10, v10, v5
    v_add_f32 v11, v11, v6
    v_lshlrev_b32 v5, 16, v62
    v_and_b32 v6, 0xffff0000, v62
    v_add_f32 v12, v12, v5
    v_add_f32 v13, v13, v6
    v_lshlrev_b32 v5, 16, v63
    v_and_b32 v6, 0xffff0000, v63
    v_add_f32 v14, v14, v5
    v_add_f32 v15, v15, v6
    v_lshlrev_b32 v5, 16, v64
    v_and_b32 v6, 0xffff0000, v64
    v_add_f32 v8, v8, v5
    v_add_f32 v9, v9, v6
    v_lshlrev_b32 v5, 16, v65
    v_and_b32 v6, 0xffff0000, v65
    v_add_f32 v10, v10, v5
    v_add_f32 v11, v11, v6
    v_lshlrev_b32 v5, 16, v66
    v_and_b32 v6, 0xffff0000, v66
    v_add_f32 v12, v12, v5
    v_add_f32 v13, v13, v6
    v_lshlrev_b32 v5, 16, v67
    v_and_b32 v6, 0xffff0000, v67
    v_add_f32 v14, v14, v5
    v_add_f32 v15, v15, v6
    v_lshlrev_b32 v5, 16, v68
    v_and_b32 v6, 0xffff0000, v68
    v_add_f32 v8, v8, v5
    v_add_f32 v9, v9, v6
    v_lshlrev_b32 v5, 16, v69
    v_and_b32 v6, 0xffff0000, v69
    v_add_f32 v10, v10, v5
    v_add_f32 v11, v11, v6
    v_lshlrev_b32 v5, 16, v70
    v_and_b32 v6, 0xffff0000, v70
    v_add_f32 v12, v12, v5
    v_add_f32 v13, v13, v6
    v_lshlrev_b32 v5, 16, v71
    v_and_b32 v6, 0xffff0000, v71
    v_add_f32 v14, v14, v5
    v_add_f32 v15, v15, v6
    v_lshlrev_b32 v5, 16, v72
    v_and_b32 v6, 0xffff0000, v72
    v_add_f32 v8, v8, v5
    v_add_f32 v9, v9, v6
    v_lshlrev_b32 v5, 16, v73
    v_and_b32 v6, 0xffff0000, v73
    v_add_f32 v10, v10, v5
    v_add_f32 v11, v11, v6
    v_lshlrev_b32 v5, 16, v74
    v_and_b32 v6, 0xffff0000, v74
    v_add_f32 v12, v12, v5
    v_add_f32 v13, v13, v6
    v_lshlrev_b32 v5, 16, v75
    v_and_b32 v6, 0xffff0000, v75
    v_add_f32 v14, v14, v5
    v_add_f32 v15, v15, v6
    v_lshlrev_b32 v5, 16, v76
    v_and_b32 v6, 0xffff0000, v76
    v_add_f32 v8, v8, v5
    v_add_f32 v9, v9, v6
    v_lshlrev_b32 v5, 16, v77
    v_and_b32 v6, 0xffff0000, v77
    v_add_f32 v10, v10, v5
    v_add_f32 v11, v11, v6
    v_lshlrev_b32 v5, 16, v78
    v_and_b32 v6, 0xffff0000, v78
    v_add_f32 v12, v12, v5
    v_add_f32 v13, v13, v6
    v_lshlrev_b32 v5, 16, v79
    v_and_b32 v6, 0xffff0000, v79
    v_add_f32 v14, v14, v5
    v_add_f32 v15, v15, v6
    s_barrier
    buffer_load_dwordx4 v[48:51], v4, s[8:11], s43 offen
    s_add_u32 s43, s43, 57344
    buffer_load_dwordx4 v[52:55], v4, s[8:11], s43 offen
    s_add_u32 s43, s43, 57344
    buffer_load_dwordx4 v[56:59], v4, s[8:11], s43 offen
    s_add_u32 s43, s43, 57344
    buffer_load_dwordx4 v[60:63], v4, s[8:11], s43 offen
    s_add_u32 s43, s43, 57344
    buffer_load_dwordx4 v[64:67], v4, s[8:11], s43 offen
    s_add_u32 s43, s43, 57344
    buffer_load_dwordx4 v[68:71], v4, s[8:11], s43 offen
    s_add_u32 s43, s43, 57344
    buffer_load_dwordx4 v[72:75], v4, s[8:11], s43 offen
    s_add_u32 s43, s43, 57344
    buffer_load_dwordx4 v[76:79], v4, s[8:11], s43 offen
    s_add_u32 s43, s43, 57344
    s_barrier
    s_waitcnt vmcnt(8)
    v_lshlrev_b32 v5, 16, v16
    v_and_b32 v6, 0xffff0000, v16
    v_add_f32 v8, v8, v5
    v_add_f32 v9, v9, v6
    v_lshlrev_b32 v5, 16, v17
    v_and_b32 v6, 0xffff0000, v17
    v_add_f32 v10, v10, v5
    v_add_f32 v11, v11, v6
    v_lshlrev_b32 v5, 16, v18
    v_and_b32 v6, 0xffff0000, v18
    v_add_f32 v12, v12, v5
    v_add_f32 v13, v13, v6
    v_lshlrev_b32 v5, 16, v19
    v_and_b32 v6, 0xffff0000, v19
    v_add_f32 v14, v14, v5
    v_add_f32 v15, v15, v6
    v_lshlrev_b32 v5, 16, v20
    v_and_b32 v6, 0xffff0000, v20
    v_add_f32 v8, v8, v5
    v_add_f32 v9, v9, v6
    v_lshlrev_b32 v5, 16, v21
    v_and_b32 v6, 0xffff0000, v21
    v_add_f32 v10, v10, v5
    v_add_f32 v11, v11, v6
    v_lshlrev_b32 v5, 16, v22
    v_and_b32 v6, 0xffff0000, v22
    v_add_f32 v12, v12, v5
    v_add_f32 v13, v13, v6
    v_lshlrev_b32 v5, 16, v23
    v_and_b32 v6, 0xffff0000, v23
    v_add_f32 v14, v14, v5
    v_add_f32 v15, v15, v6
    v_lshlrev_b32 v5, 16, v24
    v_and_b32 v6, 0xffff0000, v24
    v_add_f32 v8, v8, v5
    v_add_f32 v9, v9, v6
    v_lshlrev_b32 v5, 16, v25
    v_and_b32 v6, 0xffff0000, v25
    v_add_f32 v10, v10, v5
    v_add_f32 v11, v11, v6
    v_lshlrev_b32 v5, 16, v26
    v_and_b32 v6, 0xffff0000, v26
    v_add_f32 v12, v12, v5
    v_add_f32 v13, v13, v6
    v_lshlrev_b32 v5, 16, v27
    v_and_b32 v6, 0xffff0000, v27
    v_add_f32 v14, v14, v5
    v_add_f32 v15, v15, v6
    v_lshlrev_b32 v5, 16, v28
    v_and_b32 v6, 0xffff0000, v28
    v_add_f32 v8, v8, v5
    v_add_f32 v9, v9, v6
    v_lshlrev_b32 v5, 16, v29
    v_and_b32 v6, 0xffff0000, v29
    v_add_f32 v10, v10, v5
    v_add_f32 v11, v11, v6
    v_lshlrev_b32 v5, 16, v30
    v_and_b32 v6, 0xffff0000, v30
    v_add_f32 v12, v12, v5
    v_add_f32 v13, v13, v6
    v_lshlrev_b32 v5, 16, v31
    v_and_b32 v6, 0xffff0000, v31
    v_add_f32 v14, v14, v5
    v_add_f32 v15, v15, v6
    v_lshlrev_b32 v5, 16, v32
    v_and_b32 v6, 0xffff0000, v32
    v_add_f32 v8, v8, v5
    v_add_f32 v9, v9, v6
    v_lshlrev_b32 v5, 16, v33
    v_and_b32 v6, 0xffff0000, v33
    v_add_f32 v10, v10, v5
    v_add_f32 v11, v11, v6
    v_lshlrev_b32 v5, 16, v34
    v_and_b32 v6, 0xffff0000, v34
    v_add_f32 v12, v12, v5
    v_add_f32 v13, v13, v6
    v_lshlrev_b32 v5, 16, v35
    v_and_b32 v6, 0xffff0000, v35
    v_add_f32 v14, v14, v5
    v_add_f32 v15, v15, v6
    v_lshlrev_b32 v5, 16, v36
    v_and_b32 v6, 0xffff0000, v36
    v_add_f32 v8, v8, v5
    v_add_f32 v9, v9, v6
    v_lshlrev_b32 v5, 16, v37
    v_and_b32 v6, 0xffff0000, v37
    v_add_f32 v10, v10, v5
    v_add_f32 v11, v11, v6
    v_lshlrev_b32 v5, 16, v38
    v_and_b32 v6, 0xffff0000, v38
    v_add_f32 v12, v12, v5
    v_add_f32 v13, v13, v6
    v_lshlrev_b32 v5, 16, v39
    v_and_b32 v6, 0xffff0000, v39
    v_add_f32 v14, v14, v5
    v_add_f32 v15, v15, v6
    v_lshlrev_b32 v5, 16, v40
    v_and_b32 v6, 0xffff0000, v40
    v_add_f32 v8, v8, v5
    v_add_f32 v9, v9, v6
    v_lshlrev_b32 v5, 16, v41
    v_and_b32 v6, 0xffff0000, v41
    v_add_f32 v10, v10, v5
    v_add_f32 v11, v11, v6
    v_lshlrev_b32 v5, 16, v42
    v_and_b32 v6, 0xffff0000, v42
    v_add_f32 v12, v12, v5
    v_add_f32 v13, v13, v6
    v_lshlrev_b32 v5, 16, v43
    v_and_b32 v6, 0xffff0000, v43
    v_add_f32 v14, v14, v5
    v_add_f32 v15, v15, v6
    v_lshlrev_b32 v5, 16, v44
    v_and_b32 v6, 0xffff0000, v44
    v_add_f32 v8, v8, v5
    v_add_f32 v9, v9, v6
    v_lshlrev_b32 v5, 16, v45
    v_and_b32 v6, 0xffff0000, v45
    v_add_f32 v10, v10, v5
    v_add_f32 v11, v11, v6
    v_lshlrev_b32 v5, 16, v46
    v_and_b32 v6, 0xffff0000, v46
    v_add_f32 v12, v12, v5
    v_add_f32 v13, v13, v6
    v_lshlrev_b32 v5, 16, v47
    v_and_b32 v6, 0xffff0000, v47
    v_add_f32 v14, v14, v5
    v_add_f32 v15, v15, v6
    s_barrier
    s_barrier
    s_waitcnt vmcnt(0)
    v_lshlrev_b32 v5, 16, v48
    v_and_b32 v6, 0xffff0000, v48
    v_add_f32 v8, v8, v5
    v_add_f32 v9, v9, v6
    v_lshlrev_b32 v5, 16, v49
    v_and_b32 v6, 0xffff0000, v49
    v_add_f32 v10, v10, v5
    v_add_f32 v11, v11, v6
    v_lshlrev_b32 v5, 16, v50
    v_and_b32 v6, 0xffff0000, v50
    v_add_f32 v12, v12, v5
    v_add_f32 v13, v13, v6
    v_lshlrev_b32 v5, 16, v51
    v_and_b32 v6, 0xffff0000, v51
    v_add_f32 v14, v14, v5
    v_add_f32 v15, v15, v6
    v_lshlrev_b32 v5, 16, v52
    v_and_b32 v6, 0xffff0000, v52
    v_add_f32 v8, v8, v5
    v_add_f32 v9, v9, v6
    v_lshlrev_b32 v5, 16, v53
    v_and_b32 v6, 0xffff0000, v53
    v_add_f32 v10, v10, v5
    v_add_f32 v11, v11, v6
    v_lshlrev_b32 v5, 16, v54
    v_and_b32 v6, 0xffff0000, v54
    v_add_f32 v12, v12, v5
    v_add_f32 v13, v13, v6
    v_lshlrev_b32 v5, 16, v55
    v_and_b32 v6, 0xffff0000, v55
    v_add_f32 v14, v14, v5
    v_add_f32 v15, v15, v6
    v_lshlrev_b32 v5, 16, v56
    v_and_b32 v6, 0xffff0000, v56
    v_add_f32 v8, v8, v5
    v_add_f32 v9, v9, v6
    v_lshlrev_b32 v5, 16, v57
    v_and_b32 v6, 0xffff0000, v57
    v_add_f32 v10, v10, v5
    v_add_f32 v11, v11, v6
    v_lshlrev_b32 v5, 16, v58
    v_and_b32 v6, 0xffff0000, v58
    v_add_f32 v12, v12, v5
    v_add_f32 v13, v13, v6
    v_lshlrev_b32 v5, 16, v59
    v_and_b32 v6, 0xffff0000, v59
    v_add_f32 v14, v14, v5
    v_add_f32 v15, v15, v6
    v_lshlrev_b32 v5, 16, v60
    v_and_b32 v6, 0xffff0000, v60
    v_add_f32 v8, v8, v5
    v_add_f32 v9, v9, v6
    v_lshlrev_b32 v5, 16, v61
    v_and_b32 v6, 0xffff0000, v61
    v_add_f32 v10, v10, v5
    v_add_f32 v11, v11, v6
    v_lshlrev_b32 v5, 16, v62
    v_and_b32 v6, 0xffff0000, v62
    v_add_f32 v12, v12, v5
    v_add_f32 v13, v13, v6
    v_lshlrev_b32 v5, 16, v63
    v_and_b32 v6, 0xffff0000, v63
    v_add_f32 v14, v14, v5
    v_add_f32 v15, v15, v6
    v_lshlrev_b32 v5, 16, v64
    v_and_b32 v6, 0xffff0000, v64
    v_add_f32 v8, v8, v5
    v_add_f32 v9, v9, v6
    v_lshlrev_b32 v5, 16, v65
    v_and_b32 v6, 0xffff0000, v65
    v_add_f32 v10, v10, v5
    v_add_f32 v11, v11, v6
    v_lshlrev_b32 v5, 16, v66
    v_and_b32 v6, 0xffff0000, v66
    v_add_f32 v12, v12, v5
    v_add_f32 v13, v13, v6
    v_lshlrev_b32 v5, 16, v67
    v_and_b32 v6, 0xffff0000, v67
    v_add_f32 v14, v14, v5
    v_add_f32 v15, v15, v6
    v_lshlrev_b32 v5, 16, v68
    v_and_b32 v6, 0xffff0000, v68
    v_add_f32 v8, v8, v5
    v_add_f32 v9, v9, v6
    v_lshlrev_b32 v5, 16, v69
    v_and_b32 v6, 0xffff0000, v69
    v_add_f32 v10, v10, v5
    v_add_f32 v11, v11, v6
    v_lshlrev_b32 v5, 16, v70
    v_and_b32 v6, 0xffff0000, v70
    v_add_f32 v12, v12, v5
    v_add_f32 v13, v13, v6
    v_lshlrev_b32 v5, 16, v71
    v_and_b32 v6, 0xffff0000, v71
    v_add_f32 v14, v14, v5
    v_add_f32 v15, v15, v6
    v_lshlrev_b32 v5, 16, v72
    v_and_b32 v6, 0xffff0000, v72
    v_add_f32 v8, v8, v5
    v_add_f32 v9, v9, v6
    v_lshlrev_b32 v5, 16, v73
    v_and_b32 v6, 0xffff0000, v73
    v_add_f32 v10, v10, v5
    v_add_f32 v11, v11, v6
    v_lshlrev_b32 v5, 16, v74
    v_and_b32 v6, 0xffff0000, v74
    v_add_f32 v12, v12, v5
    v_add_f32 v13, v13, v6
    v_lshlrev_b32 v5, 16, v75
    v_and_b32 v6, 0xffff0000, v75
    v_add_f32 v14, v14, v5
    v_add_f32 v15, v15, v6
    v_lshlrev_b32 v5, 16, v76
    v_and_b32 v6, 0xffff0000, v76
    v_add_f32 v8, v8, v5
    v_add_f32 v9, v9, v6
    v_lshlrev_b32 v5, 16, v77
    v_and_b32 v6, 0xffff0000, v77
    v_add_f32 v10, v10, v5
    v_add_f32 v11, v11, v6
    v_lshlrev_b32 v5, 16, v78
    v_and_b32 v6, 0xffff0000, v78
    v_add_f32 v12, v12, v5
    v_add_f32 v13, v13, v6
    v_lshlrev_b32 v5, 16, v79
    v_and_b32 v6, 0xffff0000, v79
    v_add_f32 v14, v14, v5
    v_add_f32 v15, v15, v6
    s_nop 1
    v_add_f32_dpp v5, v8, v8 row_ror:8 row_mask:0xf bank_mask:0xf
    v_mov_b32 v8, v5
    v_mov_b32 v5, v8
    s_nop 1
    v_permlane16_swap_b32 v8, v5
    s_nop 1
    v_add_f32 v8, v8, v5
    v_mov_b32 v5, v8
    s_nop 1
    v_permlane32_swap_b32 v8, v5
    s_nop 1
    v_add_f32 v8, v8, v5
    s_nop 1
    v_add_f32_dpp v5, v9, v9 row_ror:8 row_mask:0xf bank_mask:0xf
    v_mov_b32 v9, v5
    v_mov_b32 v5, v9
    s_nop 1
    v_permlane16_swap_b32 v9, v5
    s_nop 1
    v_add_f32 v9, v9, v5
    v_mov_b32 v5, v9
    s_nop 1
    v_permlane32_swap_b32 v9, v5
    s_nop 1
    v_add_f32 v9, v9, v5
    s_nop 1
    v_add_f32_dpp v5, v10, v10 row_ror:8 row_mask:0xf bank_mask:0xf
    v_mov_b32 v10, v5
    v_mov_b32 v5, v10
    s_nop 1
    v_permlane16_swap_b32 v10, v5
    s_nop 1
    v_add_f32 v10, v10, v5
    v_mov_b32 v5, v10
    s_nop 1
    v_permlane32_swap_b32 v10, v5
    s_nop 1
    v_add_f32 v10, v10, v5
    s_nop 1
    v_add_f32_dpp v5, v11, v11 row_ror:8 row_mask:0xf bank_mask:0xf
    v_mov_b32 v11, v5
    v_mov_b32 v5, v11
    s_nop 1
    v_permlane16_swap_b32 v11, v5
    s_nop 1
    v_add_f32 v11, v11, v5
    v_mov_b32 v5, v11
    s_nop 1
    v_permlane32_swap_b32 v11, v5
    s_nop 1
    v_add_f32 v11, v11, v5
    s_nop 1
    v_add_f32_dpp v5, v12, v12 row_ror:8 row_mask:0xf bank_mask:0xf
    v_mov_b32 v12, v5
    v_mov_b32 v5, v12
    s_nop 1
    v_permlane16_swap_b32 v12, v5
    s_nop 1
    v_add_f32 v12, v12, v5
    v_mov_b32 v5, v12
    s_nop 1
    v_permlane32_swap_b32 v12, v5
    s_nop 1
    v_add_f32 v12, v12, v5
    s_nop 1
    v_add_f32_dpp v5, v13, v13 row_ror:8 row_mask:0xf bank_mask:0xf
    v_mov_b32 v13, v5
    v_mov_b32 v5, v13
    s_nop 1
    v_permlane16_swap_b32 v13, v5
    s_nop 1
    v_add_f32 v13, v13, v5
    v_mov_b32 v5, v13
    s_nop 1
    v_permlane32_swap_b32 v13, v5
    s_nop 1
    v_add_f32 v13, v13, v5
    s_nop 1
    v_add_f32_dpp v5, v14, v14 row_ror:8 row_mask:0xf bank_mask:0xf
    v_mov_b32 v14, v5
    v_mov_b32 v5, v14
    s_nop 1
    v_permlane16_swap_b32 v14, v5
    s_nop 1
    v_add_f32 v14, v14, v5
    v_mov_b32 v5, v14
    s_nop 1
    v_permlane32_swap_b32 v14, v5
    s_nop 1
    v_add_f32 v14, v14, v5
    s_nop 1
    v_add_f32_dpp v5, v15, v15 row_ror:8 row_mask:0xf bank_mask:0xf
    v_mov_b32 v15, v5
    v_mov_b32 v5, v15
    s_nop 1
    v_permlane16_swap_b32 v15, v5
    s_nop 1
    v_add_f32 v15, v15, v5
    v_mov_b32 v5, v15
    s_nop 1
    v_permlane32_swap_b32 v15, v5
    s_nop 1
    v_add_f32 v15, v15, v5
    v_lshlrev_b32 v3, 5, v0
    s_lshl_b32 s43, s40, 8
    s_mov_b64 exec, 0xff
    buffer_atomic_add_f32 v8, v3, s[12:15], s43 offen offset:0
    buffer_atomic_add_f32 v9, v3, s[12:15], s43 offen offset:4
    buffer_atomic_add_f32 v10, v3, s[12:15], s43 offen offset:8
    buffer_atomic_add_f32 v11, v3, s[12:15], s43 offen offset:12
    buffer_atomic_add_f32 v12, v3, s[12:15], s43 offen offset:16
    buffer_atomic_add_f32 v13, v3, s[12:15], s43 offen offset:20
    buffer_atomic_add_f32 v14, v3, s[12:15], s43 offen offset:24
    buffer_atomic_add_f32 v15, v3, s[12:15], s43 offen offset:28
    s_mov_b64 exec, -1
    s_barrier
    s_barrier
    s_endpgm
L_hidle_8:
    s_barrier
    s_barrier
    s_barrier
    s_barrier
    s_barrier
    s_barrier
    s_barrier
    s_barrier
    s_barrier
    s_barrier
    s_barrier
    s_barrier
    s_barrier
    s_barrier
    s_barrier
    s_barrier
    s_barrier
    s_barrier
L_end_4:
    s_endpgm
.globl gemm2_kernel
.p2align 8
.type gemm2_kernel,@function
gemm2_kernel:
    s_cmp_ge_u32 s2, 256
    s_cbranch_scc1 L_end_9
    s_load_dwordx2 s[4:5], s[0:1], 72
    s_load_dwordx2 s[6:7], s[0:1], 16
    s_load_dwordx2 s[62:63], s[0:1], 0
    v_lshrrev_b32 v1, 6, v0
    v_and_b32 v0, 63, v0
    s_nop 0
    v_readfirstlane_b32 s28, v1
    v_and_b32 v1, 15, v0
    v_lshrrev_b32 v2, 4, v0
    s_and_b32 s42, s2, 7
    s_lshr_b32 s43, s2, 3
    s_and_b32 s29, s42, 3
    s_lshl_b32 s29, s29, 3
    s_and_b32 s44, s43, 7
    s_add_u32 s29, s29, s44
    s_lshr_b32 s30, s42, 2
    s_lshl_b32 s30, s30, 2
    s_lshr_b32 s44, s43, 3
    s_add_u32 s30, s30, s44
    s_and_b32 s38, s28, 1
    s_bfe_u32 s39, s28, 0x10001
    s_lshr_b32 s40, s28, 2
    v_lshrrev_b32 v12, 3, v0
    v_and_b32 v13, 7, v0
    v_xor_b32 v13, v13, v12
    s_mul_i32 s44, s30, 256
    s_mov_b32 s45, 2048
    v_lshrrev_b32 v12, 3, v0
    v_bfe_u32 v14, v0, 4, 1
    v_lshlrev_b32 v14, 1, v14
    v_and_b32 v13, 7, v0
    v_xor_b32 v13, v13, v14
    v_mul_lo_u32 v12, v12, s45
    s_mov_b32 s42, 0
    s_mul_i32 s43, s38, 16384
    s_add_u32 s42, s42, s43
    s_mul_i32 s43, s39, 32768
    s_add_u32 s42, s42, s43
    s_mul_i32 s43, s40, 128
    s_add_u32 s42, s42, s43
    s_add_u32 s42, s42, s44
    v_add_u32 v12, s42, v12
    s_lshl_b32 s43, s38, 2
    s_xor_b32 s43, s43, 0
    v_xor_b32 v14, s43, v13
    v_lshl_add_u32 v14, v14, 4, v12
    v_add_u32 v3, 0x0, v14
    s_mov_b32 s37, 131072
    s_mul_i32 s42, s38, 2048
    s_add_u32 s37, s37, s42
    s_mul_i32 s42, s39, 4096
    s_add_u32 s37, s37, s42
    s_mul_i32 s42, s40, 1024
    s_add_u32 s37, s37, s42
    s_waitcnt lgkmcnt(0)
    s_add_u32 s8, s4, 0x900000
    s_addc_u32 s9, s5, 0
    s_mov_b32 s10, 0x400000
    s_mov_b32 s11, 0x00020000
    s_mov_b32 s12, s6
    s_mov_b32 s13, s7
    s_mov_b32 s14, 0x200000
    s_mov_b32 s15, 0x00020000
    s_mov_b32 s32, 0
    s_mov_b32 s33, 0
    s_mov_b32 s35, 0
    s_mov_b32 s96, 0
    s_add_u32 s42, s96, s37
    s_add_u32 m0, s42, 0
    s_nop 0
    buffer_load_dwordx4 v3, s[12:15], s33 offen lds
    s_add_u32 s33, s33, 65536
    s_add_u32 s96, s96, 8192
    s_add_u32 s42, s96, s37
    s_add_u32 m0, s42, 0
    s_nop 0
    buffer_load_dwordx4 v3, s[12:15], s33 offen lds
    s_add_u32 s33, s33, 65536
    s_add_u32 s96, s96, 8192
    s_add_u32 s42, s96, s37
    s_add_u32 m0, s42, 0
    s_nop 0
    buffer_load_dwordx4 v3, s[12:15], s33 offen lds
    s_add_u32 s33, s33, 65536
    s_add_u32 s96, s96, 8192
    s_add_u32 s16, s4, 0xd00000
    s_addc_u32 s17, s5, 0
    s_mov_b32 s18, 0x400000
    s_mov_b32 s19, 0x00020000
    s_mov_b32 s20, s62
    s_mov_b32 s21, s63
    s_mov_b32 s22, 0x400000
    s_mov_b32 s23, 0x00020000
    s_add_u32 s24, s4, 0x840000
    s_addc_u32 s25, s5, 0
    s_mov_b32 s26, 0x20000
    s_mov_b32 s27, 0x00020000
    v_and_b32 v12, 7, v0
    v_xor_b32 v12, v12, v2
    v_lshlrev_b32 v12, 4, v12
    v_lshl_add_u32 v12, v1, 7, v12
    s_mov_b32 s42, 0
    s_mul_i32 s43, s38, 4096
    s_add_u32 s42, s42, s43
    v_add_u32 v4, s42, v12
    v_xor_b32 v5, 64, v4
    s_mov_b32 s42, 2048
    v_mul_lo_u32 v12, v2, s42
    v_lshrrev_b32 v14, 2, v1
    v_lshl_add_u32 v12, v14, 7, v12
    v_bfe_u32 v13, v0, 3, 2
    s_mov_b32 s42, 0
    s_mul_i32 s43, s39, 1
    s_add_u32 s42, s42, s43
    v_xor_b32 v13, s42, v13
    v_lshl_add_u32 v12, v13, 5, v12
    v_bfe_u32 v14, v0, 1, 1
    v_lshl_add_u32 v12, v14, 4, v12
    v_and_b32 v14, 1, v0
    v_lshl_add_u32 v12, v14, 3, v12
    s_mov_b32 s42, 131072
    s_mul_i32 s43, s40, 1024
    s_add_u32 s42, s42, s43
    v_add_u32 v6, s42, v12
    v_xor_b32 v7, 64, v6
    s_add_u32 s44, s4, 0x400000
    s_addc_u32 s45, s5, 0
    s_mov_b32 s46, 0x400000
    s_mov_b32 s47, 0x00020000
    s_add_u32 s52, s4, 0x800000
    s_addc_u32 s53, s5, 0
    s_mov_b32 s54, 0x21000
    s_mov_b32 s55, 0x00020000
    v_lshrrev_b32 v31, 3, v0
    v_and_b32 v30, 7, v0
    v_xor_b32 v30, v30, v31
    v_lshlrev_b32 v30, 4, v30
    v_lshl_add_u32 v30, v31, 11, v30
    s_lshl_b32 s58, s29, 17
    s_lshl_b32 s59, s28, 8
    s_add_u32 s58, s58, s59
    s_lshl_b32 s57, s28, 14
    v_lshlrev_b32 v28, 4, v0
    v_lshlrev_b32 v29, 5, v2
    s_lshl_b32 s56, s28, 14
    s_lshl_b32 s65, s28, 9
    s_add_u32 s65, s65, 131072
    s_add_u32 s59, s58, 0
    s_add_u32 m0, s57, 0
    s_nop 0
    buffer_load_dwordx4 v30, s[44:47], s59 offen lds
    s_add_u32 s59, s58, 16384
    s_add_u32 m0, s57, 1024
    s_nop 0
    buffer_load_dwordx4 v30, s[44:47], s59 offen lds
    s_add_u32 s59, s58, 32768
    s_add_u32 m0, s57, 2048
    s_nop 0
    buffer_load_dwordx4 v30, s[44:47], s59 offen lds
    s_add_u32 s59, s58, 49152
    s_add_u32 m0, s57, 3072
    s_nop 0
    buffer_load_dwordx4 v30, s[44:47], s59 offen lds
    s_add_u32 s59, s58, 65536
    s_add_u32 m0, s57, 4096
    s_nop 0
    buffer_load_dwordx4 v30, s[44:47], s59 offen lds
    s_add_u32 s59, s58, 81920
    s_add_u32 m0, s57, 5120
    s_nop 0
    buffer_load_dwordx4 v30, s[44:47], s59 offen lds
    s_add_u32 s59, s58, 98304
    s_add_u32 m0, s57, 6144
    s_nop 0
    buffer_load_dwordx4 v30, s[44:47], s59 offen lds
    s_add_u32 s59, s58, 114688
    s_add_u32 m0, s57, 7168
    s_nop 0
    buffer_load_dwordx4 v30, s[44:47], s59 offen lds
    s_add_u32 s66, s56, 0
    buffer_load_dwordx4 v[40:43], v28, s[52:55], s66 offen offset:0
    buffer_load_dwordx4 v[44:47], v28, s[52:55], s66 offen offset:1024
    buffer_load_dwordx4 v[48:51], v28, s[52:55], s66 offen offset:2048
    buffer_load_dwordx4 v[52:55], v28, s[52:55], s66 offen offset:3072
    buffer_load_dwordx4 v[56:59], v29, s[52:55], s65 offen offset:0
    buffer_load_dwordx4 v[60:63], v29, s[52:55], s65 offen offset:16
    s_add_u32 s66, s56, 4096
    buffer_load_dwordx4 v[64:67], v28, s[52:55], s66 offen offset:0
    buffer_load_dwordx4 v[68:71], v28, s[52:55], s66 offen offset:1024
    buffer_load_dwordx4 v[72:75], v28, s[52:55], s66 offen offset:2048
    buffer_load_dwordx4 v[76:79], v28, s[52:55], s66 offen offset:3072
    buffer_load_dwordx4 v[80:83], v29, s[52:55], s65 offen offset:128
    buffer_load_dwordx4 v[84:87], v29, s[52:55], s65 offen offset:144
    s_add_u32 s59, s58, 128
    s_add_u32 m0, s57, 8192
    s_nop 0
    buffer_load_dwordx4 v30, s[44:47], s59 offen lds
    s_add_u32 s59, s58, 16512
    s_add_u32 m0, s57, 9216
    s_nop 0
    buffer_load_dwordx4 v30, s[44:47], s59 offen lds
    s_add_u32 s59, s58, 32896
    s_add_u32 m0, s57, 10240
    s_nop 0
    buffer_load_dwordx4 v30, s[44:47], s59 offen lds
    s_add_u32 s59, s58, 49280
    s_add_u32 m0, s57, 11264
    s_nop 0
    buffer_load_dwordx4 v30, s[44:47], s59 offen lds
    s_add_u32 s59, s58, 65664
    s_add_u32 m0, s57, 12288
    s_nop 0
    buffer_load_dwordx4 v30, s[44:47], s59 offen lds
    s_add_u32 s59, s58, 82048
    s_add_u32 m0, s57, 13312
    s_nop 0
    buffer_load_dwordx4 v30, s[44:47], s59 offen lds
    s_add_u32 s59, s58, 98432
    s_add_u32 m0, s57, 14336
    s_nop 0
    buffer_load_dwordx4 v30, s[44:47], s59 offen lds
    s_add_u32 s59, s58, 114816
    s_add_u32 m0, s57, 15360
    s_nop 0
    buffer_load_dwordx4 v30, s[44:47], s59 offen lds
    s_add_u32 s66, s56, 8192
    buffer_load_dwordx4 v[88:91], v28, s[52:55], s66 offen offset:0
    buffer_load_dwordx4 v[92:95], v28, s[52:55], s66 offen offset:1024
    buffer_load_dwordx4 v[96:99], v28, s[52:55], s66 offen offset:2048
    buffer_load_dwordx4 v[100:103], v28, s[52:55], s66 offen offset:3072
    buffer_load_dwordx4 v[104:107], v29, s[52:55], s65 offen offset:256
    buffer_load_dwordx4 v[108:111], v29, s[52:55], s65 offen offset:272
    s_add_u32 s66, s56, 12288
    buffer_load_dwordx4 v[112:115], v28, s[52:55], s66 offen offset:0
    buffer_load_dwordx4 v[116:119], v28, s[52:55], s66 offen offset:1024
    buffer_load_dwordx4 v[120:123], v28, s[52:55], s66 offen offset:2048
    buffer_load_dwordx4 v[124:127], v28, s[52:55], s66 offen offset:3072
    buffer_load_dwordx4 v[128:131], v29, s[52:55], s65 offen offset:384
    buffer_load_dwordx4 v[132:135], v29, s[52:55], s65 offen offset:400
    v_and_b32 v31, 7, v0
    v_xor_b32 v36, v31, v2
    v_lshlrev_b32 v36, 4, v36
    v_lshl_add_u32 v36, v1, 7, v36
    v_add_u32 v36, s57, v36
    v_xor_b32 v37, 64, v36
    v_lshrrev_b32 v32, 1, v2
    v_xor_b32 v32, v32, v31
    v_lshlrev_b32 v32, 4, v32
    v_lshl_add_u32 v32, v1, 7, v32
    v_and_b32 v33, 1, v2
    v_lshl_add_u32 v32, v33, 3, v32
    v_add_u32 v32, s57, v32
    v_xor_b32 v33, 32, v32
    v_xor_b32 v34, 64, v32
    v_xor_b32 v35, 96, v32
    s_waitcnt vmcnt(26)
    ds_read_b128 a[0:3], v36 offset:0
    ds_read_b128 a[4:7], v36 offset:2048
    ds_read_b128 a[8:11], v36 offset:4096
    ds_read_b128 a[12:15], v36 offset:6144
    v_cvt_pk_bf16_f32 v40, v40, v41
    v_cvt_pk_bf16_f32 v41, v42, v43
    v_cvt_pk_bf16_f32 v42, v44, v45
    v_cvt_pk_bf16_f32 v43, v46, v47
    v_cvt_pk_bf16_f32 v44, v48, v49
    v_cvt_pk_bf16_f32 v45, v50, v51
    v_cvt_pk_bf16_f32 v46, v52, v53
    v_cvt_pk_bf16_f32 v47, v54, v55
    v_cvt_pk_bf16_f32 v48, v56, v57
    v_cvt_pk_bf16_f32 v49, v58, v59
    v_cvt_pk_bf16_f32 v50, v60, v61
    v_cvt_pk_bf16_f32 v51, v62, v63
    s_waitcnt lgkmcnt(0)
    v_mfma_f32_16x16x32_bf16 v[136:139], v[40:43], a[0:3], 0
    v_mfma_f32_16x16x32_bf16 v[140:143], v[44:47], a[0:3], 0
    v_mfma_f32_16x16x32_bf16 v[144:147], v[48:51], a[0:3], 0
    v_mfma_f32_16x16x32_bf16 v[148:151], v[40:43], a[4:7], 0
    v_mfma_f32_16x16x32_bf16 v[152:155], v[44:47], a[4:7], 0
    v_mfma_f32_16x16x32_bf16 v[156:159], v[48:51], a[4:7], 0
    s_nop 7
    v_cvt_pk_bf16_f32 v144, v144, v144
    v_cvt_pk_bf16_f32 v156, v156, v156
    v_lshlrev_b32 v144, 16, v144
    v_lshlrev_b32 v156, 16, v156
    v_add_f32 v144, 0x358637bd, v144
    v_add_f32 v156, 0x358637bd, v156
    v_rcp_f32 v144, v144
    v_rcp_f32 v156, v156
    s_nop 0
    v_mul_f32 v136, v136, v144
    v_mul_f32 v137, v137, v144
    v_mul_f32 v138, v138, v144
    v_mul_f32 v139, v139, v144
    v_mul_f32 v140, v140, v144
    v_mul_f32 v141, v141, v144
    v_mul_f32 v142, v142, v144
    v_mul_f32 v143, v143, v144
    v_cvt_pk_bf16_f32 v52, v136, v137
    v_cvt_pk_bf16_f32 v53, v138, v139
    v_cvt_pk_bf16_f32 v54, v140, v141
    v_cvt_pk_bf16_f32 v55, v142, v143
    ds_write_b64 v32, v[52:53] offset:0
    ds_write_b64 v33, v[54:55] offset:0
    v_mul_f32 v148, v148, v156
    v_mul_f32 v149, v149, v156
    v_mul_f32 v150, v150, v156
    v_mul_f32 v151, v151, v156
    v_mul_f32 v152, v152, v156
    v_mul_f32 v153, v153, v156
    v_mul_f32 v154, v154, v156
    v_mul_f32 v155, v155, v156
    v_cvt_pk_bf16_f32 v56, v148, v149
    v_cvt_pk_bf16_f32 v57, v150, v151
    v_cvt_pk_bf16_f32 v58, v152, v153
    v_cvt_pk_bf16_f32 v59, v154, v155
    ds_write_b64 v32, v[56:57] offset:2048
    ds_write_b64 v33, v[58:59] offset:2048
    s_waitcnt lgkmcnt(0)
    v_mfma_f32_16x16x32_bf16 v[136:139], v[40:43], a[8:11], 0
    v_mfma_f32_16x16x32_bf16 v[140:143], v[44:47], a[8:11], 0
    v_mfma_f32_16x16x32_bf16 v[144:147], v[48:51], a[8:11], 0
    v_mfma_f32_16x16x32_bf16 v[148:151], v[40:43], a[12:15], 0
    v_mfma_f32_16x16x32_bf16 v[152:155], v[44:47], a[12:15], 0
    v_mfma_f32_16x16x32_bf16 v[156:159], v[48:51], a[12:15], 0
    s_nop 7
    v_cvt_pk_bf16_f32 v144, v144, v144
    v_cvt_pk_bf16_f32 v156, v156, v156
    v_lshlrev_b32 v144, 16, v144
    v_lshlrev_b32 v156, 16, v156
    v_add_f32 v144, 0x358637bd, v144
    v_add_f32 v156, 0x358637bd, v156
    v_rcp_f32 v144, v144
    v_rcp_f32 v156, v156
    s_nop 0
    v_mul_f32 v136, v136, v144
    v_mul_f32 v137, v137, v144
    v_mul_f32 v138, v138, v144
    v_mul_f32 v139, v139, v144
    v_mul_f32 v140, v140, v144
    v_mul_f32 v141, v141, v144
    v_mul_f32 v142, v142, v144
    v_mul_f32 v143, v143, v144
    v_cvt_pk_bf16_f32 v52, v136, v137
    v_cvt_pk_bf16_f32 v53, v138, v139
    v_cvt_pk_bf16_f32 v54, v140, v141
    v_cvt_pk_bf16_f32 v55, v142, v143
    ds_write_b64 v32, v[52:53] offset:4096
    ds_write_b64 v33, v[54:55] offset:4096
    v_mul_f32 v148, v148, v156
    v_mul_f32 v149, v149, v156
    v_mul_f32 v150, v150, v156
    v_mul_f32 v151, v151, v156
    v_mul_f32 v152, v152, v156
    v_mul_f32 v153, v153, v156
    v_mul_f32 v154, v154, v156
    v_mul_f32 v155, v155, v156
    v_cvt_pk_bf16_f32 v56, v148, v149
    v_cvt_pk_bf16_f32 v57, v150, v151
    v_cvt_pk_bf16_f32 v58, v152, v153
    v_cvt_pk_bf16_f32 v59, v154, v155
    ds_write_b64 v32, v[56:57] offset:6144
    ds_write_b64 v33, v[58:59] offset:6144
    s_waitcnt vmcnt(20)
    ds_read_b128 a[16:19], v37 offset:0
    ds_read_b128 a[20:23], v37 offset:2048
    ds_read_b128 a[24:27], v37 offset:4096
    ds_read_b128 a[28:31], v37 offset:6144
    v_cvt_pk_bf16_f32 v64, v64, v65
    v_cvt_pk_bf16_f32 v65, v66, v67
    v_cvt_pk_bf16_f32 v66, v68, v69
    v_cvt_pk_bf16_f32 v67, v70, v71
    v_cvt_pk_bf16_f32 v68, v72, v73
    v_cvt_pk_bf16_f32 v69, v74, v75
    v_cvt_pk_bf16_f32 v70, v76, v77
    v_cvt_pk_bf16_f32 v71, v78, v79
    v_cvt_pk_bf16_f32 v72, v80, v81
    v_cvt_pk_bf16_f32 v73, v82, v83
    v_cvt_pk_bf16_f32 v74, v84, v85
    v_cvt_pk_bf16_f32 v75, v86, v87
    s_waitcnt lgkmcnt(0)
    v_mfma_f32_16x16x32_bf16 v[136:139], v[64:67], a[16:19], 0
    v_mfma_f32_16x16x32_bf16 v[140:143], v[68:71], a[16:19], 0
    v_mfma_f32_16x16x32_bf16 v[144:147], v[72:75], a[16:19], 0
    v_mfma_f32_16x16x32_bf16 v[148:151], v[64:67], a[20:23], 0
    v_mfma_f32_16x16x32_bf16 v[152:155], v[68:71], a[20:23], 0
    v_mfma_f32_16x16x32_bf16 v[156:159], v[72:75], a[20:23], 0
    s_nop 7
    v_cvt_pk_bf16_f32 v144, v144, v144
    v_cvt_pk_bf16_f32 v156, v156, v156
    v_lshlrev_b32 v144, 16, v144
    v_lshlrev_b32 v156, 16, v156
    v_add_f32 v144, 0x358637bd, v144
    v_add_f32 v156, 0x358637bd, v156
    v_rcp_f32 v144, v144
    v_rcp_f32 v156, v156
    s_nop 0
    v_mul_f32 v136, v136, v144
    v_mul_f32 v137, v137, v144
    v_mul_f32 v138, v138, v144
    v_mul_f32 v139, v139, v144
    v_mul_f32 v140, v140, v144
    v_mul_f32 v141, v141, v144
    v_mul_f32 v142, v142, v144
    v_mul_f32 v143, v143, v144
    v_cvt_pk_bf16_f32 v76, v136, v137
    v_cvt_pk_bf16_f32 v77, v138, v139
    v_cvt_pk_bf16_f32 v78, v140, v141
    v_cvt_pk_bf16_f32 v79, v142, v143
    ds_write_b64 v34, v[76:77] offset:0
    ds_write_b64 v35, v[78:79] offset:0
    v_mul_f32 v148, v148, v156
    v_mul_f32 v149, v149, v156
    v_mul_f32 v150, v150, v156
    v_mul_f32 v151, v151, v156
    v_mul_f32 v152, v152, v156
    v_mul_f32 v153, v153, v156
    v_mul_f32 v154, v154, v156
    v_mul_f32 v155, v155, v156
    v_cvt_pk_bf16_f32 v80, v148, v149
    v_cvt_pk_bf16_f32 v81, v150, v151
    v_cvt_pk_bf16_f32 v82, v152, v153
    v_cvt_pk_bf16_f32 v83, v154, v155
    ds_write_b64 v34, v[80:81] offset:2048
    ds_write_b64 v35, v[82:83] offset:2048
    s_waitcnt lgkmcnt(0)
    v_mfma_f32_16x16x32_bf16 v[136:139], v[64:67], a[24:27], 0
    v_mfma_f32_16x16x32_bf16 v[140:143], v[68:71], a[24:27], 0
    v_mfma_f32_16x16x32_bf16 v[144:147], v[72:75], a[24:27], 0
    v_mfma_f32_16x16x32_bf16 v[148:151], v[64:67], a[28:31], 0
    v_mfma_f32_16x16x32_bf16 v[152:155], v[68:71], a[28:31], 0
    v_mfma_f32_16x16x32_bf16 v[156:159], v[72:75], a[28:31], 0
    s_nop 7
    v_cvt_pk_bf16_f32 v144, v144, v144
    v_cvt_pk_bf16_f32 v156, v156, v156
    v_lshlrev_b32 v144, 16, v144
    v_lshlrev_b32 v156, 16, v156
    v_add_f32 v144, 0x358637bd, v144
    v_add_f32 v156, 0x358637bd, v156
    v_rcp_f32 v144, v144
    v_rcp_f32 v156, v156
    s_nop 0
    v_mul_f32 v136, v136, v144
    v_mul_f32 v137, v137, v144
    v_mul_f32 v138, v138, v144
    v_mul_f32 v139, v139, v144
    v_mul_f32 v140, v140, v144
    v_mul_f32 v141, v141, v144
    v_mul_f32 v142, v142, v144
    v_mul_f32 v143, v143, v144
    v_cvt_pk_bf16_f32 v76, v136, v137
    v_cvt_pk_bf16_f32 v77, v138, v139
    v_cvt_pk_bf16_f32 v78, v140, v141
    v_cvt_pk_bf16_f32 v79, v142, v143
    ds_write_b64 v34, v[76:77] offset:4096
    ds_write_b64 v35, v[78:79] offset:4096
    v_mul_f32 v148, v148, v156
    v_mul_f32 v149, v149, v156
    v_mul_f32 v150, v150, v156
    v_mul_f32 v151, v151, v156
    v_mul_f32 v152, v152, v156
    v_mul_f32 v153, v153, v156
    v_mul_f32 v154, v154, v156
    v_mul_f32 v155, v155, v156
    v_cvt_pk_bf16_f32 v80, v148, v149
    v_cvt_pk_bf16_f32 v81, v150, v151
    v_cvt_pk_bf16_f32 v82, v152, v153
    v_cvt_pk_bf16_f32 v83, v154, v155
    ds_write_b64 v34, v[80:81] offset:6144
    ds_write_b64 v35, v[82:83] offset:6144
    s_waitcnt vmcnt(6)
    ds_read_b128 a[0:3], v36 offset:8192
    ds_read_b128 a[4:7], v36 offset:10240
    ds_read_b128 a[8:11], v36 offset:12288
    ds_read_b128 a[12:15], v36 offset:14336
    v_cvt_pk_bf16_f32 v88, v88, v89
    v_cvt_pk_bf16_f32 v89, v90, v91
    v_cvt_pk_bf16_f32 v90, v92, v93
    v_cvt_pk_bf16_f32 v91, v94, v95
    v_cvt_pk_bf16_f32 v92, v96, v97
    v_cvt_pk_bf16_f32 v93, v98, v99
    v_cvt_pk_bf16_f32 v94, v100, v101
    v_cvt_pk_bf16_f32 v95, v102, v103
    v_cvt_pk_bf16_f32 v96, v104, v105
    v_cvt_pk_bf16_f32 v97, v106, v107
    v_cvt_pk_bf16_f32 v98, v108, v109
    v_cvt_pk_bf16_f32 v99, v110, v111
    s_waitcnt lgkmcnt(0)
    v_mfma_f32_16x16x32_bf16 v[136:139], v[88:91], a[0:3], 0
    v_mfma_f32_16x16x32_bf16 v[140:143], v[92:95], a[0:3], 0
    v_mfma_f32_16x16x32_bf16 v[144:147], v[96:99], a[0:3], 0
    v_mfma_f32_16x16x32_bf16 v[148:151], v[88:91], a[4:7], 0
    v_mfma_f32_16x16x32_bf16 v[152:155], v[92:95], a[4:7], 0
    v_mfma_f32_16x16x32_bf16 v[156:159], v[96:99], a[4:7], 0
    s_nop 7
    v_cvt_pk_bf16_f32 v144, v144, v144
    v_cvt_pk_bf16_f32 v156, v156, v156
    v_lshlrev_b32 v144, 16, v144
    v_lshlrev_b32 v156, 16, v156
    v_add_f32 v144, 0x358637bd, v144
    v_add_f32 v156, 0x358637bd, v156
    v_rcp_f32 v144, v144
    v_rcp_f32 v156, v156
    s_nop 0
    v_mul_f32 v136, v136, v144
    v_mul_f32 v137, v137, v144
    v_mul_f32 v138, v138, v144
    v_mul_f32 v139, v139, v144
    v_mul_f32 v140, v140, v144
    v_mul_f32 v141, v141, v144
    v_mul_f32 v142, v142, v144
    v_mul_f32 v143, v143, v144
    v_cvt_pk_bf16_f32 v100, v136, v137
    v_cvt_pk_bf16_f32 v101, v138, v139
    v_cvt_pk_bf16_f32 v102, v140, v141
    v_cvt_pk_bf16_f32 v103, v142, v143
    ds_write_b64 v32, v[100:101] offset:8192
    ds_write_b64 v33, v[102:103] offset:8192
    v_mul_f32 v148, v148, v156
    v_mul_f32 v149, v149, v156
    v_mul_f32 v150, v150, v156
    v_mul_f32 v151, v151, v156
    v_mul_f32 v152, v152, v156
    v_mul_f32 v153, v153, v156
    v_mul_f32 v154, v154, v156
    v_mul_f32 v155, v155, v156
    v_cvt_pk_bf16_f32 v104, v148, v149
    v_cvt_pk_bf16_f32 v105, v150, v151
    v_cvt_pk_bf16_f32 v106, v152, v153
    v_cvt_pk_bf16_f32 v107, v154, v155
    ds_write_b64 v32, v[104:105] offset:10240
    ds_write_b64 v33, v[106:107] offset:10240
    s_waitcnt lgkmcnt(0)
    v_mfma_f32_16x16x32_bf16 v[136:139], v[88:91], a[8:11], 0
    v_mfma_f32_16x16x32_bf16 v[140:143], v[92:95], a[8:11], 0
    v_mfma_f32_16x16x32_bf16 v[144:147], v[96:99], a[8:11], 0
    v_mfma_f32_16x16x32_bf16 v[148:151], v[88:91], a[12:15], 0
    v_mfma_f32_16x16x32_bf16 v[152:155], v[92:95], a[12:15], 0
    v_mfma_f32_16x16x32_bf16 v[156:159], v[96:99], a[12:15], 0
    s_nop 7
    v_cvt_pk_bf16_f32 v144, v144, v144
    v_cvt_pk_bf16_f32 v156, v156, v156
    v_lshlrev_b32 v144, 16, v144
    v_lshlrev_b32 v156, 16, v156
    v_add_f32 v144, 0x358637bd, v144
    v_add_f32 v156, 0x358637bd, v156
    v_rcp_f32 v144, v144
    v_rcp_f32 v156, v156
    s_nop 0
    v_mul_f32 v136, v136, v144
    v_mul_f32 v137, v137, v144
    v_mul_f32 v138, v138, v144
    v_mul_f32 v139, v139, v144
    v_mul_f32 v140, v140, v144
    v_mul_f32 v141, v141, v144
    v_mul_f32 v142, v142, v144
    v_mul_f32 v143, v143, v144
    v_cvt_pk_bf16_f32 v100, v136, v137
    v_cvt_pk_bf16_f32 v101, v138, v139
    v_cvt_pk_bf16_f32 v102, v140, v141
    v_cvt_pk_bf16_f32 v103, v142, v143
    ds_write_b64 v32, v[100:101] offset:12288
    ds_write_b64 v33, v[102:103] offset:12288
    v_mul_f32 v148, v148, v156
    v_mul_f32 v149, v149, v156
    v_mul_f32 v150, v150, v156
    v_mul_f32 v151, v151, v156
    v_mul_f32 v152, v152, v156
    v_mul_f32 v153, v153, v156
    v_mul_f32 v154, v154, v156
    v_mul_f32 v155, v155, v156
    v_cvt_pk_bf16_f32 v104, v148, v149
    v_cvt_pk_bf16_f32 v105, v150, v151
    v_cvt_pk_bf16_f32 v106, v152, v153
    v_cvt_pk_bf16_f32 v107, v154, v155
    ds_write_b64 v32, v[104:105] offset:14336
    ds_write_b64 v33, v[106:107] offset:14336
    s_waitcnt vmcnt(0)
    ds_read_b128 a[16:19], v37 offset:8192
    ds_read_b128 a[20:23], v37 offset:10240
    ds_read_b128 a[24:27], v37 offset:12288
    ds_read_b128 a[28:31], v37 offset:14336
    v_cvt_pk_bf16_f32 v112, v112, v113
    v_cvt_pk_bf16_f32 v113, v114, v115
    v_cvt_pk_bf16_f32 v114, v116, v117
    v_cvt_pk_bf16_f32 v115, v118, v119
    v_cvt_pk_bf16_f32 v116, v120, v121
    v_cvt_pk_bf16_f32 v117, v122, v123
    v_cvt_pk_bf16_f32 v118, v124, v125
    v_cvt_pk_bf16_f32 v119, v126, v127
    v_cvt_pk_bf16_f32 v120, v128, v129
    v_cvt_pk_bf16_f32 v121, v130, v131
    v_cvt_pk_bf16_f32 v122, v132, v133
    v_cvt_pk_bf16_f32 v123, v134, v135
    s_waitcnt lgkmcnt(0)
    v_mfma_f32_16x16x32_bf16 v[136:139], v[112:115], a[16:19], 0
    v_mfma_f32_16x16x32_bf16 v[140:143], v[116:119], a[16:19], 0
    v_mfma_f32_16x16x32_bf16 v[144:147], v[120:123], a[16:19], 0
    v_mfma_f32_16x16x32_bf16 v[148:151], v[112:115], a[20:23], 0
    v_mfma_f32_16x16x32_bf16 v[152:155], v[116:119], a[20:23], 0
    v_mfma_f32_16x16x32_bf16 v[156:159], v[120:123], a[20:23], 0
    s_nop 7
    v_cvt_pk_bf16_f32 v144, v144, v144
    v_cvt_pk_bf16_f32 v156, v156, v156
    v_lshlrev_b32 v144, 16, v144
    v_lshlrev_b32 v156, 16, v156
    v_add_f32 v144, 0x358637bd, v144
    v_add_f32 v156, 0x358637bd, v156
    v_rcp_f32 v144, v144
    v_rcp_f32 v156, v156
    s_nop 0
    v_mul_f32 v136, v136, v144
    v_mul_f32 v137, v137, v144
    v_mul_f32 v138, v138, v144
    v_mul_f32 v139, v139, v144
    v_mul_f32 v140, v140, v144
    v_mul_f32 v141, v141, v144
    v_mul_f32 v142, v142, v144
    v_mul_f32 v143, v143, v144
    v_cvt_pk_bf16_f32 v124, v136, v137
    v_cvt_pk_bf16_f32 v125, v138, v139
    v_cvt_pk_bf16_f32 v126, v140, v141
    v_cvt_pk_bf16_f32 v127, v142, v143
    ds_write_b64 v34, v[124:125] offset:8192
    ds_write_b64 v35, v[126:127] offset:8192
    v_mul_f32 v148, v148, v156
    v_mul_f32 v149, v149, v156
    v_mul_f32 v150, v150, v156
    v_mul_f32 v151, v151, v156
    v_mul_f32 v152, v152, v156
    v_mul_f32 v153, v153, v156
    v_mul_f32 v154, v154, v156
    v_mul_f32 v155, v155, v156
    v_cvt_pk_bf16_f32 v128, v148, v149
    v_cvt_pk_bf16_f32 v129, v150, v151
    v_cvt_pk_bf16_f32 v130, v152, v153
    v_cvt_pk_bf16_f32 v131, v154, v155
    ds_write_b64 v34, v[128:129] offset:10240
    ds_write_b64 v35, v[130:131] offset:10240
    s_waitcnt lgkmcnt(0)
    v_mfma_f32_16x16x32_bf16 v[136:139], v[112:115], a[24:27], 0
    v_mfma_f32_16x16x32_bf16 v[140:143], v[116:119], a[24:27], 0
    v_mfma_f32_16x16x32_bf16 v[144:147], v[120:123], a[24:27], 0
    v_mfma_f32_16x16x32_bf16 v[148:151], v[112:115], a[28:31], 0
    v_mfma_f32_16x16x32_bf16 v[152:155], v[116:119], a[28:31], 0
    v_mfma_f32_16x16x32_bf16 v[156:159], v[120:123], a[28:31], 0
    s_nop 7
    v_cvt_pk_bf16_f32 v144, v144, v144
    v_cvt_pk_bf16_f32 v156, v156, v156
    v_lshlrev_b32 v144, 16, v144
    v_lshlrev_b32 v156, 16, v156
    v_add_f32 v144, 0x358637bd, v144
    v_add_f32 v156, 0x358637bd, v156
    v_rcp_f32 v144, v144
    v_rcp_f32 v156, v156
    s_nop 0
    v_mul_f32 v136, v136, v144
    v_mul_f32 v137, v137, v144
    v_mul_f32 v138, v138, v144
    v_mul_f32 v139, v139, v144
    v_mul_f32 v140, v140, v144
    v_mul_f32 v141, v141, v144
    v_mul_f32 v142, v142, v144
    v_mul_f32 v143, v143, v144
    v_cvt_pk_bf16_f32 v124, v136, v137
    v_cvt_pk_bf16_f32 v125, v138, v139
    v_cvt_pk_bf16_f32 v126, v140, v141
    v_cvt_pk_bf16_f32 v127, v142, v143
    ds_write_b64 v34, v[124:125] offset:12288
    ds_write_b64 v35, v[126:127] offset:12288
    v_mul_f32 v148, v148, v156
    v_mul_f32 v149, v149, v156
    v_mul_f32 v150, v150, v156
    v_mul_f32 v151, v151, v156
    v_mul_f32 v152, v152, v156
    v_mul_f32 v153, v153, v156
    v_mul_f32 v154, v154, v156
    v_mul_f32 v155, v155, v156
    v_cvt_pk_bf16_f32 v128, v148, v149
    v_cvt_pk_bf16_f32 v129, v150, v151
    v_cvt_pk_bf16_f32 v130, v152, v153
    v_cvt_pk_bf16_f32 v131, v154, v155
    ds_write_b64 v34, v[128:129] offset:14336
    ds_write_b64 v35, v[130:131] offset:14336
    s_mov_b32 s34, 0
    s_mov_b32 s41, 0
    v_add_u32 v8, s34, v4
    v_add_u32 v9, s34, v5
    v_add_u32 v10, s41, v6
    v_add_u32 v11, s41, v7
    s_waitcnt vmcnt(3) lgkmcnt(0)
    s_barrier
    ds_read_b128 a[0:3], v8 offset:0
    ds_read_b128 a[4:7], v8 offset:2048
    ds_read_b64_tr_b16 a[8:9], v10 offset:0
    ds_read_b64_tr_b16 a[10:11], v10 offset:512
    ds_read_b64_tr_b16 a[12:13], v11 offset:0
    ds_read_b64_tr_b16 a[14:15], v11 offset:512
    s_add_u32 s42, s96, s37
    s_add_u32 m0, s42, 0
    s_nop 0
    buffer_load_dwordx4 v3, s[12:15], s33 offen lds
    s_add_u32 s33, s33, 65536
    s_waitcnt lgkmcnt(0)
    s_mov_b32 s96, s41
    s_add_u32 s41, s41, 8192
    s_cmp_eq_u32 s41, 32768
    s_cselect_b32 s41, 0, s41
    v_add_u32 v10, s41, v6
    v_add_u32 v11, s41, v7
    s_waitcnt vmcnt(3)
    s_barrier
    v_mfma_f32_16x16x32_bf16 v[28:31], a[8:11], a[0:3], 0
    ds_read_b128 a[16:19], v9 offset:0
    ds_read_b128 a[20:23], v9 offset:2048
    ds_read_b64_tr_b16 a[24:25], v10 offset:0
    v_mfma_f32_16x16x32_bf16 v[32:35], a[8:11], a[4:7], 0
    ds_read_b64_tr_b16 a[26:27], v10 offset:512
    ds_read_b64_tr_b16 a[28:29], v11 offset:0
    ds_read_b64_tr_b16 a[30:31], v11 offset:512
    v_mfma_f32_16x16x32_bf16 v[36:39], a[12:15], a[0:3], 0
    s_add_u32 s42, s96, s37
    s_add_u32 m0, s42, 0
    s_nop 0
    buffer_load_dwordx4 v3, s[12:15], s33 offen lds
    s_add_u32 s33, s33, 65536
    v_mfma_f32_16x16x32_bf16 v[40:43], a[12:15], a[4:7], 0
    s_waitcnt lgkmcnt(0)
    s_mov_b32 s35, s34
    s_add_u32 s34, s34, 8192
    s_cmp_eq_u32 s34, 131072
    s_cselect_b32 s34, 0, s34
    v_add_u32 v8, s34, v4
    v_add_u32 v9, s34, v5
    s_mov_b32 s96, s41
    s_add_u32 s41, s41, 8192
    s_cmp_eq_u32 s41, 32768
    s_cselect_b32 s41, 0, s41
    v_add_u32 v10, s41, v6
    v_add_u32 v11, s41, v7
    s_waitcnt vmcnt(3)
    s_barrier
    v_mfma_f32_16x16x32_bf16 v[28:31], a[24:27], a[16:19], v[28:31]
    ds_read_b128 a[0:3], v8 offset:0
    ds_read_b128 a[4:7], v8 offset:2048
    ds_read_b64_tr_b16 a[8:9], v10 offset:0
    v_mfma_f32_16x16x32_bf16 v[32:35], a[24:27], a[20:23], v[32:35]
    ds_read_b64_tr_b16 a[10:11], v10 offset:512
    ds_read_b64_tr_b16 a[12:13], v11 offset:0
    ds_read_b64_tr_b16 a[14:15], v11 offset:512
    v_mfma_f32_16x16x32_bf16 v[36:39], a[28:31], a[16:19], v[36:39]
    s_add_u32 s42, s96, s37
    s_add_u32 m0, s42, 0
    s_nop 0
    buffer_load_dwordx4 v3, s[12:15], s33 offen lds
    s_add_u32 s33, s33, 65536
    v_mfma_f32_16x16x32_bf16 v[40:43], a[28:31], a[20:23], v[40:43]
    s_waitcnt lgkmcnt(0)
    s_mov_b32 s31, 13
L_loop_10:
    s_mov_b32 s96, s41
    s_add_u32 s41, s41, 8192
    s_cmp_eq_u32 s41, 32768
    s_cselect_b32 s41, 0, s41
    v_add_u32 v10, s41, v6
    v_add_u32 v11, s41, v7
    s_waitcnt vmcnt(2)
    s_barrier
    v_mfma_f32_16x16x32_bf16 v[28:31], a[8:11], a[0:3], v[28:31]
    ds_read_b128 a[16:19], v9 offset:0
    ds_read_b128 a[20:23], v9 offset:2048
    ds_read_b64_tr_b16 a[24:25], v10 offset:0
    v_mfma_f32_16x16x32_bf16 v[32:35], a[8:11], a[4:7], v[32:35]
    ds_read_b64_tr_b16 a[26:27], v10 offset:512
    ds_read_b64_tr_b16 a[28:29], v11 offset:0
    ds_read_b64_tr_b16 a[30:31], v11 offset:512
    v_mfma_f32_16x16x32_bf16 v[36:39], a[12:15], a[0:3], v[36:39]
    s_add_u32 s42, s96, s37
    s_add_u32 m0, s42, 0
    s_nop 0
    buffer_load_dwordx4 v3, s[12:15], s33 offen lds
    s_add_u32 s33, s33, 65536
    v_mfma_f32_16x16x32_bf16 v[40:43], a[12:15], a[4:7], v[40:43]
    s_waitcnt lgkmcnt(0)
    s_mov_b32 s35, s34
    s_add_u32 s34, s34, 8192
    s_cmp_eq_u32 s34, 131072
    s_cselect_b32 s34, 0, s34
    v_add_u32 v8, s34, v4
    v_add_u32 v9, s34, v5
    s_mov_b32 s96, s41
    s_add_u32 s41, s41, 8192
    s_cmp_eq_u32 s41, 32768
    s_cselect_b32 s41, 0, s41
    v_add_u32 v10, s41, v6
    v_add_u32 v11, s41, v7
    s_waitcnt vmcnt(2)
    s_barrier
    v_mfma_f32_16x16x32_bf16 v[28:31], a[24:27], a[16:19], v[28:31]
    ds_read_b128 a[0:3], v8 offset:0
    ds_read_b128 a[4:7], v8 offset:2048
    ds_read_b64_tr_b16 a[8:9], v10 offset:0
    v_mfma_f32_16x16x32_bf16 v[32:35], a[24:27], a[20:23], v[32:35]
    ds_read_b64_tr_b16 a[10:11], v10 offset:512
    ds_read_b64_tr_b16 a[12:13], v11 offset:0
    ds_read_b64_tr_b16 a[14:15], v11 offset:512
    v_mfma_f32_16x16x32_bf16 v[36:39], a[28:31], a[16:19], v[36:39]
    s_add_u32 s42, s96, s37
    s_add_u32 m0, s42, 0
    s_nop 0
    buffer_load_dwordx4 v3, s[12:15], s33 offen lds
    s_add_u32 s33, s33, 65536
    v_mfma_f32_16x16x32_bf16 v[40:43], a[28:31], a[20:23], v[40:43]
    s_waitcnt lgkmcnt(0)
    s_sub_u32 s31, s31, 1
    s_cmp_lg_u32 s31, 0
    s_cbranch_scc1 L_loop_10
    s_mov_b32 s96, s41
    s_add_u32 s41, s41, 8192
    s_cmp_eq_u32 s41, 32768
    s_cselect_b32 s41, 0, s41
    v_add_u32 v10, s41, v6
    v_add_u32 v11, s41, v7
    s_waitcnt vmcnt(2)
    s_barrier
    v_mfma_f32_16x16x32_bf16 v[28:31], a[8:11], a[0:3], v[28:31]
    ds_read_b128 a[16:19], v9 offset:0
    ds_read_b128 a[20:23], v9 offset:2048
    v_mfma_f32_16x16x32_bf16 v[32:35], a[8:11], a[4:7], v[32:35]
    ds_read_b64_tr_b16 a[24:25], v10 offset:0
    ds_read_b64_tr_b16 a[26:27], v10 offset:512
    v_mfma_f32_16x16x32_bf16 v[36:39], a[12:15], a[0:3], v[36:39]
    ds_read_b64_tr_b16 a[28:29], v11 offset:0
    ds_read_b64_tr_b16 a[30:31], v11 offset:512
    v_mfma_f32_16x16x32_bf16 v[40:43], a[12:15], a[4:7], v[40:43]
    s_waitcnt lgkmcnt(0)
    s_mov_b32 s35, s34
    s_add_u32 s34, s34, 8192
    s_cmp_eq_u32 s34, 131072
    s_cselect_b32 s34, 0, s34
    v_add_u32 v8, s34, v4
    v_add_u32 v9, s34, v5
    s_mov_b32 s96, s41
    s_add_u32 s41, s41, 8192
    s_cmp_eq_u32 s41, 32768
    s_cselect_b32 s41, 0, s41
    v_add_u32 v10, s41, v6
    v_add_u32 v11, s41, v7
    s_waitcnt vmcnt(1)
    s_barrier
    v_mfma_f32_16x16x32_bf16 v[28:31], a[24:27], a[16:19], v[28:31]
    ds_read_b128 a[0:3], v8 offset:0
    ds_read_b128 a[4:7], v8 offset:2048
    ds_read_b64_tr_b16 a[8:9], v10 offset:0
    v_mfma_f32_16x16x32_bf16 v[32:35], a[24:27], a[20:23], v[32:35]
    ds_read_b64_tr_b16 a[10:11], v10 offset:512
    ds_read_b64_tr_b16 a[12:13], v11 offset:0
    v_mfma_f32_16x16x32_bf16 v[36:39], a[28:31], a[16:19], v[36:39]
    ds_read_b64_tr_b16 a[14:15], v11 offset:512
    s_lshl_b32 s50, s29, 6
    s_lshl_b32 s51, s38, 5
    s_add_u32 s50, s50, s51
    s_lshl_b32 s50, s50, 11
    s_lshl_b32 s51, s30, 8
    s_add_u32 s50, s50, s51
    s_lshl_b32 s51, s39, 5
    s_add_u32 s50, s50, s51
    s_lshl_b32 s51, s40, 7
    s_add_u32 s50, s50, s51
    s_add_u32 s51, s50, 32768
    v_lshlrev_b32 v44, 11, v1
    v_lshl_add_u32 v44, v2, 3, v44
    buffer_load_dwordx2 v[46:47], v44, s[20:23], s50 offen offset:0
    buffer_load_dwordx2 v[48:49], v44, s[20:23], s50 offen offset:64
    buffer_load_dwordx2 v[50:51], v44, s[20:23], s51 offen offset:0
    buffer_load_dwordx2 v[52:53], v44, s[20:23], s51 offen offset:64
    v_mfma_f32_16x16x32_bf16 v[40:43], a[28:31], a[20:23], v[40:43]
    s_waitcnt lgkmcnt(0)
    s_mov_b32 s96, s41
    s_add_u32 s41, s41, 8192
    s_cmp_eq_u32 s41, 32768
    s_cselect_b32 s41, 0, s41
    v_add_u32 v10, s41, v6
    v_add_u32 v11, s41, v7
    s_waitcnt vmcnt(4)
    s_barrier
    v_mfma_f32_16x16x32_bf16 v[28:31], a[8:11], a[0:3], v[28:31]
    ds_read_b128 a[16:19], v9 offset:0
    ds_read_b128 a[20:23], v9 offset:2048
    v_mfma_f32_16x16x32_bf16 v[32:35], a[8:11], a[4:7], v[32:35]
    ds_read_b64_tr_b16 a[24:25], v10 offset:0
    ds_read_b64_tr_b16 a[26:27], v10 offset:512
    v_mfma_f32_16x16x32_bf16 v[36:39], a[12:15], a[0:3], v[36:39]
    ds_read_b64_tr_b16 a[28:29], v11 offset:0
    ds_read_b64_tr_b16 a[30:31], v11 offset:512
    v_mfma_f32_16x16x32_bf16 v[40:43], a[12:15], a[4:7], v[40:43]
    s_waitcnt lgkmcnt(0)
    v_mfma_f32_16x16x32_bf16 v[28:31], a[24:27], a[16:19], v[28:31]
    v_mfma_f32_16x16x32_bf16 v[32:35], a[24:27], a[20:23], v[32:35]
    v_mfma_f32_16x16x32_bf16 v[36:39], a[28:31], a[16:19], v[36:39]
    v_mfma_f32_16x16x32_bf16 v[40:43], a[28:31], a[20:23], v[40:43]
    s_nop 7
    v_cvt_pk_bf16_f32 v4, v28, v29
    v_cvt_pk_bf16_f32 v5, v30, v31
    v_lshlrev_b32 v28, 16, v4
    v_and_b32 v29, 0xffff0000, v4
    v_lshlrev_b32 v30, 16, v5
    v_and_b32 v31, 0xffff0000, v5
    v_cvt_pk_bf16_f32 v4, v36, v37
    v_cvt_pk_bf16_f32 v5, v38, v39
    v_lshlrev_b32 v36, 16, v4
    v_and_b32 v37, 0xffff0000, v4
    v_lshlrev_b32 v38, 16, v5
    v_and_b32 v39, 0xffff0000, v5
    v_cvt_pk_bf16_f32 v4, v32, v33
    v_cvt_pk_bf16_f32 v5, v34, v35
    v_lshlrev_b32 v32, 16, v4
    v_and_b32 v33, 0xffff0000, v4
    v_lshlrev_b32 v34, 16, v5
    v_and_b32 v35, 0xffff0000, v5
    v_cvt_pk_bf16_f32 v4, v40, v41
    v_cvt_pk_bf16_f32 v5, v42, v43
    v_lshlrev_b32 v40, 16, v4
    v_and_b32 v41, 0xffff0000, v4
    v_lshlrev_b32 v42, 16, v5
    v_and_b32 v43, 0xffff0000, v5
    s_waitcnt vmcnt(0)
    v_lshlrev_b32 v4, 16, v46
    v_and_b32 v5, 0xffff0000, v46
    v_add_f32 v28, v28, v4
    v_add_f32 v29, v29, v5
    v_lshlrev_b32 v4, 16, v47
    v_and_b32 v5, 0xffff0000, v47
    v_add_f32 v30, v30, v4
    v_add_f32 v31, v31, v5
    v_cvt_pk_bf16_f32 v46, v28, v29
    v_cvt_pk_bf16_f32 v47, v30, v31
    buffer_store_dwordx2 v[46:47], v44, s[16:19], s50 offen offset:0
    v_lshlrev_b32 v4, 16, v48
    v_and_b32 v5, 0xffff0000, v48
    v_add_f32 v36, v36, v4
    v_add_f32 v37, v37, v5
    v_lshlrev_b32 v4, 16, v49
    v_and_b32 v5, 0xffff0000, v49
    v_add_f32 v38, v38, v4
    v_add_f32 v39, v39, v5
    v_cvt_pk_bf16_f32 v48, v36, v37
    v_cvt_pk_bf16_f32 v49, v38, v39
    buffer_store_dwordx2 v[48:49], v44, s[16:19], s50 offen offset:64
    v_lshlrev_b32 v4, 16, v50
    v_and_b32 v5, 0xffff0000, v50
    v_add_f32 v32, v32, v4
    v_add_f32 v33, v33, v5
    v_lshlrev_b32 v4, 16, v51
    v_and_b32 v5, 0xffff0000, v51
    v_add_f32 v34, v34, v4
    v_add_f32 v35, v35, v5
    v_cvt_pk_bf16_f32 v50, v32, v33
    v_cvt_pk_bf16_f32 v51, v34, v35
    buffer_store_dwordx2 v[50:51], v44, s[16:19], s51 offen offset:0
    v_lshlrev_b32 v4, 16, v52
    v_and_b32 v5, 0xffff0000, v52
    v_add_f32 v40, v40, v4
    v_add_f32 v41, v41, v5
    v_lshlrev_b32 v4, 16, v53
    v_and_b32 v5, 0xffff0000, v53
    v_add_f32 v42, v42, v4
    v_add_f32 v43, v43, v5
    v_cvt_pk_bf16_f32 v52, v40, v41
    v_cvt_pk_bf16_f32 v53, v42, v43
    buffer_store_dwordx2 v[52:53], v44, s[16:19], s51 offen offset:64
    s_lshl_b32 s52, s29, 6
    s_lshl_b32 s53, s38, 5
    s_add_u32 s52, s52, s53
    s_lshl_b32 s52, s52, 6
    s_lshl_b32 s53, s30, 3
    s_add_u32 s52, s52, s53
    v_lshlrev_b32 v9, 6, v1
    v_add_f32 v10, v28, v29
    v_add_f32 v10, v10, v30
    v_add_f32 v10, v10, v31
    v_add_f32 v10, v10, v36
    v_add_f32 v10, v10, v37
    v_add_f32 v10, v10, v38
    v_add_f32 v10, v10, v39
    v_mov_b32 v4, v10
    s_nop 1
    v_permlane16_swap_b32 v10, v4
    s_nop 1
    v_add_f32 v10, v10, v4
    v_mov_b32 v4, v10
    s_nop 1
    v_permlane32_swap_b32 v10, v4
    s_nop 1
    v_add_f32 v10, v10, v4
    v_mul_f32 v10, 0x3d000000, v10
    v_sub_f32 v4, v28, v10
    v_mul_f32 v11, v4, v4
    v_sub_f32 v4, v29, v10
    v_fmac_f32 v11, v4, v4
    v_sub_f32 v4, v30, v10
    v_fmac_f32 v11, v4, v4
    v_sub_f32 v4, v31, v10
    v_fmac_f32 v11, v4, v4
    v_sub_f32 v4, v36, v10
    v_fmac_f32 v11, v4, v4
    v_sub_f32 v4, v37, v10
    v_fmac_f32 v11, v4, v4
    v_sub_f32 v4, v38, v10
    v_fmac_f32 v11, v4, v4
    v_sub_f32 v4, v39, v10
    v_fmac_f32 v11, v4, v4
    v_mov_b32 v4, v11
    s_nop 1
    v_permlane16_swap_b32 v11, v4
    s_nop 1
    v_add_f32 v11, v11, v4
    v_mov_b32 v4, v11
    s_nop 1
    v_permlane32_swap_b32 v11, v4
    s_nop 1
    v_add_f32 v11, v11, v4
    v_add_f32 v12, v32, v33
    v_add_f32 v12, v12, v34
    v_add_f32 v12, v12, v35
    v_add_f32 v12, v12, v40
    v_add_f32 v12, v12, v41
    v_add_f32 v12, v12, v42
    v_add_f32 v12, v12, v43
    v_mov_b32 v4, v12
    s_nop 1
    v_permlane16_swap_b32 v12, v4
    s_nop 1
    v_add_f32 v12, v12, v4
    v_mov_b32 v4, v12
    s_nop 1
    v_permlane32_swap_b32 v12, v4
    s_nop 1
    v_add_f32 v12, v12, v4
    v_mul_f32 v12, 0x3d000000, v12
    v_sub_f32 v4, v32, v12
    v_mul_f32 v13, v4, v4
    v_sub_f32 v4, v33, v12
    v_fmac_f32 v13, v4, v4
    v_sub_f32 v4, v34, v12
    v_fmac_f32 v13, v4, v4
    v_sub_f32 v4, v35, v12
    v_fmac_f32 v13, v4, v4
    v_sub_f32 v4, v40, v12
    v_fmac_f32 v13, v4, v4
    v_sub_f32 v4, v41, v12
    v_fmac_f32 v13, v4, v4
    v_sub_f32 v4, v42, v12
    v_fmac_f32 v13, v4, v4
    v_sub_f32 v4, v43, v12
    v_fmac_f32 v13, v4, v4
    v_mov_b32 v4, v13
    s_nop 1
    v_permlane16_swap_b32 v13, v4
    s_nop 1
    v_add_f32 v13, v13, v4
    v_mov_b32 v4, v13
    s_nop 1
    v_permlane32_swap_b32 v13, v4
    s_nop 1
    v_add_f32 v13, v13, v4
    s_barrier
    v_lshlrev_b32 v14, 4, v0
    s_mov_b32 s53, 0
    s_mul_i32 s54, s38, 4096
    s_add_u32 s53, s53, s54
    s_mul_i32 s54, s39, 1024
    s_add_u32 s53, s53, s54
    s_mul_i32 s54, s40, 2048
    s_add_u32 s53, s53, s54
    v_add_u32 v15, s53, v14
    ds_write_b128 v15, v[10:13]
    s_waitcnt lgkmcnt(0)
    s_barrier
    s_or_b32 s54, s39, s40
    s_cmp_lg_u32 s54, 0
    s_cbranch_scc1 L_st0_11
    ds_read_b128 v[68:71], v15 offset:1024
    ds_read_b128 v[72:75], v15 offset:2048
    ds_read_b128 v[76:79], v15 offset:3072
    s_waitcnt lgkmcnt(0)
    v_add_f32 v4, v10, v68
    v_add_f32 v4, v4, v72
    v_add_f32 v4, v4, v76
    v_mul_f32 v4, 0x3e800000, v4
    v_add_f32 v11, v11, v69
    v_add_f32 v11, v11, v73
    v_add_f32 v11, v11, v77
    v_mov_b32 v5, 0
    v_sub_f32 v6, v10, v4
    v_fmac_f32 v5, v6, v6
    v_sub_f32 v6, v68, v4
    v_fmac_f32 v5, v6, v6
    v_sub_f32 v6, v72, v4
    v_fmac_f32 v5, v6, v6
    v_sub_f32 v6, v76, v4
    v_fmac_f32 v5, v6, v6
    v_fmac_f32 v11, 0x42000000, v5
    v_mov_b32 v10, v4
    v_add_f32 v4, v12, v70
    v_add_f32 v4, v4, v74
    v_add_f32 v4, v4, v78
    v_mul_f32 v4, 0x3e800000, v4
    v_add_f32 v13, v13, v71
    v_add_f32 v13, v13, v75
    v_add_f32 v13, v13, v79
    v_mov_b32 v5, 0
    v_sub_f32 v6, v12, v4
    v_fmac_f32 v5, v6, v6
    v_sub_f32 v6, v70, v4
    v_fmac_f32 v5, v6, v6
    v_sub_f32 v6, v74, v4
    v_fmac_f32 v5, v6, v6
    v_sub_f32 v6, v78, v4
    v_fmac_f32 v5, v6, v6
    v_fmac_f32 v13, 0x42000000, v5
    v_mov_b32 v12, v4
    s_mov_b64 exec, 0xffff
    buffer_store_dwordx2 v[10:11], v9, s[24:27], s52 offen offset:0
    buffer_store_dwordx2 v[12:13], v9, s[24:27], s52 offen offset:1024
    s_mov_b64 exec, -1
L_st0_11:
L_end_9:
    s_endpgm
.globl gemm3_kernel
.p2align 8
.type gemm3_kernel,@function
gemm3_kernel:
    s_cmp_ge_u32 s2, 256
    s_cbranch_scc1 L_end_12
    s_load_dwordx2 s[4:5], s[0:1], 72
    s_load_dwordx2 s[6:7], s[0:1], 32
    s_load_dwordx2 s[60:61], s[0:1], 40
    s_load_dwordx2 s[82:83], s[0:1], 48
    v_lshrrev_b32 v1, 6, v0
    v_and_b32 v0, 63, v0
    s_nop 0
    v_readfirstlane_b32 s28, v1
    v_and_b32 v1, 15, v0
    v_lshrrev_b32 v2, 4, v0
    s_and_b32 s42, s2, 7
    s_lshr_b32 s43, s2, 3
    s_and_b32 s29, s42, 1
    s_lshl_b32 s29, s29, 3
    s_and_b32 s44, s43, 7
    s_add_u32 s29, s29, s44
    s_lshr_b32 s30, s42, 1
    s_lshl_b32 s30, s30, 2
    s_lshr_b32 s44, s43, 3
    s_add_u32 s30, s30, s44
    s_and_b32 s38, s28, 1
    s_bfe_u32 s39, s28, 0x10001
    s_lshr_b32 s40, s28, 2
    s_cmp_ge_u32 s28, 4
    s_cbranch_scc1 L_role1_13
    v_lshrrev_b32 v16, 3, v0
    v_and_b32 v17, 7, v0
    v_xor_b32 v17, v17, v16
    s_mov_b32 s42, 0
    s_mul_i32 s43, s38, 16
    s_add_u32 s42, s42, s43
    s_mul_i32 s43, s39, 32
    s_add_u32 s42, s42, s43
    s_mul_i32 s43, s40, 64
    s_add_u32 s42, s42, s43
    s_mul_i32 s43, s29, 128
    s_add_u32 s42, s42, s43
    v_add_u32 v16, s42, v16
    s_mov_b32 s43, 2048
    v_mul_lo_u32 v16, v16, s43
    v_lshl_add_u32 v3, v17, 4, v16
    v_add_u32 v4, 0x4000, v3
    s_mov_b32 s36, 0
    s_mul_i32 s42, s38, 2048
    s_add_u32 s36, s36, s42
    s_mul_i32 s42, s39, 4096
    s_add_u32 s36, s36, s42
    s_mul_i32 s42, s40, 8192
    s_add_u32 s36, s36, s42
    s_mul_i32 s44, s30, 448
    s_mov_b32 s45, 7168
    v_lshrrev_b32 v16, 3, v0
    v_bfe_u32 v18, v0, 4, 1
    v_lshlrev_b32 v18, 1, v18
    v_and_b32 v17, 7, v0
    v_xor_b32 v17, v17, v18
    v_mul_lo_u32 v16, v16, s45
    s_mov_b32 s42, 0
    s_mul_i32 s43, s38, 57344
    s_add_u32 s42, s42, s43
    s_add_u32 s42, s42, s44
    s_and_b32 s43, s30, 1
    s_cmp_lg_u32 s43, 0
    s_cselect_b32 s43, 64, 0
    s_add_u32 s42, s42, s43
    v_add_u32 v16, s42, v16
    s_lshl_b32 s43, s38, 2
    s_xor_b32 s43, s43, 0
    v_xor_b32 v18, s43, v17
    v_lshl_add_u32 v18, v18, 4, v16
    v_add_u32 v5, 0x0, v18
    s_lshl_b32 s43, s38, 2
    s_xor_b32 s43, s43, 0
    v_xor_b32 v18, s43, v17
    v_lshl_add_u32 v18, v18, 4, v16
    v_add_u32 v6, 0x80, v18
    s_lshl_b32 s43, s38, 2
    s_xor_b32 s43, s43, 0
    v_xor_b32 v18, s43, v17
    v_lshl_add_u32 v18, v18, 4, v16
    v_add_u32 v7, 0x100, v18
    s_mov_b32 s37, 49152
    s_mul_i32 s42, s38, 3072
    s_add_u32 s37, s37, s42
    s_mul_i32 s42, s39, 14336
    s_add_u32 s37, s37, s42
    s_waitcnt lgkmcnt(0)
    s_add_u32 s8, s4, 0xd00000
    s_addc_u32 s9, s5, 0
    s_mov_b32 s10, 0x400000
    s_mov_b32 s11, 0x00020000
    s_cmp_lg_u32 s39, 0
    s_cselect_b32 s6, s60, s6
    s_cselect_b32 s7, s61, s7
    s_mov_b32 s12, s6
    s_mov_b32 s13, s7
    s_mov_b32 s14, 0x700000
    s_mov_b32 s15, 0x00020000
    s_mov_b32 s32, 0
    s_mov_b32 s33, 0
    s_mov_b32 s35, 0
    s_mov_b32 s96, 0
    s_add_u32 s42, s35, s36
    s_add_u32 m0, s42, 0
    s_nop 0
    buffer_load_dwordx4 v3, s[8:11], s32 offen lds
    s_add_u32 s42, s35, s36
    s_add_u32 m0, s42, 1024
    s_nop 0
    buffer_load_dwordx4 v4, s[8:11], s32 offen lds
    s_add_u32 s32, s32, 128
    s_add_u32 s35, s35, 16384
    s_add_u32 s42, s96, s37
    s_add_u32 m0, s42, 0
    s_nop 0
    buffer_load_dwordx4 v5, s[12:15], s33 offen lds
    s_add_u32 s42, s96, s37
    s_add_u32 m0, s42, 1024
    s_nop 0
    buffer_load_dwordx4 v6, s[12:15], s33 offen lds
    s_add_u32 s42, s96, s37
    s_add_u32 m0, s42, 2048
    s_nop 0
    buffer_load_dwordx4 v7, s[12:15], s33 offen lds
    s_add_u32 s33, s33, 229376
    s_add_u32 s96, s96, 28672
    s_add_u32 s42, s96, s37
    s_add_u32 m0, s42, 0
    s_nop 0
    buffer_load_dwordx4 v5, s[12:15], s33 offen lds
    s_add_u32 s42, s96, s37
    s_add_u32 m0, s42, 1024
    s_nop 0
    buffer_load_dwordx4 v6, s[12:15], s33 offen lds
    s_add_u32 s42, s96, s37
    s_add_u32 m0, s42, 2048
    s_nop 0
    buffer_load_dwordx4 v7, s[12:15], s33 offen lds
    s_add_u32 s33, s33, 229376
    s_add_u32 s96, s96, 28672
    s_add_u32 s42, s35, s36
    s_add_u32 m0, s42, 0
    s_nop 0
    buffer_load_dwordx4 v3, s[8:11], s32 offen lds
    s_add_u32 s42, s35, s36
    s_add_u32 m0, s42, 1024
    s_nop 0
    buffer_load_dwordx4 v4, s[8:11], s32 offen lds
    s_add_u32 s32, s32, 128
    s_add_u32 s35, s35, 16384
    s_add_u32 s42, s96, s37
    s_add_u32 m0, s42, 0
    s_nop 0
    buffer_load_dwordx4 v5, s[12:15], s33 offen lds
    s_add_u32 s42, s96, s37
    s_add_u32 m0, s42, 1024
    s_nop 0
    buffer_load_dwordx4 v6, s[12:15], s33 offen lds
    s_add_u32 s42, s96, s37
    s_add_u32 m0, s42, 2048
    s_nop 0
    buffer_load_dwordx4 v7, s[12:15], s33 offen lds
    s_add_u32 s33, s33, 229376
    s_add_u32 s96, s96, 28672
    s_add_u32 s16, s4, 0x1500000
    s_addc_u32 s17, s5, 0
    s_mov_b32 s18, 0xe00000
    s_mov_b32 s19, 0x00020000
    v_and_b32 v16, 7, v0
    v_xor_b32 v16, v16, v2
    v_lshlrev_b32 v16, 4, v16
    v_lshl_add_u32 v16, v1, 7, v16
    s_mov_b32 s42, 0
    s_mul_i32 s43, s38, 8192
    s_add_u32 s42, s42, s43
    v_add_u32 v8, s42, v16
    v_xor_b32 v9, 64, v8
    s_mov_b32 s42, 3072
    v_mul_lo_u32 v16, v2, s42
    v_lshrrev_b32 v18, 2, v1
    v_lshl_add_u32 v16, v18, 7, v16
    v_bfe_u32 v17, v0, 3, 2
    s_mov_b32 s42, 0
    s_mul_i32 s43, s39, 1
    s_add_u32 s42, s42, s43
    v_xor_b32 v17, s42, v17
    v_lshl_add_u32 v16, v17, 5, v16
    v_bfe_u32 v18, v0, 1, 1
    v_lshl_add_u32 v16, v18, 4, v16
    v_and_b32 v18, 1, v0
    v_lshl_add_u32 v16, v18, 3, v16
    s_mov_b32 s42, 49152
    v_add_u32 v10, s42, v16
    v_xor_b32 v11, 64, v10
    s_mov_b32 s34, 0
    s_mov_b32 s41, 0
    v_add_u32 v12, s34, v8
    v_add_u32 v13, s34, v9
    v_add_u32 v14, s41, v10
    v_add_u32 v15, s41, v11
    s_waitcnt vmcnt(8) lgkmcnt(0)
    s_barrier
    ds_read_b128 a[0:3], v12 offset:0
    ds_read_b128 a[4:7], v12 offset:2048
    ds_read_b128 a[8:11], v12 offset:4096
    ds_read_b128 a[12:15], v12 offset:6144
    ds_read_b64_tr_b16 a[16:17], v14 offset:0
    ds_read_b64_tr_b16 a[18:19], v14 offset:512
    ds_read_b64_tr_b16 a[20:21], v15 offset:0
    ds_read_b64_tr_b16 a[22:23], v15 offset:512
    ds_read_b64_tr_b16 a[24:25], v14 offset:1024
    ds_read_b64_tr_b16 a[26:27], v14 offset:1536
    ds_read_b64_tr_b16 a[28:29], v15 offset:1024
    ds_read_b64_tr_b16 a[30:31], v15 offset:1536
    ds_read_b64_tr_b16 a[32:33], v14 offset:14336
    ds_read_b64_tr_b16 a[34:35], v14 offset:14848
    ds_read_b64_tr_b16 a[36:37], v15 offset:14336
    ds_read_b64_tr_b16 a[38:39], v15 offset:14848
    ds_read_b64_tr_b16 a[40:41], v14 offset:15360
    ds_read_b64_tr_b16 a[42:43], v14 offset:15872
    ds_read_b64_tr_b16 a[44:45], v15 offset:15360
    ds_read_b64_tr_b16 a[46:47], v15 offset:15872
    s_add_u32 s42, s35, s36
    s_add_u32 m0, s42, 0
    s_nop 0
    buffer_load_dwordx4 v3, s[8:11], s32 offen lds
    s_add_u32 s42, s35, s36
    s_add_u32 m0, s42, 1024
    s_nop 0
    buffer_load_dwordx4 v4, s[8:11], s32 offen lds
    s_add_u32 s32, s32, 128
    s_add_u32 s42, s96, s37
    s_add_u32 m0, s42, 0
    s_nop 0
    buffer_load_dwordx4 v5, s[12:15], s33 offen lds
    s_add_u32 s42, s96, s37
    s_add_u32 m0, s42, 1024
    s_nop 0
    buffer_load_dwordx4 v6, s[12:15], s33 offen lds
    s_add_u32 s42, s96, s37
    s_add_u32 m0, s42, 2048
    s_nop 0
    buffer_load_dwordx4 v7, s[12:15], s33 offen lds
    s_add_u32 s33, s33, 229376
    s_waitcnt lgkmcnt(0)
    s_mov_b32 s96, s41
    s_add_u32 s41, s41, 28672
    s_cmp_eq_u32 s41, 114688
    s_cselect_b32 s41, 0, s41
    v_add_u32 v14, s41, v10
    v_add_u32 v15, s41, v11
    s_waitcnt vmcnt(10)
    s_barrier
    v_mfma_f32_16x16x32_bf16 v[28:31], a[16:19], a[0:3], 0
    ds_read_b128 a[48:51], v13 offset:0
    v_mfma_f32_16x16x32_bf16 v[32:35], a[16:19], a[4:7], 0
    ds_read_b128 a[52:55], v13 offset:2048
    v_mfma_f32_16x16x32_bf16 v[36:39], a[16:19], a[8:11], 0
    ds_read_b128 a[56:59], v13 offset:4096
    v_mfma_f32_16x16x32_bf16 v[40:43], a[16:19], a[12:15], 0
    ds_read_b128 a[60:63], v13 offset:6144
    v_mfma_f32_16x16x32_bf16 v[44:47], a[20:23], a[0:3], 0
    ds_read_b64_tr_b16 a[64:65], v14 offset:0
    v_mfma_f32_16x16x32_bf16 v[48:51], a[20:23], a[4:7], 0
    ds_read_b64_tr_b16 a[66:67], v14 offset:512
    v_mfma_f32_16x16x32_bf16 v[52:55], a[20:23], a[8:11], 0
    ds_read_b64_tr_b16 a[68:69], v15 offset:0
    v_mfma_f32_16x16x32_bf16 v[56:59], a[20:23], a[12:15], 0
    ds_read_b64_tr_b16 a[70:71], v15 offset:512
    v_mfma_f32_16x16x32_bf16 v[60:63], a[24:27], a[0:3], 0
    v_mfma_f32_16x16x32_bf16 v[64:67], a[24:27], a[4:7], 0
    ds_read_b64_tr_b16 a[72:73], v14 offset:1024
    v_mfma_f32_16x16x32_bf16 v[68:71], a[24:27], a[8:11], 0
    ds_read_b64_tr_b16 a[74:75], v14 offset:1536
    v_mfma_f32_16x16x32_bf16 v[72:75], a[24:27], a[12:15], 0
    ds_read_b64_tr_b16 a[76:77], v15 offset:1024
    v_mfma_f32_16x16x32_bf16 v[76:79], a[28:31], a[0:3], 0
    ds_read_b64_tr_b16 a[78:79], v15 offset:1536
    v_mfma_f32_16x16x32_bf16 v[80:83], a[28:31], a[4:7], 0
    ds_read_b64_tr_b16 a[80:81], v14 offset:14336
    v_mfma_f32_16x16x32_bf16 v[84:87], a[28:31], a[8:11], 0
    ds_read_b64_tr_b16 a[82:83], v14 offset:14848
    v_mfma_f32_16x16x32_bf16 v[88:91], a[28:31], a[12:15], 0
    ds_read_b64_tr_b16 a[84:85], v15 offset:14336
    v_mfma_f32_16x16x32_bf16 v[92:95], a[32:35], a[0:3], 0
    ds_read_b64_tr_b16 a[86:87], v15 offset:14848
    v_mfma_f32_16x16x32_bf16 v[96:99], a[32:35], a[4:7], 0
    v_mfma_f32_16x16x32_bf16 v[100:103], a[32:35], a[8:11], 0
    ds_read_b64_tr_b16 a[88:89], v14 offset:15360
    v_mfma_f32_16x16x32_bf16 v[104:107], a[32:35], a[12:15], 0
    ds_read_b64_tr_b16 a[90:91], v14 offset:15872
    v_mfma_f32_16x16x32_bf16 v[108:111], a[36:39], a[0:3], 0
    ds_read_b64_tr_b16 a[92:93], v15 offset:15360
    v_mfma_f32_16x16x32_bf16 v[112:115], a[36:39], a[4:7], 0
    ds_read_b64_tr_b16 a[94:95], v15 offset:15872
    v_mfma_f32_16x16x32_bf16 v[116:119], a[36:39], a[8:11], 0
    s_add_u32 s42, s96, s37
    s_add_u32 m0, s42, 0
    s_nop 0
    buffer_load_dwordx4 v5, s[12:15], s33 offen lds
    v_mfma_f32_16x16x32_bf16 v[120:123], a[36:39], a[12:15], 0
    s_add_u32 s42, s96, s37
    s_add_u32 m0, s42, 1024
    s_nop 0
    buffer_load_dwordx4 v6, s[12:15], s33 offen lds
    v_mfma_f32_16x16x32_bf16 v[124:127], a[40:43], a[0:3], 0
    s_add_u32 s42, s96, s37
    s_add_u32 m0, s42, 2048
    s_nop 0
    buffer_load_dwordx4 v7, s[12:15], s33 offen lds
    v_mfma_f32_16x16x32_bf16 v[128:131], a[40:43], a[4:7], 0
    s_add_u32 s33, s33, 229376
    v_mfma_f32_16x16x32_bf16 v[132:135], a[40:43], a[8:11], 0
    v_mfma_f32_16x16x32_bf16 v[136:139], a[40:43], a[12:15], 0
    v_mfma_f32_16x16x32_bf16 v[140:143], a[44:47], a[0:3], 0
    v_mfma_f32_16x16x32_bf16 v[144:147], a[44:47], a[4:7], 0
    v_mfma_f32_16x16x32_bf16 v[148:151], a[44:47], a[8:11], 0
    v_mfma_f32_16x16x32_bf16 v[152:155], a[44:47], a[12:15], 0
    s_waitcnt lgkmcnt(0)
    s_mov_b32 s35, s34
    s_add_u32 s34, s34, 16384
    s_cmp_eq_u32 s34, 49152
    s_cselect_b32 s34, 0, s34
    v_add_u32 v12, s34, v8
    v_add_u32 v13, s34, v9
    s_mov_b32 s96, s41
    s_add_u32 s41, s41, 28672
    s_cmp_eq_u32 s41, 114688
    s_cselect_b32 s41, 0, s41
    v_add_u32 v14, s41, v10
    v_add_u32 v15, s41, v11
    s_waitcnt vmcnt(8)
    s_barrier
    v_mfma_f32_16x16x32_bf16 v[28:31], a[64:67], a[48:51], v[28:31]
    ds_read_b128 a[0:3], v12 offset:0
    v_mfma_f32_16x16x32_bf16 v[32:35], a[64:67], a[52:55], v[32:35]
    ds_read_b128 a[4:7], v12 offset:2048
    v_mfma_f32_16x16x32_bf16 v[36:39], a[64:67], a[56:59], v[36:39]
    ds_read_b128 a[8:11], v12 offset:4096
    v_mfma_f32_16x16x32_bf16 v[40:43], a[64:67], a[60:63], v[40:43]
    ds_read_b128 a[12:15], v12 offset:6144
    v_mfma_f32_16x16x32_bf16 v[44:47], a[68:71], a[48:51], v[44:47]
    ds_read_b64_tr_b16 a[16:17], v14 offset:0
    v_mfma_f32_16x16x32_bf16 v[48:51], a[68:71], a[52:55], v[48:51]
    ds_read_b64_tr_b16 a[18:19], v14 offset:512
    v_mfma_f32_16x16x32_bf16 v[52:55], a[68:71], a[56:59], v[52:55]
    ds_read_b64_tr_b16 a[20:21], v15 offset:0
    v_mfma_f32_16x16x32_bf16 v[56:59], a[68:71], a[60:63], v[56:59]
    ds_read_b64_tr_b16 a[22:23], v15 offset:512
    v_mfma_f32_16x16x32_bf16 v[60:63], a[72:75], a[48:51], v[60:63]
    ds_read_b64_tr_b16 a[24:25], v14 offset:1024
    v_mfma_f32_16x16x32_bf16 v[64:67], a[72:75], a[52:55], v[64:67]
    ds_read_b64_tr_b16 a[26:27], v14 offset:1536
    v_mfma_f32_16x16x32_bf16 v[68:71], a[72:75], a[56:59], v[68:71]
    ds_read_b64_tr_b16 a[28:29], v15 offset:1024
    v_mfma_f32_16x16x32_bf16 v[72:75], a[72:75], a[60:63], v[72:75]
    ds_read_b64_tr_b16 a[30:31], v15 offset:1536
    v_mfma_f32_16x16x32_bf16 v[76:79], a[76:79], a[48:51], v[76:79]
    ds_read_b64_tr_b16 a[32:33], v14 offset:14336
    v_mfma_f32_16x16x32_bf16 v[80:83], a[76:79], a[52:55], v[80:83]
    ds_read_b64_tr_b16 a[34:35], v14 offset:14848
    v_mfma_f32_16x16x32_bf16 v[84:87], a[76:79], a[56:59], v[84:87]
    ds_read_b64_tr_b16 a[36:37], v15 offset:14336
    v_mfma_f32_16x16x32_bf16 v[88:91], a[76:79], a[60:63], v[88:91]
    ds_read_b64_tr_b16 a[38:39], v15 offset:14848
    v_mfma_f32_16x16x32_bf16 v[92:95], a[80:83], a[48:51], v[92:95]
    ds_read_b64_tr_b16 a[40:41], v14 offset:15360
    v_mfma_f32_16x16x32_bf16 v[96:99], a[80:83], a[52:55], v[96:99]
    ds_read_b64_tr_b16 a[42:43], v14 offset:15872
    v_mfma_f32_16x16x32_bf16 v[100:103], a[80:83], a[56:59], v[100:103]
    ds_read_b64_tr_b16 a[44:45], v15 offset:15360
    v_mfma_f32_16x16x32_bf16 v[104:107], a[80:83], a[60:63], v[104:107]
    ds_read_b64_tr_b16 a[46:47], v15 offset:15872
    v_mfma_f32_16x16x32_bf16 v[108:111], a[84:87], a[48:51], v[108:111]
    s_add_u32 s42, s96, s37
    s_add_u32 m0, s42, 0
    s_nop 0
    buffer_load_dwordx4 v5, s[12:15], s33 offen lds
    v_mfma_f32_16x16x32_bf16 v[112:115], a[84:87], a[52:55], v[112:115]
    s_add_u32 s42, s96, s37
    s_add_u32 m0, s42, 1024
    s_nop 0
    buffer_load_dwordx4 v6, s[12:15], s33 offen lds
    v_mfma_f32_16x16x32_bf16 v[116:119], a[84:87], a[56:59], v[116:119]
    s_add_u32 s42, s96, s37
    s_add_u32 m0, s42, 2048
    s_nop 0
    buffer_load_dwordx4 v7, s[12:15], s33 offen lds
    v_mfma_f32_16x16x32_bf16 v[120:123], a[84:87], a[60:63], v[120:123]
    s_add_u32 s33, s33, 229376
    v_mfma_f32_16x16x32_bf16 v[124:127], a[88:91], a[48:51], v[124:127]
    s_add_u32 s42, s35, s36
    s_add_u32 m0, s42, 0
    s_nop 0
    buffer_load_dwordx4 v3, s[8:11], s32 offen lds
    v_mfma_f32_16x16x32_bf16 v[128:131], a[88:91], a[52:55], v[128:131]
    s_add_u32 s42, s35, s36
    s_add_u32 m0, s42, 1024
    s_nop 0
    buffer_load_dwordx4 v4, s[8:11], s32 offen lds
    v_mfma_f32_16x16x32_bf16 v[132:135], a[88:91], a[56:59], v[132:135]
    s_add_u32 s32, s32, 128
    v_mfma_f32_16x16x32_bf16 v[136:139], a[88:91], a[60:63], v[136:139]
    v_mfma_f32_16x16x32_bf16 v[140:143], a[92:95], a[48:51], v[140:143]
    v_mfma_f32_16x16x32_bf16 v[144:147], a[92:95], a[52:55], v[144:147]
    v_mfma_f32_16x16x32_bf16 v[148:151], a[92:95], a[56:59], v[148:151]
    v_mfma_f32_16x16x32_bf16 v[152:155], a[92:95], a[60:63], v[152:155]
    s_waitcnt lgkmcnt(0)
    s_mov_b32 s96, s41
    s_add_u32 s41, s41, 28672
    s_cmp_eq_u32 s41, 114688
    s_cselect_b32 s41, 0, s41
    v_add_u32 v14, s41, v10
    v_add_u32 v15, s41, v11
    s_waitcnt vmcnt(8)
    s_barrier
    v_mfma_f32_16x16x32_bf16 v[28:31], a[16:19], a[0:3], v[28:31]
    ds_read_b128 a[48:51], v13 offset:0
    v_mfma_f32_16x16x32_bf16 v[32:35], a[16:19], a[4:7], v[32:35]
    ds_read_b128 a[52:55], v13 offset:2048
    v_mfma_f32_16x16x32_bf16 v[36:39], a[16:19], a[8:11], v[36:39]
    ds_read_b128 a[56:59], v13 offset:4096
    v_mfma_f32_16x16x32_bf16 v[40:43], a[16:19], a[12:15], v[40:43]
    ds_read_b128 a[60:63], v13 offset:6144
    v_mfma_f32_16x16x32_bf16 v[44:47], a[20:23], a[0:3], v[44:47]
    ds_read_b64_tr_b16 a[64:65], v14 offset:0
    v_mfma_f32_16x16x32_bf16 v[48:51], a[20:23], a[4:7], v[48:51]
    ds_read_b64_tr_b16 a[66:67], v14 offset:512
    v_mfma_f32_16x16x32_bf16 v[52:55], a[20:23], a[8:11], v[52:55]
    ds_read_b64_tr_b16 a[68:69], v15 offset:0
    v_mfma_f32_16x16x32_bf16 v[56:59], a[20:23], a[12:15], v[56:59]
    ds_read_b64_tr_b16 a[70:71], v15 offset:512
    v_mfma_f32_16x16x32_bf16 v[60:63], a[24:27], a[0:3], v[60:63]
    v_mfma_f32_16x16x32_bf16 v[64:67], a[24:27], a[4:7], v[64:67]
    ds_read_b64_tr_b16 a[72:73], v14 offset:1024
    v_mfma_f32_16x16x32_bf16 v[68:71], a[24:27], a[8:11], v[68:71]
    ds_read_b64_tr_b16 a[74:75], v14 offset:1536
    v_mfma_f32_16x16x32_bf16 v[72:75], a[24:27], a[12:15], v[72:75]
    ds_read_b64_tr_b16 a[76:77], v15 offset:1024
    v_mfma_f32_16x16x32_bf16 v[76:79], a[28:31], a[0:3], v[76:79]
    ds_read_b64_tr_b16 a[78:79], v15 offset:1536
    v_mfma_f32_16x16x32_bf16 v[80:83], a[28:31], a[4:7], v[80:83]
    ds_read_b64_tr_b16 a[80:81], v14 offset:14336
    v_mfma_f32_16x16x32_bf16 v[84:87], a[28:31], a[8:11], v[84:87]
    ds_read_b64_tr_b16 a[82:83], v14 offset:14848
    v_mfma_f32_16x16x32_bf16 v[88:91], a[28:31], a[12:15], v[88:91]
    ds_read_b64_tr_b16 a[84:85], v15 offset:14336
    v_mfma_f32_16x16x32_bf16 v[92:95], a[32:35], a[0:3], v[92:95]
    ds_read_b64_tr_b16 a[86:87], v15 offset:14848
    v_mfma_f32_16x16x32_bf16 v[96:99], a[32:35], a[4:7], v[96:99]
    v_mfma_f32_16x16x32_bf16 v[100:103], a[32:35], a[8:11], v[100:103]
    ds_read_b64_tr_b16 a[88:89], v14 offset:15360
    v_mfma_f32_16x16x32_bf16 v[104:107], a[32:35], a[12:15], v[104:107]
    ds_read_b64_tr_b16 a[90:91], v14 offset:15872
    v_mfma_f32_16x16x32_bf16 v[108:111], a[36:39], a[0:3], v[108:111]
    ds_read_b64_tr_b16 a[92:93], v15 offset:15360
    v_mfma_f32_16x16x32_bf16 v[112:115], a[36:39], a[4:7], v[112:115]
    ds_read_b64_tr_b16 a[94:95], v15 offset:15872
    v_mfma_f32_16x16x32_bf16 v[116:119], a[36:39], a[8:11], v[116:119]
    s_add_u32 s42, s96, s37
    s_add_u32 m0, s42, 0
    s_nop 0
    buffer_load_dwordx4 v5, s[12:15], s33 offen lds
    v_mfma_f32_16x16x32_bf16 v[120:123], a[36:39], a[12:15], v[120:123]
    s_add_u32 s42, s96, s37
    s_add_u32 m0, s42, 1024
    s_nop 0
    buffer_load_dwordx4 v6, s[12:15], s33 offen lds
    v_mfma_f32_16x16x32_bf16 v[124:127], a[40:43], a[0:3], v[124:127]
    s_add_u32 s42, s96, s37
    s_add_u32 m0, s42, 2048
    s_nop 0
    buffer_load_dwordx4 v7, s[12:15], s33 offen lds
    v_mfma_f32_16x16x32_bf16 v[128:131], a[40:43], a[4:7], v[128:131]
    s_add_u32 s33, s33, 229376
    v_mfma_f32_16x16x32_bf16 v[132:135], a[40:43], a[8:11], v[132:135]
    v_mfma_f32_16x16x32_bf16 v[136:139], a[40:43], a[12:15], v[136:139]
    v_mfma_f32_16x16x32_bf16 v[140:143], a[44:47], a[0:3], v[140:143]
    v_mfma_f32_16x16x32_bf16 v[144:147], a[44:47], a[4:7], v[144:147]
    v_mfma_f32_16x16x32_bf16 v[148:151], a[44:47], a[8:11], v[148:151]
    v_mfma_f32_16x16x32_bf16 v[152:155], a[44:47], a[12:15], v[152:155]
    s_waitcnt lgkmcnt(0)
    s_mov_b32 s35, s34
    s_add_u32 s34, s34, 16384
    s_cmp_eq_u32 s34, 49152
    s_cselect_b32 s34, 0, s34
    v_add_u32 v12, s34, v8
    v_add_u32 v13, s34, v9
    s_mov_b32 s96, s41
    s_add_u32 s41, s41, 28672
    s_cmp_eq_u32 s41, 114688
    s_cselect_b32 s41, 0, s41
    v_add_u32 v14, s41, v10
    v_add_u32 v15, s41, v11
    s_waitcnt vmcnt(8)
    s_barrier
    v_mfma_f32_16x16x32_bf16 v[28:31], a[64:67], a[48:51], v[28:31]
    ds_read_b128 a[0:3], v12 offset:0
    v_mfma_f32_16x16x32_bf16 v[32:35], a[64:67], a[52:55], v[32:35]
    ds_read_b128 a[4:7], v12 offset:2048
    v_mfma_f32_16x16x32_bf16 v[36:39], a[64:67], a[56:59], v[36:39]
    ds_read_b128 a[8:11], v12 offset:4096
    v_mfma_f32_16x16x32_bf16 v[40:43], a[64:67], a[60:63], v[40:43]
    ds_read_b128 a[12:15], v12 offset:6144
    v_mfma_f32_16x16x32_bf16 v[44:47], a[68:71], a[48:51], v[44:47]
    ds_read_b64_tr_b16 a[16:17], v14 offset:0
    v_mfma_f32_16x16x32_bf16 v[48:51], a[68:71], a[52:55], v[48:51]
    ds_read_b64_tr_b16 a[18:19], v14 offset:512
    v_mfma_f32_16x16x32_bf16 v[52:55], a[68:71], a[56:59], v[52:55]
    ds_read_b64_tr_b16 a[20:21], v15 offset:0
    v_mfma_f32_16x16x32_bf16 v[56:59], a[68:71], a[60:63], v[56:59]
    ds_read_b64_tr_b16 a[22:23], v15 offset:512
    v_mfma_f32_16x16x32_bf16 v[60:63], a[72:75], a[48:51], v[60:63]
    ds_read_b64_tr_b16 a[24:25], v14 offset:1024
    v_mfma_f32_16x16x32_bf16 v[64:67], a[72:75], a[52:55], v[64:67]
    ds_read_b64_tr_b16 a[26:27], v14 offset:1536
    v_mfma_f32_16x16x32_bf16 v[68:71], a[72:75], a[56:59], v[68:71]
    ds_read_b64_tr_b16 a[28:29], v15 offset:1024
    v_mfma_f32_16x16x32_bf16 v[72:75], a[72:75], a[60:63], v[72:75]
    ds_read_b64_tr_b16 a[30:31], v15 offset:1536
    v_mfma_f32_16x16x32_bf16 v[76:79], a[76:79], a[48:51], v[76:79]
    ds_read_b64_tr_b16 a[32:33], v14 offset:14336
    v_mfma_f32_16x16x32_bf16 v[80:83], a[76:79], a[52:55], v[80:83]
    ds_read_b64_tr_b16 a[34:35], v14 offset:14848
    v_mfma_f32_16x16x32_bf16 v[84:87], a[76:79], a[56:59], v[84:87]
    ds_read_b64_tr_b16 a[36:37], v15 offset:14336
    v_mfma_f32_16x16x32_bf16 v[88:91], a[76:79], a[60:63], v[88:91]
    ds_read_b64_tr_b16 a[38:39], v15 offset:14848
    v_mfma_f32_16x16x32_bf16 v[92:95], a[80:83], a[48:51], v[92:95]
    ds_read_b64_tr_b16 a[40:41], v14 offset:15360
    v_mfma_f32_16x16x32_bf16 v[96:99], a[80:83], a[52:55], v[96:99]
    ds_read_b64_tr_b16 a[42:43], v14 offset:15872
    v_mfma_f32_16x16x32_bf16 v[100:103], a[80:83], a[56:59], v[100:103]
    ds_read_b64_tr_b16 a[44:45], v15 offset:15360
    v_mfma_f32_16x16x32_bf16 v[104:107], a[80:83], a[60:63], v[104:107]
    ds_read_b64_tr_b16 a[46:47], v15 offset:15872
    v_mfma_f32_16x16x32_bf16 v[108:111], a[84:87], a[48:51], v[108:111]
    s_add_u32 s42, s96, s37
    s_add_u32 m0, s42, 0
    s_nop 0
    buffer_load_dwordx4 v5, s[12:15], s33 offen lds
    v_mfma_f32_16x16x32_bf16 v[112:115], a[84:87], a[52:55], v[112:115]
    s_add_u32 s42, s96, s37
    s_add_u32 m0, s42, 1024
    s_nop 0
    buffer_load_dwordx4 v6, s[12:15], s33 offen lds
    v_mfma_f32_16x16x32_bf16 v[116:119], a[84:87], a[56:59], v[116:119]
    s_add_u32 s42, s96, s37
    s_add_u32 m0, s42, 2048
    s_nop 0
    buffer_load_dwordx4 v7, s[12:15], s33 offen lds
    v_mfma_f32_16x16x32_bf16 v[120:123], a[84:87], a[60:63], v[120:123]
    s_add_u32 s33, s33, 229376
    v_mfma_f32_16x16x32_bf16 v[124:127], a[88:91], a[48:51], v[124:127]
    s_add_u32 s42, s35, s36
    s_add_u32 m0, s42, 0
    s_nop 0
    buffer_load_dwordx4 v3, s[8:11], s32 offen lds
    v_mfma_f32_16x16x32_bf16 v[128:131], a[88:91], a[52:55], v[128:131]
    s_add_u32 s42, s35, s36
    s_add_u32 m0, s42, 1024
    s_nop 0
    buffer_load_dwordx4 v4, s[8:11], s32 offen lds
    v_mfma_f32_16x16x32_bf16 v[132:135], a[88:91], a[56:59], v[132:135]
    s_add_u32 s32, s32, 128
    v_mfma_f32_16x16x32_bf16 v[136:139], a[88:91], a[60:63], v[136:139]
    v_mfma_f32_16x16x32_bf16 v[140:143], a[92:95], a[48:51], v[140:143]
    v_mfma_f32_16x16x32_bf16 v[144:147], a[92:95], a[52:55], v[144:147]
    v_mfma_f32_16x16x32_bf16 v[148:151], a[92:95], a[56:59], v[148:151]
    v_mfma_f32_16x16x32_bf16 v[152:155], a[92:95], a[60:63], v[152:155]
    s_waitcnt lgkmcnt(0)
    s_mov_b32 s31, 6
L_loop_14:
    s_mov_b32 s96, s41
    s_add_u32 s41, s41, 28672
    s_cmp_eq_u32 s41, 114688
    s_cselect_b32 s41, 0, s41
    v_add_u32 v14, s41, v10
    v_add_u32 v15, s41, v11
    s_waitcnt vmcnt(10)
    s_barrier
    v_mfma_f32_16x16x32_bf16 v[28:31], a[16:19], a[0:3], v[28:31]
    ds_read_b128 a[48:51], v13 offset:0
    v_mfma_f32_16x16x32_bf16 v[32:35], a[16:19], a[4:7], v[32:35]
    ds_read_b128 a[52:55], v13 offset:2048
    v_mfma_f32_16x16x32_bf16 v[36:39], a[16:19], a[8:11], v[36:39]
    ds_read_b128 a[56:59], v13 offset:4096
    v_mfma_f32_16x16x32_bf16 v[40:43], a[16:19], a[12:15], v[40:43]
    ds_read_b128 a[60:63], v13 offset:6144
    v_mfma_f32_16x16x32_bf16 v[44:47], a[20:23], a[0:3], v[44:47]
    ds_read_b64_tr_b16 a[64:65], v14 offset:0
    v_mfma_f32_16x16x32_bf16 v[48:51], a[20:23], a[4:7], v[48:51]
    ds_read_b64_tr_b16 a[66:67], v14 offset:512
    v_mfma_f32_16x16x32_bf16 v[52:55], a[20:23], a[8:11], v[52:55]
    ds_read_b64_tr_b16 a[68:69], v15 offset:0
    v_mfma_f32_16x16x32_bf16 v[56:59], a[20:23], a[12:15], v[56:59]
    ds_read_b64_tr_b16 a[70:71], v15 offset:512
    v_mfma_f32_16x16x32_bf16 v[60:63], a[24:27], a[0:3], v[60:63]
    v_mfma_f32_16x16x32_bf16 v[64:67], a[24:27], a[4:7], v[64:67]
    ds_read_b64_tr_b16 a[72:73], v14 offset:1024
    v_mfma_f32_16x16x32_bf16 v[68:71], a[24:27], a[8:11], v[68:71]
    ds_read_b64_tr_b16 a[74:75], v14 offset:1536
    v_mfma_f32_16x16x32_bf16 v[72:75], a[24:27], a[12:15], v[72:75]
    ds_read_b64_tr_b16 a[76:77], v15 offset:1024
    v_mfma_f32_16x16x32_bf16 v[76:79], a[28:31], a[0:3], v[76:79]
    ds_read_b64_tr_b16 a[78:79], v15 offset:1536
    v_mfma_f32_16x16x32_bf16 v[80:83], a[28:31], a[4:7], v[80:83]
    ds_read_b64_tr_b16 a[80:81], v14 offset:14336
    v_mfma_f32_16x16x32_bf16 v[84:87], a[28:31], a[8:11], v[84:87]
    ds_read_b64_tr_b16 a[82:83], v14 offset:14848
    v_mfma_f32_16x16x32_bf16 v[88:91], a[28:31], a[12:15], v[88:91]
    ds_read_b64_tr_b16 a[84:85], v15 offset:14336
    v_mfma_f32_16x16x32_bf16 v[92:95], a[32:35], a[0:3], v[92:95]
    ds_read_b64_tr_b16 a[86:87], v15 offset:14848
    v_mfma_f32_16x16x32_bf16 v[96:99], a[32:35], a[4:7], v[96:99]
    v_mfma_f32_16x16x32_bf16 v[100:103], a[32:35], a[8:11], v[100:103]
    ds_read_b64_tr_b16 a[88:89], v14 offset:15360
    v_mfma_f32_16x16x32_bf16 v[104:107], a[32:35], a[12:15], v[104:107]
    ds_read_b64_tr_b16 a[90:91], v14 offset:15872
    v_mfma_f32_16x16x32_bf16 v[108:111], a[36:39], a[0:3], v[108:111]
    ds_read_b64_tr_b16 a[92:93], v15 offset:15360
    v_mfma_f32_16x16x32_bf16 v[112:115], a[36:39], a[4:7], v[112:115]
    ds_read_b64_tr_b16 a[94:95], v15 offset:15872
    v_mfma_f32_16x16x32_bf16 v[116:119], a[36:39], a[8:11], v[116:119]
    s_add_u32 s42, s96, s37
    s_add_u32 m0, s42, 0
    s_nop 0
    buffer_load_dwordx4 v5, s[12:15], s33 offen lds
    v_mfma_f32_16x16x32_bf16 v[120:123], a[36:39], a[12:15], v[120:123]
    s_add_u32 s42, s96, s37
    s_add_u32 m0, s42, 1024
    s_nop 0
    buffer_load_dwordx4 v6, s[12:15], s33 offen lds
    v_mfma_f32_16x16x32_bf16 v[124:127], a[40:43], a[0:3], v[124:127]
    s_add_u32 s42, s96, s37
    s_add_u32 m0, s42, 2048
    s_nop 0
    buffer_load_dwordx4 v7, s[12:15], s33 offen lds
    v_mfma_f32_16x16x32_bf16 v[128:131], a[40:43], a[4:7], v[128:131]
    s_add_u32 s33, s33, 229376
    v_mfma_f32_16x16x32_bf16 v[132:135], a[40:43], a[8:11], v[132:135]
    v_mfma_f32_16x16x32_bf16 v[136:139], a[40:43], a[12:15], v[136:139]
    v_mfma_f32_16x16x32_bf16 v[140:143], a[44:47], a[0:3], v[140:143]
    v_mfma_f32_16x16x32_bf16 v[144:147], a[44:47], a[4:7], v[144:147]
    v_mfma_f32_16x16x32_bf16 v[148:151], a[44:47], a[8:11], v[148:151]
    v_mfma_f32_16x16x32_bf16 v[152:155], a[44:47], a[12:15], v[152:155]
    s_waitcnt lgkmcnt(0)
    s_mov_b32 s35, s34
    s_add_u32 s34, s34, 16384
    s_cmp_eq_u32 s34, 49152
    s_cselect_b32 s34, 0, s34
    v_add_u32 v12, s34, v8
    v_add_u32 v13, s34, v9
    s_mov_b32 s96, s41
    s_add_u32 s41, s41, 28672
    s_cmp_eq_u32 s41, 114688
    s_cselect_b32 s41, 0, s41
    v_add_u32 v14, s41, v10
    v_add_u32 v15, s41, v11
    s_waitcnt vmcnt(8)
    s_barrier
    v_mfma_f32_16x16x32_bf16 v[28:31], a[64:67], a[48:51], v[28:31]
    ds_read_b128 a[0:3], v12 offset:0
    v_mfma_f32_16x16x32_bf16 v[32:35], a[64:67], a[52:55], v[32:35]
    ds_read_b128 a[4:7], v12 offset:2048
    v_mfma_f32_16x16x32_bf16 v[36:39], a[64:67], a[56:59], v[36:39]
    ds_read_b128 a[8:11], v12 offset:4096
    v_mfma_f32_16x16x32_bf16 v[40:43], a[64:67], a[60:63], v[40:43]
    ds_read_b128 a[12:15], v12 offset:6144
    v_mfma_f32_16x16x32_bf16 v[44:47], a[68:71], a[48:51], v[44:47]
    ds_read_b64_tr_b16 a[16:17], v14 offset:0
    v_mfma_f32_16x16x32_bf16 v[48:51], a[68:71], a[52:55], v[48:51]
    ds_read_b64_tr_b16 a[18:19], v14 offset:512
    v_mfma_f32_16x16x32_bf16 v[52:55], a[68:71], a[56:59], v[52:55]
    ds_read_b64_tr_b16 a[20:21], v15 offset:0
    v_mfma_f32_16x16x32_bf16 v[56:59], a[68:71], a[60:63], v[56:59]
    ds_read_b64_tr_b16 a[22:23], v15 offset:512
    v_mfma_f32_16x16x32_bf16 v[60:63], a[72:75], a[48:51], v[60:63]
    ds_read_b64_tr_b16 a[24:25], v14 offset:1024
    v_mfma_f32_16x16x32_bf16 v[64:67], a[72:75], a[52:55], v[64:67]
    ds_read_b64_tr_b16 a[26:27], v14 offset:1536
    v_mfma_f32_16x16x32_bf16 v[68:71], a[72:75], a[56:59], v[68:71]
    ds_read_b64_tr_b16 a[28:29], v15 offset:1024
    v_mfma_f32_16x16x32_bf16 v[72:75], a[72:75], a[60:63], v[72:75]
    ds_read_b64_tr_b16 a[30:31], v15 offset:1536
    v_mfma_f32_16x16x32_bf16 v[76:79], a[76:79], a[48:51], v[76:79]
    ds_read_b64_tr_b16 a[32:33], v14 offset:14336
    v_mfma_f32_16x16x32_bf16 v[80:83], a[76:79], a[52:55], v[80:83]
    ds_read_b64_tr_b16 a[34:35], v14 offset:14848
    v_mfma_f32_16x16x32_bf16 v[84:87], a[76:79], a[56:59], v[84:87]
    ds_read_b64_tr_b16 a[36:37], v15 offset:14336
    v_mfma_f32_16x16x32_bf16 v[88:91], a[76:79], a[60:63], v[88:91]
    ds_read_b64_tr_b16 a[38:39], v15 offset:14848
    v_mfma_f32_16x16x32_bf16 v[92:95], a[80:83], a[48:51], v[92:95]
    ds_read_b64_tr_b16 a[40:41], v14 offset:15360
    v_mfma_f32_16x16x32_bf16 v[96:99], a[80:83], a[52:55], v[96:99]
    ds_read_b64_tr_b16 a[42:43], v14 offset:15872
    v_mfma_f32_16x16x32_bf16 v[100:103], a[80:83], a[56:59], v[100:103]
    ds_read_b64_tr_b16 a[44:45], v15 offset:15360
    v_mfma_f32_16x16x32_bf16 v[104:107], a[80:83], a[60:63], v[104:107]
    ds_read_b64_tr_b16 a[46:47], v15 offset:15872
    v_mfma_f32_16x16x32_bf16 v[108:111], a[84:87], a[48:51], v[108:111]
    s_add_u32 s42, s96, s37
    s_add_u32 m0, s42, 0
    s_nop 0
    buffer_load_dwordx4 v5, s[12:15], s33 offen lds
    v_mfma_f32_16x16x32_bf16 v[112:115], a[84:87], a[52:55], v[112:115]
    s_add_u32 s42, s96, s37
    s_add_u32 m0, s42, 1024
    s_nop 0
    buffer_load_dwordx4 v6, s[12:15], s33 offen lds
    v_mfma_f32_16x16x32_bf16 v[116:119], a[84:87], a[56:59], v[116:119]
    s_add_u32 s42, s96, s37
    s_add_u32 m0, s42, 2048
    s_nop 0
    buffer_load_dwordx4 v7, s[12:15], s33 offen lds
    v_mfma_f32_16x16x32_bf16 v[120:123], a[84:87], a[60:63], v[120:123]
    s_add_u32 s33, s33, 229376
    v_mfma_f32_16x16x32_bf16 v[124:127], a[88:91], a[48:51], v[124:127]
    s_add_u32 s42, s35, s36
    s_add_u32 m0, s42, 0
    s_nop 0
    buffer_load_dwordx4 v3, s[8:11], s32 offen lds
    v_mfma_f32_16x16x32_bf16 v[128:131], a[88:91], a[52:55], v[128:131]
    s_add_u32 s42, s35, s36
    s_add_u32 m0, s42, 1024
    s_nop 0
    buffer_load_dwordx4 v4, s[8:11], s32 offen lds
    v_mfma_f32_16x16x32_bf16 v[132:135], a[88:91], a[56:59], v[132:135]
    s_add_u32 s32, s32, 128
    v_mfma_f32_16x16x32_bf16 v[136:139], a[88:91], a[60:63], v[136:139]
    v_mfma_f32_16x16x32_bf16 v[140:143], a[92:95], a[48:51], v[140:143]
    v_mfma_f32_16x16x32_bf16 v[144:147], a[92:95], a[52:55], v[144:147]
    v_mfma_f32_16x16x32_bf16 v[148:151], a[92:95], a[56:59], v[148:151]
    v_mfma_f32_16x16x32_bf16 v[152:155], a[92:95], a[60:63], v[152:155]
    s_waitcnt lgkmcnt(0)
    s_sub_u32 s31, s31, 1
    s_cmp_lg_u32 s31, 0
    s_cbranch_scc1 L_loop_14
    s_mov_b32 s96, s41
    s_add_u32 s41, s41, 28672
    s_cmp_eq_u32 s41, 114688
    s_cselect_b32 s41, 0, s41
    v_add_u32 v14, s41, v10
    v_add_u32 v15, s41, v11
    s_waitcnt vmcnt(10)
    s_barrier
    v_mfma_f32_16x16x32_bf16 v[28:31], a[16:19], a[0:3], v[28:31]
    ds_read_b128 a[48:51], v13 offset:0
    v_mfma_f32_16x16x32_bf16 v[32:35], a[16:19], a[4:7], v[32:35]
    ds_read_b128 a[52:55], v13 offset:2048
    v_mfma_f32_16x16x32_bf16 v[36:39], a[16:19], a[8:11], v[36:39]
    ds_read_b128 a[56:59], v13 offset:4096
    v_mfma_f32_16x16x32_bf16 v[40:43], a[16:19], a[12:15], v[40:43]
    ds_read_b128 a[60:63], v13 offset:6144
    v_mfma_f32_16x16x32_bf16 v[44:47], a[20:23], a[0:3], v[44:47]
    ds_read_b64_tr_b16 a[64:65], v14 offset:0
    v_mfma_f32_16x16x32_bf16 v[48:51], a[20:23], a[4:7], v[48:51]
    ds_read_b64_tr_b16 a[66:67], v14 offset:512
    v_mfma_f32_16x16x32_bf16 v[52:55], a[20:23], a[8:11], v[52:55]
    ds_read_b64_tr_b16 a[68:69], v15 offset:0
    v_mfma_f32_16x16x32_bf16 v[56:59], a[20:23], a[12:15], v[56:59]
    ds_read_b64_tr_b16 a[70:71], v15 offset:512
    v_mfma_f32_16x16x32_bf16 v[60:63], a[24:27], a[0:3], v[60:63]
    ds_read_b64_tr_b16 a[72:73], v14 offset:1024
    v_mfma_f32_16x16x32_bf16 v[64:67], a[24:27], a[4:7], v[64:67]
    ds_read_b64_tr_b16 a[74:75], v14 offset:1536
    v_mfma_f32_16x16x32_bf16 v[68:71], a[24:27], a[8:11], v[68:71]
    ds_read_b64_tr_b16 a[76:77], v15 offset:1024
    v_mfma_f32_16x16x32_bf16 v[72:75], a[24:27], a[12:15], v[72:75]
    ds_read_b64_tr_b16 a[78:79], v15 offset:1536
    v_mfma_f32_16x16x32_bf16 v[76:79], a[28:31], a[0:3], v[76:79]
    ds_read_b64_tr_b16 a[80:81], v14 offset:14336
    v_mfma_f32_16x16x32_bf16 v[80:83], a[28:31], a[4:7], v[80:83]
    v_mfma_f32_16x16x32_bf16 v[84:87], a[28:31], a[8:11], v[84:87]
    ds_read_b64_tr_b16 a[82:83], v14 offset:14848
    v_mfma_f32_16x16x32_bf16 v[88:91], a[28:31], a[12:15], v[88:91]
    ds_read_b64_tr_b16 a[84:85], v15 offset:14336
    v_mfma_f32_16x16x32_bf16 v[92:95], a[32:35], a[0:3], v[92:95]
    ds_read_b64_tr_b16 a[86:87], v15 offset:14848
    v_mfma_f32_16x16x32_bf16 v[96:99], a[32:35], a[4:7], v[96:99]
    ds_read_b64_tr_b16 a[88:89], v14 offset:15360
    v_mfma_f32_16x16x32_bf16 v[100:103], a[32:35], a[8:11], v[100:103]
    ds_read_b64_tr_b16 a[90:91], v14 offset:15872
    v_mfma_f32_16x16x32_bf16 v[104:107], a[32:35], a[12:15], v[104:107]
    ds_read_b64_tr_b16 a[92:93], v15 offset:15360
    v_mfma_f32_16x16x32_bf16 v[108:111], a[36:39], a[0:3], v[108:111]
    ds_read_b64_tr_b16 a[94:95], v15 offset:15872
    v_mfma_f32_16x16x32_bf16 v[112:115], a[36:39], a[4:7], v[112:115]
    s_add_u32 s42, s96, s37
    s_add_u32 m0, s42, 0
    s_nop 0
    buffer_load_dwordx4 v5, s[12:15], s33 offen lds
    v_mfma_f32_16x16x32_bf16 v[116:119], a[36:39], a[8:11], v[116:119]
    s_add_u32 s42, s96, s37
    s_add_u32 m0, s42, 1024
    s_nop 0
    buffer_load_dwordx4 v6, s[12:15], s33 offen lds
    v_mfma_f32_16x16x32_bf16 v[120:123], a[36:39], a[12:15], v[120:123]
    s_add_u32 s42, s96, s37
    s_add_u32 m0, s42, 2048
    s_nop 0
    buffer_load_dwordx4 v7, s[12:15], s33 offen lds
    v_mfma_f32_16x16x32_bf16 v[124:127], a[40:43], a[0:3], v[124:127]
    s_add_u32 s33, s33, 229376
    v_mfma_f32_16x16x32_bf16 v[128:131], a[40:43], a[4:7], v[128:131]
    s_mov_b32 s88, s82
    s_mov_b32 s89, s83
    s_mov_b32 s90, 0x700000
    s_mov_b32 s91, 0x00020000
    s_mul_i32 s98, s2, 8
    s_add_u32 s98, s98, s28
    s_mul_i32 s98, s98, 4096
    v_lshlrev_b32 v16, 6, v0
    buffer_load_dword v17, v16, s[88:91], s98 offen
    s_add_u32 s98, s98, 4096
    v_mfma_f32_16x16x32_bf16 v[132:135], a[40:43], a[8:11], v[132:135]
    v_mfma_f32_16x16x32_bf16 v[136:139], a[40:43], a[12:15], v[136:139]
    v_mfma_f32_16x16x32_bf16 v[140:143], a[44:47], a[0:3], v[140:143]
    v_mfma_f32_16x16x32_bf16 v[144:147], a[44:47], a[4:7], v[144:147]
    v_mfma_f32_16x16x32_bf16 v[148:151], a[44:47], a[8:11], v[148:151]
    v_mfma_f32_16x16x32_bf16 v[152:155], a[44:47], a[12:15], v[152:155]
    s_waitcnt lgkmcnt(0)
    s_mov_b32 s35, s34
    s_add_u32 s34, s34, 16384
    s_cmp_eq_u32 s34, 49152
    s_cselect_b32 s34, 0, s34
    v_add_u32 v12, s34, v8
    v_add_u32 v13, s34, v9
    s_mov_b32 s96, s41
    s_add_u32 s41, s41, 28672
    s_cmp_eq_u32 s41, 114688
    s_cselect_b32 s41, 0, s41
    v_add_u32 v14, s41, v10
    v_add_u32 v15, s41, v11
    s_waitcnt vmcnt(9)
    s_barrier
    v_mfma_f32_16x16x32_bf16 v[28:31], a[64:67], a[48:51], v[28:31]
    ds_read_b128 a[0:3], v12 offset:0
    v_mfma_f32_16x16x32_bf16 v[32:35], a[64:67], a[52:55], v[32:35]
    ds_read_b128 a[4:7], v12 offset:2048
    v_mfma_f32_16x16x32_bf16 v[36:39], a[64:67], a[56:59], v[36:39]
    ds_read_b128 a[8:11], v12 offset:4096
    v_mfma_f32_16x16x32_bf16 v[40:43], a[64:67], a[60:63], v[40:43]
    ds_read_b128 a[12:15], v12 offset:6144
    v_mfma_f32_16x16x32_bf16 v[44:47], a[68:71], a[48:51], v[44:47]
    ds_read_b64_tr_b16 a[16:17], v14 offset:0
    v_mfma_f32_16x16x32_bf16 v[48:51], a[68:71], a[52:55], v[48:51]
    ds_read_b64_tr_b16 a[18:19], v14 offset:512
    v_mfma_f32_16x16x32_bf16 v[52:55], a[68:71], a[56:59], v[52:55]
    ds_read_b64_tr_b16 a[20:21], v15 offset:0
    v_mfma_f32_16x16x32_bf16 v[56:59], a[68:71], a[60:63], v[56:59]
    ds_read_b64_tr_b16 a[22:23], v15 offset:512
    v_mfma_f32_16x16x32_bf16 v[60:63], a[72:75], a[48:51], v[60:63]
    ds_read_b64_tr_b16 a[24:25], v14 offset:1024
    v_mfma_f32_16x16x32_bf16 v[64:67], a[72:75], a[52:55], v[64:67]
    ds_read_b64_tr_b16 a[26:27], v14 offset:1536
    v_mfma_f32_16x16x32_bf16 v[68:71], a[72:75], a[56:59], v[68:71]
    ds_read_b64_tr_b16 a[28:29], v15 offset:1024
    v_mfma_f32_16x16x32_bf16 v[72:75], a[72:75], a[60:63], v[72:75]
    ds_read_b64_tr_b16 a[30:31], v15 offset:1536
    v_mfma_f32_16x16x32_bf16 v[76:79], a[76:79], a[48:51], v[76:79]
    ds_read_b64_tr_b16 a[32:33], v14 offset:14336
    v_mfma_f32_16x16x32_bf16 v[80:83], a[76:79], a[52:55], v[80:83]
    ds_read_b64_tr_b16 a[34:35], v14 offset:14848
    v_mfma_f32_16x16x32_bf16 v[84:87], a[76:79], a[56:59], v[84:87]
    ds_read_b64_tr_b16 a[36:37], v15 offset:14336
    v_mfma_f32_16x16x32_bf16 v[88:91], a[76:79], a[60:63], v[88:91]
    ds_read_b64_tr_b16 a[38:39], v15 offset:14848
    v_mfma_f32_16x16x32_bf16 v[92:95], a[80:83], a[48:51], v[92:95]
    ds_read_b64_tr_b16 a[40:41], v14 offset:15360
    v_mfma_f32_16x16x32_bf16 v[96:99], a[80:83], a[52:55], v[96:99]
    ds_read_b64_tr_b16 a[42:43], v14 offset:15872
    v_mfma_f32_16x16x32_bf16 v[100:103], a[80:83], a[56:59], v[100:103]
    ds_read_b64_tr_b16 a[44:45], v15 offset:15360
    v_mfma_f32_16x16x32_bf16 v[104:107], a[80:83], a[60:63], v[104:107]
    ds_read_b64_tr_b16 a[46:47], v15 offset:15872
    v_mfma_f32_16x16x32_bf16 v[108:111], a[84:87], a[48:51], v[108:111]
    s_add_u32 s42, s96, s37
    s_add_u32 m0, s42, 0
    s_nop 0
    buffer_load_dwordx4 v5, s[12:15], s33 offen lds
    v_mfma_f32_16x16x32_bf16 v[112:115], a[84:87], a[52:55], v[112:115]
    s_add_u32 s42, s96, s37
    s_add_u32 m0, s42, 1024
    s_nop 0
    buffer_load_dwordx4 v6, s[12:15], s33 offen lds
    v_mfma_f32_16x16x32_bf16 v[116:119], a[84:87], a[56:59], v[116:119]
    s_add_u32 s42, s96, s37
    s_add_u32 m0, s42, 2048
    s_nop 0
    buffer_load_dwordx4 v7, s[12:15], s33 offen lds
    v_mfma_f32_16x16x32_bf16 v[120:123], a[84:87], a[60:63], v[120:123]
    s_add_u32 s33, s33, 229376
    v_mfma_f32_16x16x32_bf16 v[124:127], a[88:91], a[48:51], v[124:127]
    s_add_u32 s42, s35, s36
    s_add_u32 m0, s42, 0
    s_nop 0
    buffer_load_dwordx4 v3, s[8:11], s32 offen lds
    v_mfma_f32_16x16x32_bf16 v[128:131], a[88:91], a[52:55], v[128:131]
    s_add_u32 s42, s35, s36
    s_add_u32 m0, s42, 1024
    s_nop 0
    buffer_load_dwordx4 v4, s[8:11], s32 offen lds
    v_mfma_f32_16x16x32_bf16 v[132:135], a[88:91], a[56:59], v[132:135]
    s_add_u32 s32, s32, 128
    v_mfma_f32_16x16x32_bf16 v[136:139], a[88:91], a[60:63], v[136:139]
    v_mfma_f32_16x16x32_bf16 v[140:143], a[92:95], a[48:51], v[140:143]
    v_mfma_f32_16x16x32_bf16 v[144:147], a[92:95], a[52:55], v[144:147]
    v_mfma_f32_16x16x32_bf16 v[148:151], a[92:95], a[56:59], v[148:151]
    v_mfma_f32_16x16x32_bf16 v[152:155], a[92:95], a[60:63], v[152:155]
    s_waitcnt lgkmcnt(0)
    s_mov_b32 s96, s41
    s_add_u32 s41, s41, 28672
    s_cmp_eq_u32 s41, 114688
    s_cselect_b32 s41, 0, s41
    v_add_u32 v14, s41, v10
    v_add_u32 v15, s41, v11
    s_waitcnt vmcnt(11)
    s_barrier
    v_mfma_f32_16x16x32_bf16 v[28:31], a[16:19], a[0:3], v[28:31]
    ds_read_b128 a[48:51], v13 offset:0
    v_mfma_f32_16x16x32_bf16 v[32:35], a[16:19], a[4:7], v[32:35]
    ds_read_b128 a[52:55], v13 offset:2048
    v_mfma_f32_16x16x32_bf16 v[36:39], a[16:19], a[8:11], v[36:39]
    ds_read_b128 a[56:59], v13 offset:4096
    v_mfma_f32_16x16x32_bf16 v[40:43], a[16:19], a[12:15], v[40:43]
    ds_read_b128 a[60:63], v13 offset:6144
    v_mfma_f32_16x16x32_bf16 v[44:47], a[20:23], a[0:3], v[44:47]
    ds_read_b64_tr_b16 a[64:65], v14 offset:0
    v_mfma_f32_16x16x32_bf16 v[48:51], a[20:23], a[4:7], v[48:51]
    ds_read_b64_tr_b16 a[66:67], v14 offset:512
    v_mfma_f32_16x16x32_bf16 v[52:55], a[20:23], a[8:11], v[52:55]
    ds_read_b64_tr_b16 a[68:69], v15 offset:0
    v_mfma_f32_16x16x32_bf16 v[56:59], a[20:23], a[12:15], v[56:59]
    ds_read_b64_tr_b16 a[70:71], v15 offset:512
    v_mfma_f32_16x16x32_bf16 v[60:63], a[24:27], a[0:3], v[60:63]
    v_mfma_f32_16x16x32_bf16 v[64:67], a[24:27], a[4:7], v[64:67]
    ds_read_b64_tr_b16 a[72:73], v14 offset:1024
    v_mfma_f32_16x16x32_bf16 v[68:71], a[24:27], a[8:11], v[68:71]
    ds_read_b64_tr_b16 a[74:75], v14 offset:1536
    v_mfma_f32_16x16x32_bf16 v[72:75], a[24:27], a[12:15], v[72:75]
    ds_read_b64_tr_b16 a[76:77], v15 offset:1024
    v_mfma_f32_16x16x32_bf16 v[76:79], a[28:31], a[0:3], v[76:79]
    ds_read_b64_tr_b16 a[78:79], v15 offset:1536
    v_mfma_f32_16x16x32_bf16 v[80:83], a[28:31], a[4:7], v[80:83]
    ds_read_b64_tr_b16 a[80:81], v14 offset:14336
    v_mfma_f32_16x16x32_bf16 v[84:87], a[28:31], a[8:11], v[84:87]
    ds_read_b64_tr_b16 a[82:83], v14 offset:14848
    v_mfma_f32_16x16x32_bf16 v[88:91], a[28:31], a[12:15], v[88:91]
    ds_read_b64_tr_b16 a[84:85], v15 offset:14336
    v_mfma_f32_16x16x32_bf16 v[92:95], a[32:35], a[0:3], v[92:95]
    ds_read_b64_tr_b16 a[86:87], v15 offset:14848
    v_mfma_f32_16x16x32_bf16 v[96:99], a[32:35], a[4:7], v[96:99]
    v_mfma_f32_16x16x32_bf16 v[100:103], a[32:35], a[8:11], v[100:103]
    ds_read_b64_tr_b16 a[88:89], v14 offset:15360
    v_mfma_f32_16x16x32_bf16 v[104:107], a[32:35], a[12:15], v[104:107]
    ds_read_b64_tr_b16 a[90:91], v14 offset:15872
    v_mfma_f32_16x16x32_bf16 v[108:111], a[36:39], a[0:3], v[108:111]
    ds_read_b64_tr_b16 a[92:93], v15 offset:15360
    v_mfma_f32_16x16x32_bf16 v[112:115], a[36:39], a[4:7], v[112:115]
    ds_read_b64_tr_b16 a[94:95], v15 offset:15872
    v_mfma_f32_16x16x32_bf16 v[116:119], a[36:39], a[8:11], v[116:119]
    s_add_u32 s42, s96, s37
    s_add_u32 m0, s42, 0
    s_nop 0
    buffer_load_dwordx4 v5, s[12:15], s33 offen lds
    v_mfma_f32_16x16x32_bf16 v[120:123], a[36:39], a[12:15], v[120:123]
    s_add_u32 s42, s96, s37
    s_add_u32 m0, s42, 1024
    s_nop 0
    buffer_load_dwordx4 v6, s[12:15], s33 offen lds
    v_mfma_f32_16x16x32_bf16 v[124:127], a[40:43], a[0:3], v[124:127]
    s_add_u32 s42, s96, s37
    s_add_u32 m0, s42, 2048
    s_nop 0
    buffer_load_dwordx4 v7, s[12:15], s33 offen lds
    v_mfma_f32_16x16x32_bf16 v[128:131], a[40:43], a[4:7], v[128:131]
    s_add_u32 s33, s33, 229376
    v_mfma_f32_16x16x32_bf16 v[132:135], a[40:43], a[8:11], v[132:135]
    v_mfma_f32_16x16x32_bf16 v[136:139], a[40:43], a[12:15], v[136:139]
    v_mfma_f32_16x16x32_bf16 v[140:143], a[44:47], a[0:3], v[140:143]
    v_mfma_f32_16x16x32_bf16 v[144:147], a[44:47], a[4:7], v[144:147]
    v_mfma_f32_16x16x32_bf16 v[148:151], a[44:47], a[8:11], v[148:151]
    v_mfma_f32_16x16x32_bf16 v[152:155], a[44:47], a[12:15], v[152:155]
    s_waitcnt lgkmcnt(0)
    s_mov_b32 s35, s34
    s_add_u32 s34, s34, 16384
    s_cmp_eq_u32 s34, 49152
    s_cselect_b32 s34, 0, s34
    v_add_u32 v12, s34, v8
    v_add_u32 v13, s34, v9
    s_mov_b32 s96, s41
    s_add_u32 s41, s41, 28672
    s_cmp_eq_u32 s41, 114688
    s_cselect_b32 s41, 0, s41
    v_add_u32 v14, s41, v10
    v_add_u32 v15, s41, v11
    s_waitcnt vmcnt(9)
    s_barrier
    v_mfma_f32_16x16x32_bf16 v[28:31], a[64:67], a[48:51], v[28:31]
    ds_read_b128 a[0:3], v12 offset:0
    v_mfma_f32_16x16x32_bf16 v[32:35], a[64:67], a[52:55], v[32:35]
    ds_read_b128 a[4:7], v12 offset:2048
    v_mfma_f32_16x16x32_bf16 v[36:39], a[64:67], a[56:59], v[36:39]
    ds_read_b128 a[8:11], v12 offset:4096
    v_mfma_f32_16x16x32_bf16 v[40:43], a[64:67], a[60:63], v[40:43]
    ds_read_b128 a[12:15], v12 offset:6144
    v_mfma_f32_16x16x32_bf16 v[44:47], a[68:71], a[48:51], v[44:47]
    ds_read_b64_tr_b16 a[16:17], v14 offset:0
    v_mfma_f32_16x16x32_bf16 v[48:51], a[68:71], a[52:55], v[48:51]
    ds_read_b64_tr_b16 a[18:19], v14 offset:512
    v_mfma_f32_16x16x32_bf16 v[52:55], a[68:71], a[56:59], v[52:55]
    ds_read_b64_tr_b16 a[20:21], v15 offset:0
    v_mfma_f32_16x16x32_bf16 v[56:59], a[68:71], a[60:63], v[56:59]
    ds_read_b64_tr_b16 a[22:23], v15 offset:512
    v_mfma_f32_16x16x32_bf16 v[60:63], a[72:75], a[48:51], v[60:63]
    ds_read_b64_tr_b16 a[24:25], v14 offset:1024
    v_mfma_f32_16x16x32_bf16 v[64:67], a[72:75], a[52:55], v[64:67]
    ds_read_b64_tr_b16 a[26:27], v14 offset:1536
    v_mfma_f32_16x16x32_bf16 v[68:71], a[72:75], a[56:59], v[68:71]
    ds_read_b64_tr_b16 a[28:29], v15 offset:1024
    v_mfma_f32_16x16x32_bf16 v[72:75], a[72:75], a[60:63], v[72:75]
    ds_read_b64_tr_b16 a[30:31], v15 offset:1536
    v_mfma_f32_16x16x32_bf16 v[76:79], a[76:79], a[48:51], v[76:79]
    ds_read_b64_tr_b16 a[32:33], v14 offset:14336
    v_mfma_f32_16x16x32_bf16 v[80:83], a[76:79], a[52:55], v[80:83]
    ds_read_b64_tr_b16 a[34:35], v14 offset:14848
    v_mfma_f32_16x16x32_bf16 v[84:87], a[76:79], a[56:59], v[84:87]
    ds_read_b64_tr_b16 a[36:37], v15 offset:14336
    v_mfma_f32_16x16x32_bf16 v[88:91], a[76:79], a[60:63], v[88:91]
    ds_read_b64_tr_b16 a[38:39], v15 offset:14848
    v_mfma_f32_16x16x32_bf16 v[92:95], a[80:83], a[48:51], v[92:95]
    ds_read_b64_tr_b16 a[40:41], v14 offset:15360
    v_mfma_f32_16x16x32_bf16 v[96:99], a[80:83], a[52:55], v[96:99]
    ds_read_b64_tr_b16 a[42:43], v14 offset:15872
    v_mfma_f32_16x16x32_bf16 v[100:103], a[80:83], a[56:59], v[100:103]
    ds_read_b64_tr_b16 a[44:45], v15 offset:15360
    v_mfma_f32_16x16x32_bf16 v[104:107], a[80:83], a[60:63], v[104:107]
    ds_read_b64_tr_b16 a[46:47], v15 offset:15872
    v_mfma_f32_16x16x32_bf16 v[108:111], a[84:87], a[48:51], v[108:111]
    s_add_u32 s42, s96, s37
    s_add_u32 m0, s42, 0
    s_nop 0
    buffer_load_dwordx4 v5, s[12:15], s33 offen lds
    v_mfma_f32_16x16x32_bf16 v[112:115], a[84:87], a[52:55], v[112:115]
    s_add_u32 s42, s96, s37
    s_add_u32 m0, s42, 1024
    s_nop 0
    buffer_load_dwordx4 v6, s[12:15], s33 offen lds
    v_mfma_f32_16x16x32_bf16 v[116:119], a[84:87], a[56:59], v[116:119]
    s_add_u32 s42, s96, s37
    s_add_u32 m0, s42, 2048
    s_nop 0
    buffer_load_dwordx4 v7, s[12:15], s33 offen lds
    v_mfma_f32_16x16x32_bf16 v[120:123], a[84:87], a[60:63], v[120:123]
    s_add_u32 s33, s33, 229376
    v_mfma_f32_16x16x32_bf16 v[124:127], a[88:91], a[48:51], v[124:127]
    s_add_u32 s42, s35, s36
    s_add_u32 m0, s42, 0
    s_nop 0
    buffer_load_dwordx4 v3, s[8:11], s32 offen lds
    v_mfma_f32_16x16x32_bf16 v[128:131], a[88:91], a[52:55], v[128:131]
    s_add_u32 s42, s35, s36
    s_add_u32 m0, s42, 1024
    s_nop 0
    buffer_load_dwordx4 v4, s[8:11], s32 offen lds
    v_mfma_f32_16x16x32_bf16 v[132:135], a[88:91], a[56:59], v[132:135]
    s_add_u32 s32, s32, 128
    v_mfma_f32_16x16x32_bf16 v[136:139], a[88:91], a[60:63], v[136:139]
    v_mfma_f32_16x16x32_bf16 v[140:143], a[92:95], a[48:51], v[140:143]
    v_mfma_f32_16x16x32_bf16 v[144:147], a[92:95], a[52:55], v[144:147]
    v_mfma_f32_16x16x32_bf16 v[148:151], a[92:95], a[56:59], v[148:151]
    v_mfma_f32_16x16x32_bf16 v[152:155], a[92:95], a[60:63], v[152:155]
    s_waitcnt lgkmcnt(0)
    s_mov_b32 s31, 3
L_loop_15:
    s_mov_b32 s96, s41
    s_add_u32 s41, s41, 28672
    s_cmp_eq_u32 s41, 114688
    s_cselect_b32 s41, 0, s41
    v_add_u32 v14, s41, v10
    v_add_u32 v15, s41, v11
    s_waitcnt vmcnt(10)
    s_barrier
    v_mfma_f32_16x16x32_bf16 v[28:31], a[16:19], a[0:3], v[28:31]
    ds_read_b128 a[48:51], v13 offset:0
    v_mfma_f32_16x16x32_bf16 v[32:35], a[16:19], a[4:7], v[32:35]
    ds_read_b128 a[52:55], v13 offset:2048
    v_mfma_f32_16x16x32_bf16 v[36:39], a[16:19], a[8:11], v[36:39]
    ds_read_b128 a[56:59], v13 offset:4096
    v_mfma_f32_16x16x32_bf16 v[40:43], a[16:19], a[12:15], v[40:43]
    ds_read_b128 a[60:63], v13 offset:6144
    v_mfma_f32_16x16x32_bf16 v[44:47], a[20:23], a[0:3], v[44:47]
    ds_read_b64_tr_b16 a[64:65], v14 offset:0
    v_mfma_f32_16x16x32_bf16 v[48:51], a[20:23], a[4:7], v[48:51]
    ds_read_b64_tr_b16 a[66:67], v14 offset:512
    v_mfma_f32_16x16x32_bf16 v[52:55], a[20:23], a[8:11], v[52:55]
    ds_read_b64_tr_b16 a[68:69], v15 offset:0
    v_mfma_f32_16x16x32_bf16 v[56:59], a[20:23], a[12:15], v[56:59]
    ds_read_b64_tr_b16 a[70:71], v15 offset:512
    v_mfma_f32_16x16x32_bf16 v[60:63], a[24:27], a[0:3], v[60:63]
    v_mfma_f32_16x16x32_bf16 v[64:67], a[24:27], a[4:7], v[64:67]
    ds_read_b64_tr_b16 a[72:73], v14 offset:1024
    v_mfma_f32_16x16x32_bf16 v[68:71], a[24:27], a[8:11], v[68:71]
    ds_read_b64_tr_b16 a[74:75], v14 offset:1536
    v_mfma_f32_16x16x32_bf16 v[72:75], a[24:27], a[12:15], v[72:75]
    ds_read_b64_tr_b16 a[76:77], v15 offset:1024
    v_mfma_f32_16x16x32_bf16 v[76:79], a[28:31], a[0:3], v[76:79]
    ds_read_b64_tr_b16 a[78:79], v15 offset:1536
    v_mfma_f32_16x16x32_bf16 v[80:83], a[28:31], a[4:7], v[80:83]
    ds_read_b64_tr_b16 a[80:81], v14 offset:14336
    v_mfma_f32_16x16x32_bf16 v[84:87], a[28:31], a[8:11], v[84:87]
    ds_read_b64_tr_b16 a[82:83], v14 offset:14848
    v_mfma_f32_16x16x32_bf16 v[88:91], a[28:31], a[12:15], v[88:91]
    ds_read_b64_tr_b16 a[84:85], v15 offset:14336
    v_mfma_f32_16x16x32_bf16 v[92:95], a[32:35], a[0:3], v[92:95]
    ds_read_b64_tr_b16 a[86:87], v15 offset:14848
    v_mfma_f32_16x16x32_bf16 v[96:99], a[32:35], a[4:7], v[96:99]
    v_mfma_f32_16x16x32_bf16 v[100:103], a[32:35], a[8:11], v[100:103]
    ds_read_b64_tr_b16 a[88:89], v14 offset:15360
    v_mfma_f32_16x16x32_bf16 v[104:107], a[32:35], a[12:15], v[104:107]
    ds_read_b64_tr_b16 a[90:91], v14 offset:15872
    v_mfma_f32_16x16x32_bf16 v[108:111], a[36:39], a[0:3], v[108:111]
    ds_read_b64_tr_b16 a[92:93], v15 offset:15360
    v_mfma_f32_16x16x32_bf16 v[112:115], a[36:39], a[4:7], v[112:115]
    ds_read_b64_tr_b16 a[94:95], v15 offset:15872
    v_mfma_f32_16x16x32_bf16 v[116:119], a[36:39], a[8:11], v[116:119]
    s_add_u32 s42, s96, s37
    s_add_u32 m0, s42, 0
    s_nop 0
    buffer_load_dwordx4 v5, s[12:15], s33 offen lds
    v_mfma_f32_16x16x32_bf16 v[120:123], a[36:39], a[12:15], v[120:123]
    s_add_u32 s42, s96, s37
    s_add_u32 m0, s42, 1024
    s_nop 0
    buffer_load_dwordx4 v6, s[12:15], s33 offen lds
    v_mfma_f32_16x16x32_bf16 v[124:127], a[40:43], a[0:3], v[124:127]
    s_add_u32 s42, s96, s37
    s_add_u32 m0, s42, 2048
    s_nop 0
    buffer_load_dwordx4 v7, s[12:15], s33 offen lds
    v_mfma_f32_16x16x32_bf16 v[128:131], a[40:43], a[4:7], v[128:131]
    s_add_u32 s33, s33, 229376
    v_mfma_f32_16x16x32_bf16 v[132:135], a[40:43], a[8:11], v[132:135]
    v_mfma_f32_16x16x32_bf16 v[136:139], a[40:43], a[12:15], v[136:139]
    v_mfma_f32_16x16x32_bf16 v[140:143], a[44:47], a[0:3], v[140:143]
    v_mfma_f32_16x16x32_bf16 v[144:147], a[44:47], a[4:7], v[144:147]
    v_mfma_f32_16x16x32_bf16 v[148:151], a[44:47], a[8:11], v[148:151]
    v_mfma_f32_16x16x32_bf16 v[152:155], a[44:47], a[12:15], v[152:155]
    s_waitcnt lgkmcnt(0)
    s_mov_b32 s35, s34
    s_add_u32 s34, s34, 16384
    s_cmp_eq_u32 s34, 49152
    s_cselect_b32 s34, 0, s34
    v_add_u32 v12, s34, v8
    v_add_u32 v13, s34, v9
    s_mov_b32 s96, s41
    s_add_u32 s41, s41, 28672
    s_cmp_eq_u32 s41, 114688
    s_cselect_b32 s41, 0, s41
    v_add_u32 v14, s41, v10
    v_add_u32 v15, s41, v11
    s_waitcnt vmcnt(8)
    s_barrier
    v_mfma_f32_16x16x32_bf16 v[28:31], a[64:67], a[48:51], v[28:31]
    ds_read_b128 a[0:3], v12 offset:0
    v_mfma_f32_16x16x32_bf16 v[32:35], a[64:67], a[52:55], v[32:35]
    ds_read_b128 a[4:7], v12 offset:2048
    v_mfma_f32_16x16x32_bf16 v[36:39], a[64:67], a[56:59], v[36:39]
    ds_read_b128 a[8:11], v12 offset:4096
    v_mfma_f32_16x16x32_bf16 v[40:43], a[64:67], a[60:63], v[40:43]
    ds_read_b128 a[12:15], v12 offset:6144
    v_mfma_f32_16x16x32_bf16 v[44:47], a[68:71], a[48:51], v[44:47]
    ds_read_b64_tr_b16 a[16:17], v14 offset:0
    v_mfma_f32_16x16x32_bf16 v[48:51], a[68:71], a[52:55], v[48:51]
    ds_read_b64_tr_b16 a[18:19], v14 offset:512
    v_mfma_f32_16x16x32_bf16 v[52:55], a[68:71], a[56:59], v[52:55]
    ds_read_b64_tr_b16 a[20:21], v15 offset:0
    v_mfma_f32_16x16x32_bf16 v[56:59], a[68:71], a[60:63], v[56:59]
    ds_read_b64_tr_b16 a[22:23], v15 offset:512
    v_mfma_f32_16x16x32_bf16 v[60:63], a[72:75], a[48:51], v[60:63]
    ds_read_b64_tr_b16 a[24:25], v14 offset:1024
    v_mfma_f32_16x16x32_bf16 v[64:67], a[72:75], a[52:55], v[64:67]
    ds_read_b64_tr_b16 a[26:27], v14 offset:1536
    v_mfma_f32_16x16x32_bf16 v[68:71], a[72:75], a[56:59], v[68:71]
    ds_read_b64_tr_b16 a[28:29], v15 offset:1024
    v_mfma_f32_16x16x32_bf16 v[72:75], a[72:75], a[60:63], v[72:75]
    ds_read_b64_tr_b16 a[30:31], v15 offset:1536
    v_mfma_f32_16x16x32_bf16 v[76:79], a[76:79], a[48:51], v[76:79]
    ds_read_b64_tr_b16 a[32:33], v14 offset:14336
    v_mfma_f32_16x16x32_bf16 v[80:83], a[76:79], a[52:55], v[80:83]
    ds_read_b64_tr_b16 a[34:35], v14 offset:14848
    v_mfma_f32_16x16x32_bf16 v[84:87], a[76:79], a[56:59], v[84:87]
    ds_read_b64_tr_b16 a[36:37], v15 offset:14336
    v_mfma_f32_16x16x32_bf16 v[88:91], a[76:79], a[60:63], v[88:91]
    ds_read_b64_tr_b16 a[38:39], v15 offset:14848
    v_mfma_f32_16x16x32_bf16 v[92:95], a[80:83], a[48:51], v[92:95]
    ds_read_b64_tr_b16 a[40:41], v14 offset:15360
    v_mfma_f32_16x16x32_bf16 v[96:99], a[80:83], a[52:55], v[96:99]
    ds_read_b64_tr_b16 a[42:43], v14 offset:15872
    v_mfma_f32_16x16x32_bf16 v[100:103], a[80:83], a[56:59], v[100:103]
    ds_read_b64_tr_b16 a[44:45], v15 offset:15360
    v_mfma_f32_16x16x32_bf16 v[104:107], a[80:83], a[60:63], v[104:107]
    ds_read_b64_tr_b16 a[46:47], v15 offset:15872
    v_mfma_f32_16x16x32_bf16 v[108:111], a[84:87], a[48:51], v[108:111]
    s_add_u32 s42, s96, s37
    s_add_u32 m0, s42, 0
    s_nop 0
    buffer_load_dwordx4 v5, s[12:15], s33 offen lds
    v_mfma_f32_16x16x32_bf16 v[112:115], a[84:87], a[52:55], v[112:115]
    s_add_u32 s42, s96, s37
    s_add_u32 m0, s42, 1024
    s_nop 0
    buffer_load_dwordx4 v6, s[12:15], s33 offen lds
    v_mfma_f32_16x16x32_bf16 v[116:119], a[84:87], a[56:59], v[116:119]
    s_add_u32 s42, s96, s37
    s_add_u32 m0, s42, 2048
    s_nop 0
    buffer_load_dwordx4 v7, s[12:15], s33 offen lds
    v_mfma_f32_16x16x32_bf16 v[120:123], a[84:87], a[60:63], v[120:123]
    s_add_u32 s33, s33, 229376
    v_mfma_f32_16x16x32_bf16 v[124:127], a[88:91], a[48:51], v[124:127]
    s_add_u32 s42, s35, s36
    s_add_u32 m0, s42, 0
    s_nop 0
    buffer_load_dwordx4 v3, s[8:11], s32 offen lds
    v_mfma_f32_16x16x32_bf16 v[128:131], a[88:91], a[52:55], v[128:131]
    s_add_u32 s42, s35, s36
    s_add_u32 m0, s42, 1024
    s_nop 0
    buffer_load_dwordx4 v4, s[8:11], s32 offen lds
    v_mfma_f32_16x16x32_bf16 v[132:135], a[88:91], a[56:59], v[132:135]
    s_add_u32 s32, s32, 128
    v_mfma_f32_16x16x32_bf16 v[136:139], a[88:91], a[60:63], v[136:139]
    v_mfma_f32_16x16x32_bf16 v[140:143], a[92:95], a[48:51], v[140:143]
    v_mfma_f32_16x16x32_bf16 v[144:147], a[92:95], a[52:55], v[144:147]
    v_mfma_f32_16x16x32_bf16 v[148:151], a[92:95], a[56:59], v[148:151]
    v_mfma_f32_16x16x32_bf16 v[152:155], a[92:95], a[60:63], v[152:155]
    s_waitcnt lgkmcnt(0)
    s_sub_u32 s31, s31, 1
    s_cmp_lg_u32 s31, 0
    s_cbranch_scc1 L_loop_15
    s_mov_b32 s96, s41
    s_add_u32 s41, s41, 28672
    s_cmp_eq_u32 s41, 114688
    s_cselect_b32 s41, 0, s41
    v_add_u32 v14, s41, v10
    v_add_u32 v15, s41, v11
    s_waitcnt vmcnt(10)
    s_barrier
    v_mfma_f32_16x16x32_bf16 v[28:31], a[16:19], a[0:3], v[28:31]
    ds_read_b128 a[48:51], v13 offset:0
    v_mfma_f32_16x16x32_bf16 v[32:35], a[16:19], a[4:7], v[32:35]
    ds_read_b128 a[52:55], v13 offset:2048
    v_mfma_f32_16x16x32_bf16 v[36:39], a[16:19], a[8:11], v[36:39]
    ds_read_b128 a[56:59], v13 offset:4096
    v_mfma_f32_16x16x32_bf16 v[40:43], a[16:19], a[12:15], v[40:43]
    ds_read_b128 a[60:63], v13 offset:6144
    v_mfma_f32_16x16x32_bf16 v[44:47], a[20:23], a[0:3], v[44:47]
    ds_read_b64_tr_b16 a[64:65], v14 offset:0
    v_mfma_f32_16x16x32_bf16 v[48:51], a[20:23], a[4:7], v[48:51]
    ds_read_b64_tr_b16 a[66:67], v14 offset:512
    v_mfma_f32_16x16x32_bf16 v[52:55], a[20:23], a[8:11], v[52:55]
    ds_read_b64_tr_b16 a[68:69], v15 offset:0
    v_mfma_f32_16x16x32_bf16 v[56:59], a[20:23], a[12:15], v[56:59]
    ds_read_b64_tr_b16 a[70:71], v15 offset:512
    v_mfma_f32_16x16x32_bf16 v[60:63], a[24:27], a[0:3], v[60:63]
    v_mfma_f32_16x16x32_bf16 v[64:67], a[24:27], a[4:7], v[64:67]
    ds_read_b64_tr_b16 a[72:73], v14 offset:1024
    v_mfma_f32_16x16x32_bf16 v[68:71], a[24:27], a[8:11], v[68:71]
    ds_read_b64_tr_b16 a[74:75], v14 offset:1536
    v_mfma_f32_16x16x32_bf16 v[72:75], a[24:27], a[12:15], v[72:75]
    ds_read_b64_tr_b16 a[76:77], v15 offset:1024
    v_mfma_f32_16x16x32_bf16 v[76:79], a[28:31], a[0:3], v[76:79]
    ds_read_b64_tr_b16 a[78:79], v15 offset:1536
    v_mfma_f32_16x16x32_bf16 v[80:83], a[28:31], a[4:7], v[80:83]
    ds_read_b64_tr_b16 a[80:81], v14 offset:14336
    v_mfma_f32_16x16x32_bf16 v[84:87], a[28:31], a[8:11], v[84:87]
    ds_read_b64_tr_b16 a[82:83], v14 offset:14848
    v_mfma_f32_16x16x32_bf16 v[88:91], a[28:31], a[12:15], v[88:91]
    ds_read_b64_tr_b16 a[84:85], v15 offset:14336
    v_mfma_f32_16x16x32_bf16 v[92:95], a[32:35], a[0:3], v[92:95]
    ds_read_b64_tr_b16 a[86:87], v15 offset:14848
    v_mfma_f32_16x16x32_bf16 v[96:99], a[32:35], a[4:7], v[96:99]
    v_mfma_f32_16x16x32_bf16 v[100:103], a[32:35], a[8:11], v[100:103]
    ds_read_b64_tr_b16 a[88:89], v14 offset:15360
    v_mfma_f32_16x16x32_bf16 v[104:107], a[32:35], a[12:15], v[104:107]
    ds_read_b64_tr_b16 a[90:91], v14 offset:15872
    v_mfma_f32_16x16x32_bf16 v[108:111], a[36:39], a[0:3], v[108:111]
    ds_read_b64_tr_b16 a[92:93], v15 offset:15360
    v_mfma_f32_16x16x32_bf16 v[112:115], a[36:39], a[4:7], v[112:115]
    ds_read_b64_tr_b16 a[94:95], v15 offset:15872
    v_mfma_f32_16x16x32_bf16 v[116:119], a[36:39], a[8:11], v[116:119]
    s_add_u32 s42, s96, s37
    s_add_u32 m0, s42, 0
    s_nop 0
    buffer_load_dwordx4 v5, s[12:15], s33 offen lds
    v_mfma_f32_16x16x32_bf16 v[120:123], a[36:39], a[12:15], v[120:123]
    s_add_u32 s42, s96, s37
    s_add_u32 m0, s42, 1024
    s_nop 0
    buffer_load_dwordx4 v6, s[12:15], s33 offen lds
    v_mfma_f32_16x16x32_bf16 v[124:127], a[40:43], a[0:3], v[124:127]
    s_add_u32 s42, s96, s37
    s_add_u32 m0, s42, 2048
    s_nop 0
    buffer_load_dwordx4 v7, s[12:15], s33 offen lds
    v_mfma_f32_16x16x32_bf16 v[128:131], a[40:43], a[4:7], v[128:131]
    s_add_u32 s33, s33, 229376
    v_mfma_f32_16x16x32_bf16 v[132:135], a[40:43], a[8:11], v[132:135]
    v_mfma_f32_16x16x32_bf16 v[136:139], a[40:43], a[12:15], v[136:139]
    v_mfma_f32_16x16x32_bf16 v[140:143], a[44:47], a[0:3], v[140:143]
    v_mfma_f32_16x16x32_bf16 v[144:147], a[44:47], a[4:7], v[144:147]
    v_mfma_f32_16x16x32_bf16 v[148:151], a[44:47], a[8:11], v[148:151]
    v_mfma_f32_16x16x32_bf16 v[152:155], a[44:47], a[12:15], v[152:155]
    s_waitcnt lgkmcnt(0)
    s_mov_b32 s35, s34
    s_add_u32 s34, s34, 16384
    s_cmp_eq_u32 s34, 49152
    s_cselect_b32 s34, 0, s34
    v_add_u32 v12, s34, v8
    v_add_u32 v13, s34, v9
    s_mov_b32 s96, s41
    s_add_u32 s41, s41, 28672
    s_cmp_eq_u32 s41, 114688
    s_cselect_b32 s41, 0, s41
    v_add_u32 v14, s41, v10
    v_add_u32 v15, s41, v11
    s_waitcnt vmcnt(8)
    s_barrier
    v_mfma_f32_16x16x32_bf16 v[28:31], a[64:67], a[48:51], v[28:31]
    ds_read_b128 a[0:3], v12 offset:0
    v_mfma_f32_16x16x32_bf16 v[32:35], a[64:67], a[52:55], v[32:35]
    ds_read_b128 a[4:7], v12 offset:2048
    v_mfma_f32_16x16x32_bf16 v[36:39], a[64:67], a[56:59], v[36:39]
    ds_read_b128 a[8:11], v12 offset:4096
    v_mfma_f32_16x16x32_bf16 v[40:43], a[64:67], a[60:63], v[40:43]
    ds_read_b128 a[12:15], v12 offset:6144
    v_mfma_f32_16x16x32_bf16 v[44:47], a[68:71], a[48:51], v[44:47]
    ds_read_b64_tr_b16 a[16:17], v14 offset:0
    v_mfma_f32_16x16x32_bf16 v[48:51], a[68:71], a[52:55], v[48:51]
    ds_read_b64_tr_b16 a[18:19], v14 offset:512
    v_mfma_f32_16x16x32_bf16 v[52:55], a[68:71], a[56:59], v[52:55]
    ds_read_b64_tr_b16 a[20:21], v15 offset:0
    v_mfma_f32_16x16x32_bf16 v[56:59], a[68:71], a[60:63], v[56:59]
    ds_read_b64_tr_b16 a[22:23], v15 offset:512
    v_mfma_f32_16x16x32_bf16 v[60:63], a[72:75], a[48:51], v[60:63]
    v_mfma_f32_16x16x32_bf16 v[64:67], a[72:75], a[52:55], v[64:67]
    ds_read_b64_tr_b16 a[24:25], v14 offset:1024
    v_mfma_f32_16x16x32_bf16 v[68:71], a[72:75], a[56:59], v[68:71]
    ds_read_b64_tr_b16 a[26:27], v14 offset:1536
    v_mfma_f32_16x16x32_bf16 v[72:75], a[72:75], a[60:63], v[72:75]
    ds_read_b64_tr_b16 a[28:29], v15 offset:1024
    v_mfma_f32_16x16x32_bf16 v[76:79], a[76:79], a[48:51], v[76:79]
    ds_read_b64_tr_b16 a[30:31], v15 offset:1536
    v_mfma_f32_16x16x32_bf16 v[80:83], a[76:79], a[52:55], v[80:83]
    ds_read_b64_tr_b16 a[32:33], v14 offset:14336
    v_mfma_f32_16x16x32_bf16 v[84:87], a[76:79], a[56:59], v[84:87]
    ds_read_b64_tr_b16 a[34:35], v14 offset:14848
    v_mfma_f32_16x16x32_bf16 v[88:91], a[76:79], a[60:63], v[88:91]
    ds_read_b64_tr_b16 a[36:37], v15 offset:14336
    v_mfma_f32_16x16x32_bf16 v[92:95], a[80:83], a[48:51], v[92:95]
    ds_read_b64_tr_b16 a[38:39], v15 offset:14848
    v_mfma_f32_16x16x32_bf16 v[96:99], a[80:83], a[52:55], v[96:99]
    v_mfma_f32_16x16x32_bf16 v[100:103], a[80:83], a[56:59], v[100:103]
    ds_read_b64_tr_b16 a[40:41], v14 offset:15360
    v_mfma_f32_16x16x32_bf16 v[104:107], a[80:83], a[60:63], v[104:107]
    ds_read_b64_tr_b16 a[42:43], v14 offset:15872
    v_mfma_f32_16x16x32_bf16 v[108:111], a[84:87], a[48:51], v[108:111]
    ds_read_b64_tr_b16 a[44:45], v15 offset:15360
    v_mfma_f32_16x16x32_bf16 v[112:115], a[84:87], a[52:55], v[112:115]
    ds_read_b64_tr_b16 a[46:47], v15 offset:15872
    v_mfma_f32_16x16x32_bf16 v[116:119], a[84:87], a[56:59], v[116:119]
    s_add_u32 s42, s96, s37
    s_add_u32 m0, s42, 0
    s_nop 0
    buffer_load_dwordx4 v5, s[12:15], s33 offen lds
    v_mfma_f32_16x16x32_bf16 v[120:123], a[84:87], a[60:63], v[120:123]
    s_add_u32 s42, s96, s37
    s_add_u32 m0, s42, 1024
    s_nop 0
    buffer_load_dwordx4 v6, s[12:15], s33 offen lds
    v_mfma_f32_16x16x32_bf16 v[124:127], a[88:91], a[48:51], v[124:127]
    s_add_u32 s42, s96, s37
    s_add_u32 m0, s42, 2048
    s_nop 0
    buffer_load_dwordx4 v7, s[12:15], s33 offen lds
    v_mfma_f32_16x16x32_bf16 v[128:131], a[88:91], a[52:55], v[128:131]
    s_add_u32 s33, s33, 229376
    v_mfma_f32_16x16x32_bf16 v[132:135], a[88:91], a[56:59], v[132:135]
    v_mfma_f32_16x16x32_bf16 v[136:139], a[88:91], a[60:63], v[136:139]
    v_mfma_f32_16x16x32_bf16 v[140:143], a[92:95], a[48:51], v[140:143]
    v_mfma_f32_16x16x32_bf16 v[144:147], a[92:95], a[52:55], v[144:147]
    v_mfma_f32_16x16x32_bf16 v[148:151], a[92:95], a[56:59], v[148:151]
    v_mfma_f32_16x16x32_bf16 v[152:155], a[92:95], a[60:63], v[152:155]
    s_waitcnt lgkmcnt(0)
    s_mov_b32 s96, s41
    s_add_u32 s41, s41, 28672
    s_cmp_eq_u32 s41, 114688
    s_cselect_b32 s41, 0, s41
    v_add_u32 v14, s41, v10
    v_add_u32 v15, s41, v11
    s_waitcnt vmcnt(8)
    s_barrier
    v_mfma_f32_16x16x32_bf16 v[28:31], a[16:19], a[0:3], v[28:31]
    ds_read_b128 a[48:51], v13 offset:0
    v_mfma_f32_16x16x32_bf16 v[32:35], a[16:19], a[4:7], v[32:35]
    ds_read_b128 a[52:55], v13 offset:2048
    v_mfma_f32_16x16x32_bf16 v[36:39], a[16:19], a[8:11], v[36:39]
    ds_read_b128 a[56:59], v13 offset:4096
    v_mfma_f32_16x16x32_bf16 v[40:43], a[16:19], a[12:15], v[40:43]
    v_mfma_f32_16x16x32_bf16 v[44:47], a[20:23], a[0:3], v[44:47]
    ds_read_b128 a[60:63], v13 offset:6144
    v_mfma_f32_16x16x32_bf16 v[48:51], a[20:23], a[4:7], v[48:51]
    ds_read_b64_tr_b16 a[64:65], v14 offset:0
    v_mfma_f32_16x16x32_bf16 v[52:55], a[20:23], a[8:11], v[52:55]
    ds_read_b64_tr_b16 a[66:67], v14 offset:512
    v_mfma_f32_16x16x32_bf16 v[56:59], a[20:23], a[12:15], v[56:59]
    v_mfma_f32_16x16x32_bf16 v[60:63], a[24:27], a[0:3], v[60:63]
    ds_read_b64_tr_b16 a[68:69], v15 offset:0
    v_mfma_f32_16x16x32_bf16 v[64:67], a[24:27], a[4:7], v[64:67]
    ds_read_b64_tr_b16 a[70:71], v15 offset:512
    v_mfma_f32_16x16x32_bf16 v[68:71], a[24:27], a[8:11], v[68:71]
    ds_read_b64_tr_b16 a[72:73], v14 offset:1024
    v_mfma_f32_16x16x32_bf16 v[72:75], a[24:27], a[12:15], v[72:75]
    v_mfma_f32_16x16x32_bf16 v[76:79], a[28:31], a[0:3], v[76:79]
    ds_read_b64_tr_b16 a[74:75], v14 offset:1536
    v_mfma_f32_16x16x32_bf16 v[80:83], a[28:31], a[4:7], v[80:83]
    ds_read_b64_tr_b16 a[76:77], v15 offset:1024
    v_mfma_f32_16x16x32_bf16 v[84:87], a[28:31], a[8:11], v[84:87]
    ds_read_b64_tr_b16 a[78:79], v15 offset:1536
    v_mfma_f32_16x16x32_bf16 v[88:91], a[28:31], a[12:15], v[88:91]
    v_mfma_f32_16x16x32_bf16 v[92:95], a[32:35], a[0:3], v[92:95]
    ds_read_b64_tr_b16 a[80:81], v14 offset:14336
    v_mfma_f32_16x16x32_bf16 v[96:99], a[32:35], a[4:7], v[96:99]
    ds_read_b64_tr_b16 a[82:83], v14 offset:14848
    v_mfma_f32_16x16x32_bf16 v[100:103], a[32:35], a[8:11], v[100:103]
    ds_read_b64_tr_b16 a[84:85], v15 offset:14336
    v_mfma_f32_16x16x32_bf16 v[104:107], a[32:35], a[12:15], v[104:107]
    v_mfma_f32_16x16x32_bf16 v[108:111], a[36:39], a[0:3], v[108:111]
    ds_read_b64_tr_b16 a[86:87], v15 offset:14848
    v_mfma_f32_16x16x32_bf16 v[112:115], a[36:39], a[4:7], v[112:115]
    ds_read_b64_tr_b16 a[88:89], v14 offset:15360
    v_mfma_f32_16x16x32_bf16 v[116:119], a[36:39], a[8:11], v[116:119]
    ds_read_b64_tr_b16 a[90:91], v14 offset:15872
    v_mfma_f32_16x16x32_bf16 v[120:123], a[36:39], a[12:15], v[120:123]
    v_mfma_f32_16x16x32_bf16 v[124:127], a[40:43], a[0:3], v[124:127]
    ds_read_b64_tr_b16 a[92:93], v15 offset:15360
    v_mfma_f32_16x16x32_bf16 v[128:131], a[40:43], a[4:7], v[128:131]
    ds_read_b64_tr_b16 a[94:95], v15 offset:15872
    v_mfma_f32_16x16x32_bf16 v[132:135], a[40:43], a[8:11], v[132:135]
    v_mfma_f32_16x16x32_bf16 v[136:139], a[40:43], a[12:15], v[136:139]
    v_mfma_f32_16x16x32_bf16 v[140:143], a[44:47], a[0:3], v[140:143]
    v_mfma_f32_16x16x32_bf16 v[144:147], a[44:47], a[4:7], v[144:147]
    v_mfma_f32_16x16x32_bf16 v[148:151], a[44:47], a[8:11], v[148:151]
    v_mfma_f32_16x16x32_bf16 v[152:155], a[44:47], a[12:15], v[152:155]
    s_waitcnt lgkmcnt(0)
    s_mov_b32 s35, s34
    s_add_u32 s34, s34, 16384
    s_cmp_eq_u32 s34, 49152
    s_cselect_b32 s34, 0, s34
    v_add_u32 v12, s34, v8
    v_add_u32 v13, s34, v9
    s_mov_b32 s96, s41
    s_add_u32 s41, s41, 28672
    s_cmp_eq_u32 s41, 114688
    s_cselect_b32 s41, 0, s41
    v_add_u32 v14, s41, v10
    v_add_u32 v15, s41, v11
    s_waitcnt vmcnt(3)
    s_barrier
    v_mfma_f32_16x16x32_bf16 v[28:31], a[64:67], a[48:51], v[28:31]
    ds_read_b128 a[0:3], v12 offset:0
    v_mfma_f32_16x16x32_bf16 v[32:35], a[64:67], a[52:55], v[32:35]
    ds_read_b128 a[4:7], v12 offset:2048
    v_mfma_f32_16x16x32_bf16 v[36:39], a[64:67], a[56:59], v[36:39]
    ds_read_b128 a[8:11], v12 offset:4096
    v_mfma_f32_16x16x32_bf16 v[40:43], a[64:67], a[60:63], v[40:43]
    v_mfma_f32_16x16x32_bf16 v[44:47], a[68:71], a[48:51], v[44:47]
    ds_read_b128 a[12:15], v12 offset:6144
    v_mfma_f32_16x16x32_bf16 v[48:51], a[68:71], a[52:55], v[48:51]
    ds_read_b64_tr_b16 a[16:17], v14 offset:0
    v_mfma_f32_16x16x32_bf16 v[52:55], a[68:71], a[56:59], v[52:55]
    ds_read_b64_tr_b16 a[18:19], v14 offset:512
    v_mfma_f32_16x16x32_bf16 v[56:59], a[68:71], a[60:63], v[56:59]
    v_mfma_f32_16x16x32_bf16 v[60:63], a[72:75], a[48:51], v[60:63]
    ds_read_b64_tr_b16 a[20:21], v15 offset:0
    v_mfma_f32_16x16x32_bf16 v[64:67], a[72:75], a[52:55], v[64:67]
    ds_read_b64_tr_b16 a[22:23], v15 offset:512
    v_mfma_f32_16x16x32_bf16 v[68:71], a[72:75], a[56:59], v[68:71]
    ds_read_b64_tr_b16 a[24:25], v14 offset:1024
    v_mfma_f32_16x16x32_bf16 v[72:75], a[72:75], a[60:63], v[72:75]
    v_mfma_f32_16x16x32_bf16 v[76:79], a[76:79], a[48:51], v[76:79]
    ds_read_b64_tr_b16 a[26:27], v14 offset:1536
    v_mfma_f32_16x16x32_bf16 v[80:83], a[76:79], a[52:55], v[80:83]
    ds_read_b64_tr_b16 a[28:29], v15 offset:1024
    v_mfma_f32_16x16x32_bf16 v[84:87], a[76:79], a[56:59], v[84:87]
    ds_read_b64_tr_b16 a[30:31], v15 offset:1536
    v_mfma_f32_16x16x32_bf16 v[88:91], a[76:79], a[60:63], v[88:91]
    v_mfma_f32_16x16x32_bf16 v[92:95], a[80:83], a[48:51], v[92:95]
    ds_read_b64_tr_b16 a[32:33], v14 offset:14336
    v_mfma_f32_16x16x32_bf16 v[96:99], a[80:83], a[52:55], v[96:99]
    ds_read_b64_tr_b16 a[34:35], v14 offset:14848
    v_mfma_f32_16x16x32_bf16 v[100:103], a[80:83], a[56:59], v[100:103]
    ds_read_b64_tr_b16 a[36:37], v15 offset:14336
    v_mfma_f32_16x16x32_bf16 v[104:107], a[80:83], a[60:63], v[104:107]
    v_mfma_f32_16x16x32_bf16 v[108:111], a[84:87], a[48:51], v[108:111]
    ds_read_b64_tr_b16 a[38:39], v15 offset:14848
    v_mfma_f32_16x16x32_bf16 v[112:115], a[84:87], a[52:55], v[112:115]
    ds_read_b64_tr_b16 a[40:41], v14 offset:15360
    v_mfma_f32_16x16x32_bf16 v[116:119], a[84:87], a[56:59], v[116:119]
    ds_read_b64_tr_b16 a[42:43], v14 offset:15872
    v_mfma_f32_16x16x32_bf16 v[120:123], a[84:87], a[60:63], v[120:123]
    v_mfma_f32_16x16x32_bf16 v[124:127], a[88:91], a[48:51], v[124:127]
    ds_read_b64_tr_b16 a[44:45], v15 offset:15360
    v_mfma_f32_16x16x32_bf16 v[128:131], a[88:91], a[52:55], v[128:131]
    ds_read_b64_tr_b16 a[46:47], v15 offset:15872
    v_mfma_f32_16x16x32_bf16 v[132:135], a[88:91], a[56:59], v[132:135]
    v_mfma_f32_16x16x32_bf16 v[136:139], a[88:91], a[60:63], v[136:139]
    v_mfma_f32_16x16x32_bf16 v[140:143], a[92:95], a[48:51], v[140:143]
    v_mfma_f32_16x16x32_bf16 v[144:147], a[92:95], a[52:55], v[144:147]
    v_mfma_f32_16x16x32_bf16 v[148:151], a[92:95], a[56:59], v[148:151]
    v_mfma_f32_16x16x32_bf16 v[152:155], a[92:95], a[60:63], v[152:155]
    s_waitcnt lgkmcnt(0)
    s_mov_b32 s96, s41
    s_add_u32 s41, s41, 28672
    s_cmp_eq_u32 s41, 114688
    s_cselect_b32 s41, 0, s41
    v_add_u32 v14, s41, v10
    v_add_u32 v15, s41, v11
    s_waitcnt vmcnt(0)
    s_barrier
    v_mfma_f32_16x16x32_bf16 v[28:31], a[16:19], a[0:3], v[28:31]
    ds_read_b128 a[48:51], v13 offset:0
    v_mfma_f32_16x16x32_bf16 v[32:35], a[16:19], a[4:7], v[32:35]
    ds_read_b128 a[52:55], v13 offset:2048
    v_mfma_f32_16x16x32_bf16 v[36:39], a[16:19], a[8:11], v[36:39]
    ds_read_b128 a[56:59], v13 offset:4096
    v_mfma_f32_16x16x32_bf16 v[40:43], a[16:19], a[12:15], v[40:43]
    v_mfma_f32_16x16x32_bf16 v[44:47], a[20:23], a[0:3], v[44:47]
    ds_read_b128 a[60:63], v13 offset:6144
    v_mfma_f32_16x16x32_bf16 v[48:51], a[20:23], a[4:7], v[48:51]
    ds_read_b64_tr_b16 a[64:65], v14 offset:0
    v_mfma_f32_16x16x32_bf16 v[52:55], a[20:23], a[8:11], v[52:55]
    ds_read_b64_tr_b16 a[66:67], v14 offset:512
    v_mfma_f32_16x16x32_bf16 v[56:59], a[20:23], a[12:15], v[56:59]
    v_mfma_f32_16x16x32_bf16 v[60:63], a[24:27], a[0:3], v[60:63]
    ds_read_b64_tr_b16 a[68:69], v15 offset:0
    v_mfma_f32_16x16x32_bf16 v[64:67], a[24:27], a[4:7], v[64:67]
    ds_read_b64_tr_b16 a[70:71], v15 offset:512
    v_mfma_f32_16x16x32_bf16 v[68:71], a[24:27], a[8:11], v[68:71]
    ds_read_b64_tr_b16 a[72:73], v14 offset:1024
    v_mfma_f32_16x16x32_bf16 v[72:75], a[24:27], a[12:15], v[72:75]
    v_mfma_f32_16x16x32_bf16 v[76:79], a[28:31], a[0:3], v[76:79]
    ds_read_b64_tr_b16 a[74:75], v14 offset:1536
    v_mfma_f32_16x16x32_bf16 v[80:83], a[28:31], a[4:7], v[80:83]
    ds_read_b64_tr_b16 a[76:77], v15 offset:1024
    v_mfma_f32_16x16x32_bf16 v[84:87], a[28:31], a[8:11], v[84:87]
    ds_read_b64_tr_b16 a[78:79], v15 offset:1536
    v_mfma_f32_16x16x32_bf16 v[88:91], a[28:31], a[12:15], v[88:91]
    v_mfma_f32_16x16x32_bf16 v[92:95], a[32:35], a[0:3], v[92:95]
    ds_read_b64_tr_b16 a[80:81], v14 offset:14336
    v_mfma_f32_16x16x32_bf16 v[96:99], a[32:35], a[4:7], v[96:99]
    ds_read_b64_tr_b16 a[82:83], v14 offset:14848
    v_mfma_f32_16x16x32_bf16 v[100:103], a[32:35], a[8:11], v[100:103]
    ds_read_b64_tr_b16 a[84:85], v15 offset:14336
    v_mfma_f32_16x16x32_bf16 v[104:107], a[32:35], a[12:15], v[104:107]
    v_mfma_f32_16x16x32_bf16 v[108:111], a[36:39], a[0:3], v[108:111]
    ds_read_b64_tr_b16 a[86:87], v15 offset:14848
    v_mfma_f32_16x16x32_bf16 v[112:115], a[36:39], a[4:7], v[112:115]
    ds_read_b64_tr_b16 a[88:89], v14 offset:15360
    v_mfma_f32_16x16x32_bf16 v[116:119], a[36:39], a[8:11], v[116:119]
    ds_read_b64_tr_b16 a[90:91], v14 offset:15872
    v_mfma_f32_16x16x32_bf16 v[120:123], a[36:39], a[12:15], v[120:123]
    v_mfma_f32_16x16x32_bf16 v[124:127], a[40:43], a[0:3], v[124:127]
    ds_read_b64_tr_b16 a[92:93], v15 offset:15360
    v_mfma_f32_16x16x32_bf16 v[128:131], a[40:43], a[4:7], v[128:131]
    ds_read_b64_tr_b16 a[94:95], v15 offset:15872
    v_mfma_f32_16x16x32_bf16 v[132:135], a[40:43], a[8:11], v[132:135]
    v_mfma_f32_16x16x32_bf16 v[136:139], a[40:43], a[12:15], v[136:139]
    v_mfma_f32_16x16x32_bf16 v[140:143], a[44:47], a[0:3], v[140:143]
    v_mfma_f32_16x16x32_bf16 v[144:147], a[44:47], a[4:7], v[144:147]
    v_mfma_f32_16x16x32_bf16 v[148:151], a[44:47], a[8:11], v[148:151]
    v_mfma_f32_16x16x32_bf16 v[152:155], a[44:47], a[12:15], v[152:155]
    s_waitcnt lgkmcnt(0)
    v_mfma_f32_16x16x32_bf16 v[28:31], a[64:67], a[48:51], v[28:31]
    s_add_u32 s88, s4, 0x830000
    s_addc_u32 s89, s5, 0
    s_mov_b32 s90, 28672
    s_mov_b32 s91, 0x00020000
    s_mul_i32 s42, s30, 896
    s_lshl_b32 s43, s39, 6
    s_add_u32 s42, s42, s43
    s_and_b32 s43, s30, 1
    s_cmp_lg_u32 s43, 0
    s_cselect_b32 s44, 0, 768
    s_cselect_b32 s43, 128, 0
    s_add_u32 s44, s44, s42
    s_add_u32 s43, s43, s42
    s_add_u32 s45, s43, 14336
    s_add_u32 s46, s44, 14336
    v_lshlrev_b32 v3, 4, v2
    s_add_u32 s20, s4, 0x840000
    s_addc_u32 s21, s5, 0
    s_mov_b32 s22, 131072
    s_mov_b32 s23, 0x00020000
    s_lshl_b32 s47, s29, 7
    s_lshl_b32 s48, s38, 6
    s_add_u32 s47, s47, s48
    s_lshl_b32 s47, s47, 6
    v_lshl_add_u32 v4, v1, 6, v3
    buffer_load_dwordx4 a[32:35], v4, s[20:23], s47 offen offset:0
    buffer_load_dwordx4 a[36:39], v4, s[20:23], s47 offen offset:1024
    buffer_load_dwordx4 a[40:43], v4, s[20:23], s47 offen offset:2048
    buffer_load_dwordx4 a[44:47], v4, s[20:23], s47 offen offset:3072
    buffer_load_dwordx4 a[0:3], v3, s[88:91], s43 offen offset:0
    buffer_load_dwordx4 a[4:7], v3, s[88:91], s43 offen offset:128
    buffer_load_dwordx4 a[8:11], v3, s[88:91], s43 offen offset:256
    buffer_load_dwordx4 a[12:15], v3, s[88:91], s43 offen offset:384
    buffer_load_dwordx4 a[16:19], v3, s[88:91], s45 offen offset:0
    buffer_load_dwordx4 a[20:23], v3, s[88:91], s45 offen offset:128
    buffer_load_dwordx4 a[24:27], v3, s[88:91], s45 offen offset:256
    buffer_load_dwordx4 a[28:31], v3, s[88:91], s45 offen offset:384
    v_mfma_f32_16x16x32_bf16 v[32:35], a[64:67], a[52:55], v[32:35]
    v_mfma_f32_16x16x32_bf16 v[36:39], a[64:67], a[56:59], v[36:39]
    v_mfma_f32_16x16x32_bf16 v[40:43], a[64:67], a[60:63], v[40:43]
    v_mfma_f32_16x16x32_bf16 v[44:47], a[68:71], a[48:51], v[44:47]
    v_mfma_f32_16x16x32_bf16 v[48:51], a[68:71], a[52:55], v[48:51]
    v_mfma_f32_16x16x32_bf16 v[52:55], a[68:71], a[56:59], v[52:55]
    v_mfma_f32_16x16x32_bf16 v[56:59], a[68:71], a[60:63], v[56:59]
    v_mfma_f32_16x16x32_bf16 v[60:63], a[72:75], a[48:51], v[60:63]
    v_mfma_f32_16x16x32_bf16 v[64:67], a[72:75], a[52:55], v[64:67]
    v_mfma_f32_16x16x32_bf16 v[68:71], a[72:75], a[56:59], v[68:71]
    v_mfma_f32_16x16x32_bf16 v[72:75], a[72:75], a[60:63], v[72:75]
    v_mfma_f32_16x16x32_bf16 v[76:79], a[76:79], a[48:51], v[76:79]
    v_mfma_f32_16x16x32_bf16 v[80:83], a[76:79], a[52:55], v[80:83]
    v_mfma_f32_16x16x32_bf16 v[84:87], a[76:79], a[56:59], v[84:87]
    v_mfma_f32_16x16x32_bf16 v[88:91], a[76:79], a[60:63], v[88:91]
    v_mfma_f32_16x16x32_bf16 v[92:95], a[80:83], a[48:51], v[92:95]
    v_mfma_f32_16x16x32_bf16 v[96:99], a[80:83], a[52:55], v[96:99]
    v_mfma_f32_16x16x32_bf16 v[100:103], a[80:83], a[56:59], v[100:103]
    v_mfma_f32_16x16x32_bf16 v[104:107], a[80:83], a[60:63], v[104:107]
    v_mfma_f32_16x16x32_bf16 v[108:111], a[84:87], a[48:51], v[108:111]
    v_mfma_f32_16x16x32_bf16 v[112:115], a[84:87], a[52:55], v[112:115]
    v_mfma_f32_16x16x32_bf16 v[116:119], a[84:87], a[56:59], v[116:119]
    v_mfma_f32_16x16x32_bf16 v[120:123], a[84:87], a[60:63], v[120:123]
    v_mfma_f32_16x16x32_bf16 v[124:127], a[88:91], a[48:51], v[124:127]
    v_mfma_f32_16x16x32_bf16 v[128:131], a[88:91], a[52:55], v[128:131]
    v_mfma_f32_16x16x32_bf16 v[132:135], a[88:91], a[56:59], v[132:135]
    v_mfma_f32_16x16x32_bf16 v[136:139], a[88:91], a[60:63], v[136:139]
    v_mfma_f32_16x16x32_bf16 v[140:143], a[92:95], a[48:51], v[140:143]
    v_mfma_f32_16x16x32_bf16 v[144:147], a[92:95], a[52:55], v[144:147]
    v_mfma_f32_16x16x32_bf16 v[148:151], a[92:95], a[56:59], v[148:151]
    v_mfma_f32_16x16x32_bf16 v[152:155], a[92:95], a[60:63], v[152:155]
    s_nop 7
    s_lshl_b32 s42, s29, 7
    s_lshl_b32 s43, s38, 6
    s_add_u32 s42, s42, s43
    s_mul_i32 s42, s42, 7168
    s_mul_i32 s43, s30, 448
    s_add_u32 s42, s42, s43
    s_lshl_b32 s43, s39, 5
    s_add_u32 s42, s42, s43
    s_add_u32 s43, s42, 114688
    s_add_u32 s44, s42, 229376
    s_add_u32 s45, s42, 344064
    s_mov_b32 s46, 7168
    v_mul_lo_u32 v3, v1, s46
    v_lshl_add_u32 v3, v2, 3, v3
    s_and_b32 s47, s30, 1
    s_cmp_lg_u32 s47, 0
    s_cselect_b32 s48, 0, 384
    s_cselect_b32 s47, 64, 0
    s_mov_b32 s50, 0xbdd2d3e8
    s_mov_b32 s51, 0xbdd2d3e8
    v_mov_b32 v4, 0xc0135761
    v_mov_b32 v5, 0xc0135761
    s_waitcnt vmcnt(0)
    v_accvgpr_read_b32 v6, a32
    v_accvgpr_read_b32 v7, a33
    v_accvgpr_read_b32 v8, a34
    v_accvgpr_read_b32 v9, a35
    v_accvgpr_read_b32 v10, a36
    v_accvgpr_read_b32 v11, a37
    v_accvgpr_read_b32 v12, a38
    v_accvgpr_read_b32 v13, a39
    v_add_f32 v14, v6, v8
    v_add_f32 v17, v10, v12
    v_add_f32 v15, v7, v9
    v_add_f32 v18, v11, v13
    s_nop 0
    v_mov_b32 v16, v14
    v_mov_b32 v19, v17
    s_nop 0
    v_permlane16_swap_b32 v14, v16
    v_permlane16_swap_b32 v17, v19
    s_nop 0
    v_add_f32 v14, v14, v16
    v_add_f32 v17, v17, v19
    v_mov_b32 v16, v14
    v_mov_b32 v19, v17
    s_nop 1
    v_permlane32_swap_b32 v14, v16
    v_permlane32_swap_b32 v17, v19
    s_nop 0
    v_add_f32 v14, v14, v16
    v_add_f32 v17, v17, v19
    v_mul_f32 v14, 0x3e000000, v14
    v_mul_f32 v17, 0x3e000000, v17
    v_sub_f32 v6, v6, v14
    v_sub_f32 v10, v10, v17
    v_sub_f32 v8, v8, v14
    v_sub_f32 v12, v12, v17
    v_mul_f32 v6, v6, v6
    v_mul_f32 v10, v10, v10
    v_fmac_f32 v6, v8, v8
    v_fmac_f32 v10, v12, v12
    v_fmac_f32 v15, 0x43000000, v6
    v_fmac_f32 v18, 0x43000000, v10
    s_nop 0
    v_mov_b32 v16, v15
    v_mov_b32 v19, v18
    s_nop 0
    v_permlane16_swap_b32 v15, v16
    v_permlane16_swap_b32 v18, v19
    s_nop 0
    v_add_f32 v15, v15, v16
    v_add_f32 v18, v18, v19
    v_mov_b32 v16, v15
    v_mov_b32 v19, v18
    s_nop 1
    v_permlane32_swap_b32 v15, v16
    v_permlane32_swap_b32 v18, v19
    s_nop 0
    v_add_f32 v15, v15, v16
    v_add_f32 v18, v18, v19
    v_mul_f32 v15, 0x3a800000, v15
    v_mul_f32 v18, 0x3a800000, v18
    v_cvt_pk_bf16_f32 v16, v14, v15
    v_cvt_pk_bf16_f32 v19, v17, v18
    v_lshlrev_b32 v14, 16, v16
    v_lshlrev_b32 v17, 16, v19
    v_and_b32 v15, 0xffff0000, v16
    v_and_b32 v18, 0xffff0000, v19
    v_add_f32 v15, 0x3727c5ac, v15
    v_add_f32 v18, 0x3727c5ac, v18
    v_cvt_pk_bf16_f32 v16, v15, v15
    v_cvt_pk_bf16_f32 v19, v18, v18
    v_lshlrev_b32 v15, 16, v16
    v_lshlrev_b32 v18, 16, v19
    v_sqrt_f32 v15, v15
    v_sqrt_f32 v18, v18
    s_nop 0
    v_cvt_pk_bf16_f32 v16, v15, v15
    v_cvt_pk_bf16_f32 v19, v18, v18
    v_lshlrev_b32 v15, 16, v16
    v_lshlrev_b32 v18, 16, v19
    v_rcp_f32 v20, v15
    v_rcp_f32 v22, v18
    s_nop 0
    v_mul_f32 v21, v14, v20
    v_mul_f32 v23, v17, v22
    v_sub_f32 v21, 0, v21
    v_sub_f32 v23, 0, v23
    v_accvgpr_read_b32 v6, a40
    v_accvgpr_read_b32 v7, a41
    v_accvgpr_read_b32 v8, a42
    v_accvgpr_read_b32 v9, a43
    v_accvgpr_read_b32 v10, a44
    v_accvgpr_read_b32 v11, a45
    v_accvgpr_read_b32 v12, a46
    v_accvgpr_read_b32 v13, a47
    v_add_f32 v14, v6, v8
    v_add_f32 v17, v10, v12
    v_add_f32 v15, v7, v9
    v_add_f32 v18, v11, v13
    s_nop 0
    v_mov_b32 v16, v14
    v_mov_b32 v19, v17
    s_nop 0
    v_permlane16_swap_b32 v14, v16
    v_permlane16_swap_b32 v17, v19
    s_nop 0
    v_add_f32 v14, v14, v16
    v_add_f32 v17, v17, v19
    v_mov_b32 v16, v14
    v_mov_b32 v19, v17
    s_nop 1
    v_permlane32_swap_b32 v14, v16
    v_permlane32_swap_b32 v17, v19
    s_nop 0
    v_add_f32 v14, v14, v16
    v_add_f32 v17, v17, v19
    v_mul_f32 v14, 0x3e000000, v14
    v_mul_f32 v17, 0x3e000000, v17
    v_sub_f32 v6, v6, v14
    v_sub_f32 v10, v10, v17
    v_sub_f32 v8, v8, v14
    v_sub_f32 v12, v12, v17
    v_mul_f32 v6, v6, v6
    v_mul_f32 v10, v10, v10
    v_fmac_f32 v6, v8, v8
    v_fmac_f32 v10, v12, v12
    v_fmac_f32 v15, 0x43000000, v6
    v_fmac_f32 v18, 0x43000000, v10
    s_nop 0
    v_mov_b32 v16, v15
    v_mov_b32 v19, v18
    s_nop 0
    v_permlane16_swap_b32 v15, v16
    v_permlane16_swap_b32 v18, v19
    s_nop 0
    v_add_f32 v15, v15, v16
    v_add_f32 v18, v18, v19
    v_mov_b32 v16, v15
    v_mov_b32 v19, v18
    s_nop 1
    v_permlane32_swap_b32 v15, v16
    v_permlane32_swap_b32 v18, v19
    s_nop 0
    v_add_f32 v15, v15, v16
    v_add_f32 v18, v18, v19
    v_mul_f32 v15, 0x3a800000, v15
    v_mul_f32 v18, 0x3a800000, v18
    v_cvt_pk_bf16_f32 v16, v14, v15
    v_cvt_pk_bf16_f32 v19, v17, v18
    v_lshlrev_b32 v14, 16, v16
    v_lshlrev_b32 v17, 16, v19
    v_and_b32 v15, 0xffff0000, v16
    v_and_b32 v18, 0xffff0000, v19
    v_add_f32 v15, 0x3727c5ac, v15
    v_add_f32 v18, 0x3727c5ac, v18
    v_cvt_pk_bf16_f32 v16, v15, v15
    v_cvt_pk_bf16_f32 v19, v18, v18
    v_lshlrev_b32 v15, 16, v16
    v_lshlrev_b32 v18, 16, v19
    v_sqrt_f32 v15, v15
    v_sqrt_f32 v18, v18
    s_nop 0
    v_cvt_pk_bf16_f32 v16, v15, v15
    v_cvt_pk_bf16_f32 v19, v18, v18
    v_lshlrev_b32 v15, 16, v16
    v_lshlrev_b32 v18, 16, v19
    v_rcp_f32 v24, v15
    v_rcp_f32 v26, v18
    s_nop 0
    v_mul_f32 v25, v14, v24
    v_mul_f32 v27, v17, v26
    v_sub_f32 v25, 0, v25
    v_sub_f32 v27, 0, v27
    v_add_u32 v10, s48, v3
    v_add_u32 v3, s47, v3
    v_accvgpr_read_b32 v12, a0
    v_accvgpr_read_b32 v13, a1
    v_accvgpr_read_b32 v14, a2
    v_accvgpr_read_b32 v15, a3
    v_pk_mul_f32 v[16:17], v[12:13], v[20:21] op_sel:[0,1] op_sel_hi:[1,1]
    v_pk_fma_f32 v[28:29], v[28:29], v[20:21], v[16:17] op_sel:[0,0,0] op_sel_hi:[1,0,1]
    v_pk_mul_f32 v[16:17], v[14:15], v[20:21] op_sel:[0,1] op_sel_hi:[1,1]
    v_pk_fma_f32 v[30:31], v[30:31], v[20:21], v[16:17] op_sel:[0,0,0] op_sel_hi:[1,0,1]
    v_pk_mul_f32 v[16:17], v[12:13], v[22:23] op_sel:[0,1] op_sel_hi:[1,1]
    v_pk_fma_f32 v[32:33], v[32:33], v[22:23], v[16:17] op_sel:[0,0,0] op_sel_hi:[1,0,1]
    v_pk_mul_f32 v[16:17], v[14:15], v[22:23] op_sel:[0,1] op_sel_hi:[1,1]
    v_pk_fma_f32 v[34:35], v[34:35], v[22:23], v[16:17] op_sel:[0,0,0] op_sel_hi:[1,0,1]
    v_pk_mul_f32 v[16:17], v[12:13], v[24:25] op_sel:[0,1] op_sel_hi:[1,1]
    v_pk_fma_f32 v[36:37], v[36:37], v[24:25], v[16:17] op_sel:[0,0,0] op_sel_hi:[1,0,1]
    v_pk_mul_f32 v[16:17], v[14:15], v[24:25] op_sel:[0,1] op_sel_hi:[1,1]
    v_pk_fma_f32 v[38:39], v[38:39], v[24:25], v[16:17] op_sel:[0,0,0] op_sel_hi:[1,0,1]
    v_pk_mul_f32 v[16:17], v[12:13], v[26:27] op_sel:[0,1] op_sel_hi:[1,1]
    v_pk_fma_f32 v[40:41], v[40:41], v[26:27], v[16:17] op_sel:[0,0,0] op_sel_hi:[1,0,1]
    v_pk_mul_f32 v[16:17], v[14:15], v[26:27] op_sel:[0,1] op_sel_hi:[1,1]
    v_pk_fma_f32 v[42:43], v[42:43], v[26:27], v[16:17] op_sel:[0,0,0] op_sel_hi:[1,0,1]
    v_accvgpr_read_b32 v12, a16
    v_accvgpr_read_b32 v13, a17
    v_accvgpr_read_b32 v14, a18
    v_accvgpr_read_b32 v15, a19
    v_pk_mul_f32 v[16:17], v[12:13], v[20:21] op_sel:[0,1] op_sel_hi:[1,1]
    v_pk_fma_f32 v[92:93], v[92:93], v[20:21], v[16:17] op_sel:[0,0,0] op_sel_hi:[1,0,1]
    v_pk_mul_f32 v[16:17], v[14:15], v[20:21] op_sel:[0,1] op_sel_hi:[1,1]
    v_pk_fma_f32 v[94:95], v[94:95], v[20:21], v[16:17] op_sel:[0,0,0] op_sel_hi:[1,0,1]
    v_pk_mul_f32 v[16:17], v[12:13], v[22:23] op_sel:[0,1] op_sel_hi:[1,1]
    v_pk_fma_f32 v[96:97], v[96:97], v[22:23], v[16:17] op_sel:[0,0,0] op_sel_hi:[1,0,1]
    v_pk_mul_f32 v[16:17], v[14:15], v[22:23] op_sel:[0,1] op_sel_hi:[1,1]
    v_pk_fma_f32 v[98:99], v[98:99], v[22:23], v[16:17] op_sel:[0,0,0] op_sel_hi:[1,0,1]
    v_pk_mul_f32 v[16:17], v[12:13], v[24:25] op_sel:[0,1] op_sel_hi:[1,1]
    v_pk_fma_f32 v[100:101], v[100:101], v[24:25], v[16:17] op_sel:[0,0,0] op_sel_hi:[1,0,1]
    v_pk_mul_f32 v[16:17], v[14:15], v[24:25] op_sel:[0,1] op_sel_hi:[1,1]
    v_pk_fma_f32 v[102:103], v[102:103], v[24:25], v[16:17] op_sel:[0,0,0] op_sel_hi:[1,0,1]
    v_pk_mul_f32 v[16:17], v[12:13], v[26:27] op_sel:[0,1] op_sel_hi:[1,1]
    v_pk_fma_f32 v[104:105], v[104:105], v[26:27], v[16:17] op_sel:[0,0,0] op_sel_hi:[1,0,1]
    v_pk_mul_f32 v[16:17], v[14:15], v[26:27] op_sel:[0,1] op_sel_hi:[1,1]
    v_pk_fma_f32 v[106:107], v[106:107], v[26:27], v[16:17] op_sel:[0,0,0] op_sel_hi:[1,0,1]
    v_accvgpr_read_b32 v12, a4
    v_accvgpr_read_b32 v13, a5
    v_accvgpr_read_b32 v14, a6
    v_accvgpr_read_b32 v15, a7
    v_pk_mul_f32 v[16:17], v[12:13], v[20:21] op_sel:[0,1] op_sel_hi:[1,1]
    v_pk_fma_f32 v[44:45], v[44:45], v[20:21], v[16:17] op_sel:[0,0,0] op_sel_hi:[1,0,1]
    v_pk_mul_f32 v[16:17], v[14:15], v[20:21] op_sel:[0,1] op_sel_hi:[1,1]
    v_pk_fma_f32 v[46:47], v[46:47], v[20:21], v[16:17] op_sel:[0,0,0] op_sel_hi:[1,0,1]
    v_pk_mul_f32 v[16:17], v[12:13], v[22:23] op_sel:[0,1] op_sel_hi:[1,1]
    v_pk_fma_f32 v[48:49], v[48:49], v[22:23], v[16:17] op_sel:[0,0,0] op_sel_hi:[1,0,1]
    v_pk_mul_f32 v[16:17], v[14:15], v[22:23] op_sel:[0,1] op_sel_hi:[1,1]
    v_pk_fma_f32 v[50:51], v[50:51], v[22:23], v[16:17] op_sel:[0,0,0] op_sel_hi:[1,0,1]
    v_pk_mul_f32 v[16:17], v[12:13], v[24:25] op_sel:[0,1] op_sel_hi:[1,1]
    v_pk_fma_f32 v[52:53], v[52:53], v[24:25], v[16:17] op_sel:[0,0,0] op_sel_hi:[1,0,1]
    v_pk_mul_f32 v[16:17], v[14:15], v[24:25] op_sel:[0,1] op_sel_hi:[1,1]
    v_pk_fma_f32 v[54:55], v[54:55], v[24:25], v[16:17] op_sel:[0,0,0] op_sel_hi:[1,0,1]
    v_pk_mul_f32 v[16:17], v[12:13], v[26:27] op_sel:[0,1] op_sel_hi:[1,1]
    v_pk_fma_f32 v[56:57], v[56:57], v[26:27], v[16:17] op_sel:[0,0,0] op_sel_hi:[1,0,1]
    v_pk_mul_f32 v[16:17], v[14:15], v[26:27] op_sel:[0,1] op_sel_hi:[1,1]
    v_pk_fma_f32 v[58:59], v[58:59], v[26:27], v[16:17] op_sel:[0,0,0] op_sel_hi:[1,0,1]
    v_accvgpr_read_b32 v12, a20
    v_accvgpr_read_b32 v13, a21
    v_accvgpr_read_b32 v14, a22
    v_accvgpr_read_b32 v15, a23
    v_pk_mul_f32 v[16:17], v[12:13], v[20:21] op_sel:[0,1] op_sel_hi:[1,1]
    v_pk_fma_f32 v[108:109], v[108:109], v[20:21], v[16:17] op_sel:[0,0,0] op_sel_hi:[1,0,1]
    v_pk_mul_f32 v[16:17], v[14:15], v[20:21] op_sel:[0,1] op_sel_hi:[1,1]
    v_pk_fma_f32 v[110:111], v[110:111], v[20:21], v[16:17] op_sel:[0,0,0] op_sel_hi:[1,0,1]
    v_pk_mul_f32 v[16:17], v[12:13], v[22:23] op_sel:[0,1] op_sel_hi:[1,1]
    v_pk_fma_f32 v[112:113], v[112:113], v[22:23], v[16:17] op_sel:[0,0,0] op_sel_hi:[1,0,1]
    v_pk_mul_f32 v[16:17], v[14:15], v[22:23] op_sel:[0,1] op_sel_hi:[1,1]
    v_pk_fma_f32 v[114:115], v[114:115], v[22:23], v[16:17] op_sel:[0,0,0] op_sel_hi:[1,0,1]
    v_pk_mul_f32 v[16:17], v[12:13], v[24:25] op_sel:[0,1] op_sel_hi:[1,1]
    v_pk_fma_f32 v[116:117], v[116:117], v[24:25], v[16:17] op_sel:[0,0,0] op_sel_hi:[1,0,1]
    v_pk_mul_f32 v[16:17], v[14:15], v[24:25] op_sel:[0,1] op_sel_hi:[1,1]
    v_pk_fma_f32 v[118:119], v[118:119], v[24:25], v[16:17] op_sel:[0,0,0] op_sel_hi:[1,0,1]
    v_pk_mul_f32 v[16:17], v[12:13], v[26:27] op_sel:[0,1] op_sel_hi:[1,1]
    v_pk_fma_f32 v[120:121], v[120:121], v[26:27], v[16:17] op_sel:[0,0,0] op_sel_hi:[1,0,1]
    v_pk_mul_f32 v[16:17], v[14:15], v[26:27] op_sel:[0,1] op_sel_hi:[1,1]
    v_pk_fma_f32 v[122:123], v[122:123], v[26:27], v[16:17] op_sel:[0,0,0] op_sel_hi:[1,0,1]
    v_accvgpr_read_b32 v12, a8
    v_accvgpr_read_b32 v13, a9
    v_accvgpr_read_b32 v14, a10
    v_accvgpr_read_b32 v15, a11
    v_pk_mul_f32 v[16:17], v[12:13], v[20:21] op_sel:[0,1] op_sel_hi:[1,1]
    v_pk_fma_f32 v[60:61], v[60:61], v[20:21], v[16:17] op_sel:[0,0,0] op_sel_hi:[1,0,1]
    v_pk_mul_f32 v[16:17], v[14:15], v[20:21] op_sel:[0,1] op_sel_hi:[1,1]
    v_pk_fma_f32 v[62:63], v[62:63], v[20:21], v[16:17] op_sel:[0,0,0] op_sel_hi:[1,0,1]
    v_pk_mul_f32 v[16:17], v[12:13], v[22:23] op_sel:[0,1] op_sel_hi:[1,1]
    v_pk_fma_f32 v[64:65], v[64:65], v[22:23], v[16:17] op_sel:[0,0,0] op_sel_hi:[1,0,1]
    v_pk_mul_f32 v[16:17], v[14:15], v[22:23] op_sel:[0,1] op_sel_hi:[1,1]
    v_pk_fma_f32 v[66:67], v[66:67], v[22:23], v[16:17] op_sel:[0,0,0] op_sel_hi:[1,0,1]
    v_pk_mul_f32 v[16:17], v[12:13], v[24:25] op_sel:[0,1] op_sel_hi:[1,1]
    v_pk_fma_f32 v[68:69], v[68:69], v[24:25], v[16:17] op_sel:[0,0,0] op_sel_hi:[1,0,1]
    v_pk_mul_f32 v[16:17], v[14:15], v[24:25] op_sel:[0,1] op_sel_hi:[1,1]
    v_pk_fma_f32 v[70:71], v[70:71], v[24:25], v[16:17] op_sel:[0,0,0] op_sel_hi:[1,0,1]
    v_pk_mul_f32 v[16:17], v[12:13], v[26:27] op_sel:[0,1] op_sel_hi:[1,1]
    v_pk_fma_f32 v[72:73], v[72:73], v[26:27], v[16:17] op_sel:[0,0,0] op_sel_hi:[1,0,1]
    v_pk_mul_f32 v[16:17], v[14:15], v[26:27] op_sel:[0,1] op_sel_hi:[1,1]
    v_pk_fma_f32 v[74:75], v[74:75], v[26:27], v[16:17] op_sel:[0,0,0] op_sel_hi:[1,0,1]
    v_accvgpr_read_b32 v12, a24
    v_accvgpr_read_b32 v13, a25
    v_accvgpr_read_b32 v14, a26
    v_accvgpr_read_b32 v15, a27
    v_pk_mul_f32 v[16:17], v[12:13], v[20:21] op_sel:[0,1] op_sel_hi:[1,1]
    v_pk_fma_f32 v[124:125], v[124:125], v[20:21], v[16:17] op_sel:[0,0,0] op_sel_hi:[1,0,1]
    v_pk_mul_f32 v[16:17], v[14:15], v[20:21] op_sel:[0,1] op_sel_hi:[1,1]
    v_pk_fma_f32 v[126:127], v[126:127], v[20:21], v[16:17] op_sel:[0,0,0] op_sel_hi:[1,0,1]
    v_pk_mul_f32 v[16:17], v[12:13], v[22:23] op_sel:[0,1] op_sel_hi:[1,1]
    v_pk_fma_f32 v[128:129], v[128:129], v[22:23], v[16:17] op_sel:[0,0,0] op_sel_hi:[1,0,1]
    v_pk_mul_f32 v[16:17], v[14:15], v[22:23] op_sel:[0,1] op_sel_hi:[1,1]
    v_pk_fma_f32 v[130:131], v[130:131], v[22:23], v[16:17] op_sel:[0,0,0] op_sel_hi:[1,0,1]
    v_pk_mul_f32 v[16:17], v[12:13], v[24:25] op_sel:[0,1] op_sel_hi:[1,1]
    v_pk_fma_f32 v[132:133], v[132:133], v[24:25], v[16:17] op_sel:[0,0,0] op_sel_hi:[1,0,1]
    v_pk_mul_f32 v[16:17], v[14:15], v[24:25] op_sel:[0,1] op_sel_hi:[1,1]
    v_pk_fma_f32 v[134:135], v[134:135], v[24:25], v[16:17] op_sel:[0,0,0] op_sel_hi:[1,0,1]
    v_pk_mul_f32 v[16:17], v[12:13], v[26:27] op_sel:[0,1] op_sel_hi:[1,1]
    v_pk_fma_f32 v[136:137], v[136:137], v[26:27], v[16:17] op_sel:[0,0,0] op_sel_hi:[1,0,1]
    v_pk_mul_f32 v[16:17], v[14:15], v[26:27] op_sel:[0,1] op_sel_hi:[1,1]
    v_pk_fma_f32 v[138:139], v[138:139], v[26:27], v[16:17] op_sel:[0,0,0] op_sel_hi:[1,0,1]
    v_accvgpr_read_b32 v12, a12
    v_accvgpr_read_b32 v13, a13
    v_accvgpr_read_b32 v14, a14
    v_accvgpr_read_b32 v15, a15
    v_pk_mul_f32 v[16:17], v[12:13], v[20:21] op_sel:[0,1] op_sel_hi:[1,1]
    v_pk_fma_f32 v[76:77], v[76:77], v[20:21], v[16:17] op_sel:[0,0,0] op_sel_hi:[1,0,1]
    v_pk_mul_f32 v[16:17], v[14:15], v[20:21] op_sel:[0,1] op_sel_hi:[1,1]
    v_pk_fma_f32 v[78:79], v[78:79], v[20:21], v[16:17] op_sel:[0,0,0] op_sel_hi:[1,0,1]
    v_pk_mul_f32 v[16:17], v[12:13], v[22:23] op_sel:[0,1] op_sel_hi:[1,1]
    v_pk_fma_f32 v[80:81], v[80:81], v[22:23], v[16:17] op_sel:[0,0,0] op_sel_hi:[1,0,1]
    v_pk_mul_f32 v[16:17], v[14:15], v[22:23] op_sel:[0,1] op_sel_hi:[1,1]
    v_pk_fma_f32 v[82:83], v[82:83], v[22:23], v[16:17] op_sel:[0,0,0] op_sel_hi:[1,0,1]
    v_pk_mul_f32 v[16:17], v[12:13], v[24:25] op_sel:[0,1] op_sel_hi:[1,1]
    v_pk_fma_f32 v[84:85], v[84:85], v[24:25], v[16:17] op_sel:[0,0,0] op_sel_hi:[1,0,1]
    v_pk_mul_f32 v[16:17], v[14:15], v[24:25] op_sel:[0,1] op_sel_hi:[1,1]
    v_pk_fma_f32 v[86:87], v[86:87], v[24:25], v[16:17] op_sel:[0,0,0] op_sel_hi:[1,0,1]
    v_pk_mul_f32 v[16:17], v[12:13], v[26:27] op_sel:[0,1] op_sel_hi:[1,1]
    v_pk_fma_f32 v[88:89], v[88:89], v[26:27], v[16:17] op_sel:[0,0,0] op_sel_hi:[1,0,1]
    v_pk_mul_f32 v[16:17], v[14:15], v[26:27] op_sel:[0,1] op_sel_hi:[1,1]
    v_pk_fma_f32 v[90:91], v[90:91], v[26:27], v[16:17] op_sel:[0,0,0] op_sel_hi:[1,0,1]
    v_accvgpr_read_b32 v12, a28
    v_accvgpr_read_b32 v13, a29
    v_accvgpr_read_b32 v14, a30
    v_accvgpr_read_b32 v15, a31
    v_pk_mul_f32 v[16:17], v[12:13], v[20:21] op_sel:[0,1] op_sel_hi:[1,1]
    v_pk_fma_f32 v[140:141], v[140:141], v[20:21], v[16:17] op_sel:[0,0,0] op_sel_hi:[1,0,1]
    v_pk_mul_f32 v[16:17], v[14:15], v[20:21] op_sel:[0,1] op_sel_hi:[1,1]
    v_pk_fma_f32 v[142:143], v[142:143], v[20:21], v[16:17] op_sel:[0,0,0] op_sel_hi:[1,0,1]
    v_pk_mul_f32 v[16:17], v[12:13], v[22:23] op_sel:[0,1] op_sel_hi:[1,1]
    v_pk_fma_f32 v[144:145], v[144:145], v[22:23], v[16:17] op_sel:[0,0,0] op_sel_hi:[1,0,1]
    v_pk_mul_f32 v[16:17], v[14:15], v[22:23] op_sel:[0,1] op_sel_hi:[1,1]
    v_pk_fma_f32 v[146:147], v[146:147], v[22:23], v[16:17] op_sel:[0,0,0] op_sel_hi:[1,0,1]
    v_pk_mul_f32 v[16:17], v[12:13], v[24:25] op_sel:[0,1] op_sel_hi:[1,1]
    v_pk_fma_f32 v[148:149], v[148:149], v[24:25], v[16:17] op_sel:[0,0,0] op_sel_hi:[1,0,1]
    v_pk_mul_f32 v[16:17], v[14:15], v[24:25] op_sel:[0,1] op_sel_hi:[1,1]
    v_pk_fma_f32 v[150:151], v[150:151], v[24:25], v[16:17] op_sel:[0,0,0] op_sel_hi:[1,0,1]
    v_pk_mul_f32 v[16:17], v[12:13], v[26:27] op_sel:[0,1] op_sel_hi:[1,1]
    v_pk_fma_f32 v[152:153], v[152:153], v[26:27], v[16:17] op_sel:[0,0,0] op_sel_hi:[1,0,1]
    v_pk_mul_f32 v[16:17], v[14:15], v[26:27] op_sel:[0,1] op_sel_hi:[1,1]
    v_pk_fma_f32 v[154:155], v[154:155], v[26:27], v[16:17] op_sel:[0,0,0] op_sel_hi:[1,0,1]
    v_pk_mul_f32 v[6:7], v[28:29], v[28:29]
    v_pk_mul_f32 v[8:9], v[30:31], v[30:31]
    v_pk_fma_f32 v[6:7], v[6:7], s[50:51], v[4:5]
    v_pk_fma_f32 v[8:9], v[8:9], s[50:51], v[4:5]
    v_pk_mul_f32 v[6:7], v[6:7], v[28:29]
    v_pk_mul_f32 v[8:9], v[8:9], v[30:31]
    v_exp_f32 v6, v6
    v_exp_f32 v7, v7
    v_exp_f32 v8, v8
    v_exp_f32 v9, v9
    v_pk_mul_f32 v[28:29], v[28:29], v[92:93]
    v_pk_mul_f32 v[30:31], v[30:31], v[94:95]
    v_add_f32 v6, 1.0, v6
    v_add_f32 v7, 1.0, v7
    v_add_f32 v8, 1.0, v8
    v_add_f32 v9, 1.0, v9
    v_rcp_f32 v6, v6
    v_rcp_f32 v7, v7
    v_rcp_f32 v8, v8
    v_rcp_f32 v9, v9
    s_nop 0
    v_pk_mul_f32 v[28:29], v[28:29], v[6:7]
    v_pk_mul_f32 v[30:31], v[30:31], v[8:9]
    v_cvt_pk_bf16_f32 v28, v28, v29
    v_cvt_pk_bf16_f32 v29, v30, v31
    buffer_store_dwordx2 v[28:29], v3, s[16:19], s42 offen offset:0
    v_pk_mul_f32 v[6:7], v[44:45], v[44:45]
    v_pk_mul_f32 v[8:9], v[46:47], v[46:47]
    v_pk_fma_f32 v[6:7], v[6:7], s[50:51], v[4:5]
    v_pk_fma_f32 v[8:9], v[8:9], s[50:51], v[4:5]
    v_pk_mul_f32 v[6:7], v[6:7], v[44:45]
    v_pk_mul_f32 v[8:9], v[8:9], v[46:47]
    v_exp_f32 v6, v6
    v_exp_f32 v7, v7
    v_exp_f32 v8, v8
    v_exp_f32 v9, v9
    v_pk_mul_f32 v[44:45], v[44:45], v[108:109]
    v_pk_mul_f32 v[46:47], v[46:47], v[110:111]
    v_add_f32 v6, 1.0, v6
    v_add_f32 v7, 1.0, v7
    v_add_f32 v8, 1.0, v8
    v_add_f32 v9, 1.0, v9
    v_rcp_f32 v6, v6
    v_rcp_f32 v7, v7
    v_rcp_f32 v8, v8
    v_rcp_f32 v9, v9
    s_nop 0
    v_pk_mul_f32 v[44:45], v[44:45], v[6:7]
    v_pk_mul_f32 v[46:47], v[46:47], v[8:9]
    v_cvt_pk_bf16_f32 v44, v44, v45
    v_cvt_pk_bf16_f32 v45, v46, v47
    buffer_store_dwordx2 v[44:45], v3, s[16:19], s42 offen offset:64
    v_pk_mul_f32 v[6:7], v[60:61], v[60:61]
    v_pk_mul_f32 v[8:9], v[62:63], v[62:63]
    v_pk_fma_f32 v[6:7], v[6:7], s[50:51], v[4:5]
    v_pk_fma_f32 v[8:9], v[8:9], s[50:51], v[4:5]
    v_pk_mul_f32 v[6:7], v[6:7], v[60:61]
    v_pk_mul_f32 v[8:9], v[8:9], v[62:63]
    v_exp_f32 v6, v6
    v_exp_f32 v7, v7
    v_exp_f32 v8, v8
    v_exp_f32 v9, v9
    v_pk_mul_f32 v[60:61], v[60:61], v[124:125]
    v_pk_mul_f32 v[62:63], v[62:63], v[126:127]
    v_add_f32 v6, 1.0, v6
    v_add_f32 v7, 1.0, v7
    v_add_f32 v8, 1.0, v8
    v_add_f32 v9, 1.0, v9
    v_rcp_f32 v6, v6
    v_rcp_f32 v7, v7
    v_rcp_f32 v8, v8
    v_rcp_f32 v9, v9
    s_nop 0
    v_pk_mul_f32 v[60:61], v[60:61], v[6:7]
    v_pk_mul_f32 v[62:63], v[62:63], v[8:9]
    v_cvt_pk_bf16_f32 v60, v60, v61
    v_cvt_pk_bf16_f32 v61, v62, v63
    buffer_store_dwordx2 v[60:61], v3, s[16:19], s42 offen offset:128
    v_pk_mul_f32 v[6:7], v[76:77], v[76:77]
    v_pk_mul_f32 v[8:9], v[78:79], v[78:79]
    v_pk_fma_f32 v[6:7], v[6:7], s[50:51], v[4:5]
    v_pk_fma_f32 v[8:9], v[8:9], s[50:51], v[4:5]
    v_pk_mul_f32 v[6:7], v[6:7], v[76:77]
    v_pk_mul_f32 v[8:9], v[8:9], v[78:79]
    v_exp_f32 v6, v6
    v_exp_f32 v7, v7
    v_exp_f32 v8, v8
    v_exp_f32 v9, v9
    v_pk_mul_f32 v[76:77], v[76:77], v[140:141]
    v_pk_mul_f32 v[78:79], v[78:79], v[142:143]
    v_add_f32 v6, 1.0, v6
    v_add_f32 v7, 1.0, v7
    v_add_f32 v8, 1.0, v8
    v_add_f32 v9, 1.0, v9
    v_rcp_f32 v6, v6
    v_rcp_f32 v7, v7
    v_rcp_f32 v8, v8
    v_rcp_f32 v9, v9
    s_nop 0
    v_pk_mul_f32 v[76:77], v[76:77], v[6:7]
    v_pk_mul_f32 v[78:79], v[78:79], v[8:9]
    v_cvt_pk_bf16_f32 v76, v76, v77
    v_cvt_pk_bf16_f32 v77, v78, v79
    buffer_store_dwordx2 v[76:77], v3, s[16:19], s42 offen offset:192
    v_pk_mul_f32 v[6:7], v[32:33], v[32:33]
    v_pk_mul_f32 v[8:9], v[34:35], v[34:35]
    v_pk_fma_f32 v[6:7], v[6:7], s[50:51], v[4:5]
    v_pk_fma_f32 v[8:9], v[8:9], s[50:51], v[4:5]
    v_pk_mul_f32 v[6:7], v[6:7], v[32:33]
    v_pk_mul_f32 v[8:9], v[8:9], v[34:35]
    v_exp_f32 v6, v6
    v_exp_f32 v7, v7
    v_exp_f32 v8, v8
    v_exp_f32 v9, v9
    v_pk_mul_f32 v[32:33], v[32:33], v[96:97]
    v_pk_mul_f32 v[34:35], v[34:35], v[98:99]
    v_add_f32 v6, 1.0, v6
    v_add_f32 v7, 1.0, v7
    v_add_f32 v8, 1.0, v8
    v_add_f32 v9, 1.0, v9
    v_rcp_f32 v6, v6
    v_rcp_f32 v7, v7
    v_rcp_f32 v8, v8
    v_rcp_f32 v9, v9
    s_nop 0
    v_pk_mul_f32 v[32:33], v[32:33], v[6:7]
    v_pk_mul_f32 v[34:35], v[34:35], v[8:9]
    v_cvt_pk_bf16_f32 v32, v32, v33
    v_cvt_pk_bf16_f32 v33, v34, v35
    buffer_store_dwordx2 v[32:33], v3, s[16:19], s43 offen offset:0
    v_pk_mul_f32 v[6:7], v[48:49], v[48:49]
    v_pk_mul_f32 v[8:9], v[50:51], v[50:51]
    v_pk_fma_f32 v[6:7], v[6:7], s[50:51], v[4:5]
    v_pk_fma_f32 v[8:9], v[8:9], s[50:51], v[4:5]
    v_pk_mul_f32 v[6:7], v[6:7], v[48:49]
    v_pk_mul_f32 v[8:9], v[8:9], v[50:51]
    v_exp_f32 v6, v6
    v_exp_f32 v7, v7
    v_exp_f32 v8, v8
    v_exp_f32 v9, v9
    v_pk_mul_f32 v[48:49], v[48:49], v[112:113]
    v_pk_mul_f32 v[50:51], v[50:51], v[114:115]
    v_add_f32 v6, 1.0, v6
    v_add_f32 v7, 1.0, v7
    v_add_f32 v8, 1.0, v8
    v_add_f32 v9, 1.0, v9
    v_rcp_f32 v6, v6
    v_rcp_f32 v7, v7
    v_rcp_f32 v8, v8
    v_rcp_f32 v9, v9
    s_nop 0
    v_pk_mul_f32 v[48:49], v[48:49], v[6:7]
    v_pk_mul_f32 v[50:51], v[50:51], v[8:9]
    v_cvt_pk_bf16_f32 v48, v48, v49
    v_cvt_pk_bf16_f32 v49, v50, v51
    buffer_store_dwordx2 v[48:49], v3, s[16:19], s43 offen offset:64
    v_pk_mul_f32 v[6:7], v[64:65], v[64:65]
    v_pk_mul_f32 v[8:9], v[66:67], v[66:67]
    v_pk_fma_f32 v[6:7], v[6:7], s[50:51], v[4:5]
    v_pk_fma_f32 v[8:9], v[8:9], s[50:51], v[4:5]
    v_pk_mul_f32 v[6:7], v[6:7], v[64:65]
    v_pk_mul_f32 v[8:9], v[8:9], v[66:67]
    v_exp_f32 v6, v6
    v_exp_f32 v7, v7
    v_exp_f32 v8, v8
    v_exp_f32 v9, v9
    v_pk_mul_f32 v[64:65], v[64:65], v[128:129]
    v_pk_mul_f32 v[66:67], v[66:67], v[130:131]
    v_add_f32 v6, 1.0, v6
    v_add_f32 v7, 1.0, v7
    v_add_f32 v8, 1.0, v8
    v_add_f32 v9, 1.0, v9
    v_rcp_f32 v6, v6
    v_rcp_f32 v7, v7
    v_rcp_f32 v8, v8
    v_rcp_f32 v9, v9
    s_nop 0
    v_pk_mul_f32 v[64:65], v[64:65], v[6:7]
    v_pk_mul_f32 v[66:67], v[66:67], v[8:9]
    v_cvt_pk_bf16_f32 v64, v64, v65
    v_cvt_pk_bf16_f32 v65, v66, v67
    buffer_store_dwordx2 v[64:65], v3, s[16:19], s43 offen offset:128
    v_pk_mul_f32 v[6:7], v[80:81], v[80:81]
    v_pk_mul_f32 v[8:9], v[82:83], v[82:83]
    v_pk_fma_f32 v[6:7], v[6:7], s[50:51], v[4:5]
    v_pk_fma_f32 v[8:9], v[8:9], s[50:51], v[4:5]
    v_pk_mul_f32 v[6:7], v[6:7], v[80:81]
    v_pk_mul_f32 v[8:9], v[8:9], v[82:83]
    v_exp_f32 v6, v6
    v_exp_f32 v7, v7
    v_exp_f32 v8, v8
    v_exp_f32 v9, v9
    v_pk_mul_f32 v[80:81], v[80:81], v[144:145]
    v_pk_mul_f32 v[82:83], v[82:83], v[146:147]
    v_add_f32 v6, 1.0, v6
    v_add_f32 v7, 1.0, v7
    v_add_f32 v8, 1.0, v8
    v_add_f32 v9, 1.0, v9
    v_rcp_f32 v6, v6
    v_rcp_f32 v7, v7
    v_rcp_f32 v8, v8
    v_rcp_f32 v9, v9
    s_nop 0
    v_pk_mul_f32 v[80:81], v[80:81], v[6:7]
    v_pk_mul_f32 v[82:83], v[82:83], v[8:9]
    v_cvt_pk_bf16_f32 v80, v80, v81
    v_cvt_pk_bf16_f32 v81, v82, v83
    buffer_store_dwordx2 v[80:81], v3, s[16:19], s43 offen offset:192
    v_pk_mul_f32 v[6:7], v[36:37], v[36:37]
    v_pk_mul_f32 v[8:9], v[38:39], v[38:39]
    v_pk_fma_f32 v[6:7], v[6:7], s[50:51], v[4:5]
    v_pk_fma_f32 v[8:9], v[8:9], s[50:51], v[4:5]
    v_pk_mul_f32 v[6:7], v[6:7], v[36:37]
    v_pk_mul_f32 v[8:9], v[8:9], v[38:39]
    v_exp_f32 v6, v6
    v_exp_f32 v7, v7
    v_exp_f32 v8, v8
    v_exp_f32 v9, v9
    v_pk_mul_f32 v[36:37], v[36:37], v[100:101]
    v_pk_mul_f32 v[38:39], v[38:39], v[102:103]
    v_add_f32 v6, 1.0, v6
    v_add_f32 v7, 1.0, v7
    v_add_f32 v8, 1.0, v8
    v_add_f32 v9, 1.0, v9
    v_rcp_f32 v6, v6
    v_rcp_f32 v7, v7
    v_rcp_f32 v8, v8
    v_rcp_f32 v9, v9
    s_nop 0
    v_pk_mul_f32 v[36:37], v[36:37], v[6:7]
    v_pk_mul_f32 v[38:39], v[38:39], v[8:9]
    v_cvt_pk_bf16_f32 v36, v36, v37
    v_cvt_pk_bf16_f32 v37, v38, v39
    buffer_store_dwordx2 v[36:37], v3, s[16:19], s44 offen offset:0
    v_pk_mul_f32 v[6:7], v[52:53], v[52:53]
    v_pk_mul_f32 v[8:9], v[54:55], v[54:55]
    v_pk_fma_f32 v[6:7], v[6:7], s[50:51], v[4:5]
    v_pk_fma_f32 v[8:9], v[8:9], s[50:51], v[4:5]
    v_pk_mul_f32 v[6:7], v[6:7], v[52:53]
    v_pk_mul_f32 v[8:9], v[8:9], v[54:55]
    v_exp_f32 v6, v6
    v_exp_f32 v7, v7
    v_exp_f32 v8, v8
    v_exp_f32 v9, v9
    v_pk_mul_f32 v[52:53], v[52:53], v[116:117]
    v_pk_mul_f32 v[54:55], v[54:55], v[118:119]
    v_add_f32 v6, 1.0, v6
    v_add_f32 v7, 1.0, v7
    v_add_f32 v8, 1.0, v8
    v_add_f32 v9, 1.0, v9
    v_rcp_f32 v6, v6
    v_rcp_f32 v7, v7
    v_rcp_f32 v8, v8
    v_rcp_f32 v9, v9
    s_nop 0
    v_pk_mul_f32 v[52:53], v[52:53], v[6:7]
    v_pk_mul_f32 v[54:55], v[54:55], v[8:9]
    v_cvt_pk_bf16_f32 v52, v52, v53
    v_cvt_pk_bf16_f32 v53, v54, v55
    buffer_store_dwordx2 v[52:53], v3, s[16:19], s44 offen offset:64
    v_pk_mul_f32 v[6:7], v[68:69], v[68:69]
    v_pk_mul_f32 v[8:9], v[70:71], v[70:71]
    v_pk_fma_f32 v[6:7], v[6:7], s[50:51], v[4:5]
    v_pk_fma_f32 v[8:9], v[8:9], s[50:51], v[4:5]
    v_pk_mul_f32 v[6:7], v[6:7], v[68:69]
    v_pk_mul_f32 v[8:9], v[8:9], v[70:71]
    v_exp_f32 v6, v6
    v_exp_f32 v7, v7
    v_exp_f32 v8, v8
    v_exp_f32 v9, v9
    v_pk_mul_f32 v[68:69], v[68:69], v[132:133]
    v_pk_mul_f32 v[70:71], v[70:71], v[134:135]
    v_add_f32 v6, 1.0, v6
    v_add_f32 v7, 1.0, v7
    v_add_f32 v8, 1.0, v8
    v_add_f32 v9, 1.0, v9
    v_rcp_f32 v6, v6
    v_rcp_f32 v7, v7
    v_rcp_f32 v8, v8
    v_rcp_f32 v9, v9
    s_nop 0
    v_pk_mul_f32 v[68:69], v[68:69], v[6:7]
    v_pk_mul_f32 v[70:71], v[70:71], v[8:9]
    v_cvt_pk_bf16_f32 v68, v68, v69
    v_cvt_pk_bf16_f32 v69, v70, v71
    buffer_store_dwordx2 v[68:69], v3, s[16:19], s44 offen offset:128
    v_pk_mul_f32 v[6:7], v[84:85], v[84:85]
    v_pk_mul_f32 v[8:9], v[86:87], v[86:87]
    v_pk_fma_f32 v[6:7], v[6:7], s[50:51], v[4:5]
    v_pk_fma_f32 v[8:9], v[8:9], s[50:51], v[4:5]
    v_pk_mul_f32 v[6:7], v[6:7], v[84:85]
    v_pk_mul_f32 v[8:9], v[8:9], v[86:87]
    v_exp_f32 v6, v6
    v_exp_f32 v7, v7
    v_exp_f32 v8, v8
    v_exp_f32 v9, v9
    v_pk_mul_f32 v[84:85], v[84:85], v[148:149]
    v_pk_mul_f32 v[86:87], v[86:87], v[150:151]
    v_add_f32 v6, 1.0, v6
    v_add_f32 v7, 1.0, v7
    v_add_f32 v8, 1.0, v8
    v_add_f32 v9, 1.0, v9
    v_rcp_f32 v6, v6
    v_rcp_f32 v7, v7
    v_rcp_f32 v8, v8
    v_rcp_f32 v9, v9
    s_nop 0
    v_pk_mul_f32 v[84:85], v[84:85], v[6:7]
    v_pk_mul_f32 v[86:87], v[86:87], v[8:9]
    v_cvt_pk_bf16_f32 v84, v84, v85
    v_cvt_pk_bf16_f32 v85, v86, v87
    buffer_store_dwordx2 v[84:85], v3, s[16:19], s44 offen offset:192
    v_pk_mul_f32 v[6:7], v[40:41], v[40:41]
    v_pk_mul_f32 v[8:9], v[42:43], v[42:43]
    v_pk_fma_f32 v[6:7], v[6:7], s[50:51], v[4:5]
    v_pk_fma_f32 v[8:9], v[8:9], s[50:51], v[4:5]
    v_pk_mul_f32 v[6:7], v[6:7], v[40:41]
    v_pk_mul_f32 v[8:9], v[8:9], v[42:43]
    v_exp_f32 v6, v6
    v_exp_f32 v7, v7
    v_exp_f32 v8, v8
    v_exp_f32 v9, v9
    v_pk_mul_f32 v[40:41], v[40:41], v[104:105]
    v_pk_mul_f32 v[42:43], v[42:43], v[106:107]
    v_add_f32 v6, 1.0, v6
    v_add_f32 v7, 1.0, v7
    v_add_f32 v8, 1.0, v8
    v_add_f32 v9, 1.0, v9
    v_rcp_f32 v6, v6
    v_rcp_f32 v7, v7
    v_rcp_f32 v8, v8
    v_rcp_f32 v9, v9
    s_nop 0
    v_pk_mul_f32 v[40:41], v[40:41], v[6:7]
    v_pk_mul_f32 v[42:43], v[42:43], v[8:9]
    v_cvt_pk_bf16_f32 v40, v40, v41
    v_cvt_pk_bf16_f32 v41, v42, v43
    buffer_store_dwordx2 v[40:41], v3, s[16:19], s45 offen offset:0
    v_pk_mul_f32 v[6:7], v[56:57], v[56:57]
    v_pk_mul_f32 v[8:9], v[58:59], v[58:59]
    v_pk_fma_f32 v[6:7], v[6:7], s[50:51], v[4:5]
    v_pk_fma_f32 v[8:9], v[8:9], s[50:51], v[4:5]
    v_pk_mul_f32 v[6:7], v[6:7], v[56:57]
    v_pk_mul_f32 v[8:9], v[8:9], v[58:59]
    v_exp_f32 v6, v6
    v_exp_f32 v7, v7
    v_exp_f32 v8, v8
    v_exp_f32 v9, v9
    v_pk_mul_f32 v[56:57], v[56:57], v[120:121]
    v_pk_mul_f32 v[58:59], v[58:59], v[122:123]
    v_add_f32 v6, 1.0, v6
    v_add_f32 v7, 1.0, v7
    v_add_f32 v8, 1.0, v8
    v_add_f32 v9, 1.0, v9
    v_rcp_f32 v6, v6
    v_rcp_f32 v7, v7
    v_rcp_f32 v8, v8
    v_rcp_f32 v9, v9
    s_nop 0
    v_pk_mul_f32 v[56:57], v[56:57], v[6:7]
    v_pk_mul_f32 v[58:59], v[58:59], v[8:9]
    v_cvt_pk_bf16_f32 v56, v56, v57
    v_cvt_pk_bf16_f32 v57, v58, v59
    buffer_store_dwordx2 v[56:57], v3, s[16:19], s45 offen offset:64
    v_pk_mul_f32 v[6:7], v[72:73], v[72:73]
    v_pk_mul_f32 v[8:9], v[74:75], v[74:75]
    v_pk_fma_f32 v[6:7], v[6:7], s[50:51], v[4:5]
    v_pk_fma_f32 v[8:9], v[8:9], s[50:51], v[4:5]
    v_pk_mul_f32 v[6:7], v[6:7], v[72:73]
    v_pk_mul_f32 v[8:9], v[8:9], v[74:75]
    v_exp_f32 v6, v6
    v_exp_f32 v7, v7
    v_exp_f32 v8, v8
    v_exp_f32 v9, v9
    v_pk_mul_f32 v[72:73], v[72:73], v[136:137]
    v_pk_mul_f32 v[74:75], v[74:75], v[138:139]
    v_add_f32 v6, 1.0, v6
    v_add_f32 v7, 1.0, v7
    v_add_f32 v8, 1.0, v8
    v_add_f32 v9, 1.0, v9
    v_rcp_f32 v6, v6
    v_rcp_f32 v7, v7
    v_rcp_f32 v8, v8
    v_rcp_f32 v9, v9
    s_nop 0
    v_pk_mul_f32 v[72:73], v[72:73], v[6:7]
    v_pk_mul_f32 v[74:75], v[74:75], v[8:9]
    v_cvt_pk_bf16_f32 v72, v72, v73
    v_cvt_pk_bf16_f32 v73, v74, v75
    buffer_store_dwordx2 v[72:73], v3, s[16:19], s45 offen offset:128
    v_pk_mul_f32 v[6:7], v[88:89], v[88:89]
    v_pk_mul_f32 v[8:9], v[90:91], v[90:91]
    v_pk_fma_f32 v[6:7], v[6:7], s[50:51], v[4:5]
    v_pk_fma_f32 v[8:9], v[8:9], s[50:51], v[4:5]
    v_pk_mul_f32 v[6:7], v[6:7], v[88:89]
    v_pk_mul_f32 v[8:9], v[8:9], v[90:91]
    v_exp_f32 v6, v6
    v_exp_f32 v7, v7
    v_exp_f32 v8, v8
    v_exp_f32 v9, v9
    v_pk_mul_f32 v[88:89], v[88:89], v[152:153]
    v_pk_mul_f32 v[90:91], v[90:91], v[154:155]
    v_add_f32 v6, 1.0, v6
    v_add_f32 v7, 1.0, v7
    v_add_f32 v8, 1.0, v8
    v_add_f32 v9, 1.0, v9
    v_rcp_f32 v6, v6
    v_rcp_f32 v7, v7
    v_rcp_f32 v8, v8
    v_rcp_f32 v9, v9
    s_nop 0
    v_pk_mul_f32 v[88:89], v[88:89], v[6:7]
    v_pk_mul_f32 v[90:91], v[90:91], v[8:9]
    v_cvt_pk_bf16_f32 v88, v88, v89
    v_cvt_pk_bf16_f32 v89, v90, v91
    buffer_store_dwordx2 v[88:89], v3, s[16:19], s45 offen offset:192
    s_branch L_end_12
L_role1_13:
    v_lshrrev_b32 v19, 3, v0
    v_and_b32 v20, 7, v0
    v_xor_b32 v20, v20, v19
    s_mov_b32 s42, 0
    s_mul_i32 s43, s38, 16
    s_add_u32 s42, s42, s43
    s_mul_i32 s43, s39, 32
    s_add_u32 s42, s42, s43
    s_mul_i32 s43, s40, 64
    s_add_u32 s42, s42, s43
    s_mul_i32 s43, s29, 128
    s_add_u32 s42, s42, s43
    v_add_u32 v19, s42, v19
    s_mov_b32 s43, 2048
    v_mul_lo_u32 v19, v19, s43
    v_lshl_add_u32 v3, v20, 4, v19
    v_add_u32 v4, 0x4000, v3
    s_mov_b32 s36, 0
    s_mul_i32 s42, s38, 2048
    s_add_u32 s36, s36, s42
    s_mul_i32 s42, s39, 4096
    s_add_u32 s36, s36, s42
    s_mul_i32 s42, s40, 8192
    s_add_u32 s36, s36, s42
    s_mul_i32 s44, s30, 448
    s_mov_b32 s45, 7168
    v_lshrrev_b32 v19, 3, v0
    v_bfe_u32 v21, v0, 4, 1
    v_lshlrev_b32 v21, 1, v21
    v_and_b32 v20, 7, v0
    v_xor_b32 v20, v20, v21
    v_mul_lo_u32 v19, v19, s45
    s_mov_b32 s42, 0
    s_mul_i32 s43, s38, 57344
    s_add_u32 s42, s42, s43
    s_add_u32 s42, s42, s44
    s_and_b32 s43, s30, 1
    s_cmp_lg_u32 s43, 0
    s_cselect_b32 s43, 64, 0
    s_add_u32 s42, s42, s43
    v_add_u32 v19, s42, v19
    s_lshl_b32 s43, s38, 2
    s_xor_b32 s43, s43, 0
    v_xor_b32 v21, s43, v20
    v_lshl_add_u32 v21, v21, 4, v19
    v_add_u32 v5, 0x1c000, v21
    s_lshl_b32 s43, s38, 2
    s_xor_b32 s43, s43, 0
    v_xor_b32 v21, s43, v20
    v_lshl_add_u32 v21, v21, 4, v19
    v_add_u32 v6, 0x1c080, v21
    s_lshl_b32 s43, s38, 2
    s_xor_b32 s43, s43, 0
    v_xor_b32 v21, s43, v20
    v_lshl_add_u32 v21, v21, 4, v19
    v_add_u32 v7, 0x1c100, v21
    v_lshrrev_b32 v19, 2, v0
    v_lshrrev_b32 v21, 5, v0
    v_lshlrev_b32 v21, 1, v21
    v_and_b32 v20, 3, v0
    v_xor_b32 v20, v20, v21
    v_mul_lo_u32 v19, v19, s45
    s_mov_b32 s42, 0
    s_mul_i32 s43, s38, 114688
    s_add_u32 s42, s42, s43
    s_add_u32 s42, s42, s44
    s_and_b32 s43, s30, 1
    s_cmp_lg_u32 s43, 0
    s_cselect_b32 s43, 0, 384
    s_add_u32 s42, s42, s43
    v_add_u32 v19, s42, v19
    v_lshl_add_u32 v19, v20, 4, v19
    v_add_u32 v8, 0x0, v19
    s_mov_b32 s37, 49152
    s_mul_i32 s42, s38, 3072
    s_add_u32 s37, s37, s42
    s_mul_i32 s42, s39, 14336
    s_add_u32 s37, s37, s42
    s_mov_b32 s97, 49152
    s_mul_i32 s42, s38, 1024
    s_add_u32 s97, s97, s42
    s_mul_i32 s42, s39, 14336
    s_add_u32 s97, s97, s42
    s_waitcnt lgkmcnt(0)
    s_add_u32 s8, s4, 0xd00000
    s_addc_u32 s9, s5, 0
    s_mov_b32 s10, 0x400000
    s_mov_b32 s11, 0x00020000
    s_cmp_lg_u32 s39, 0
    s_cselect_b32 s6, s60, s6
    s_cselect_b32 s7, s61, s7
    s_mov_b32 s12, s6
    s_mov_b32 s13, s7
    s_mov_b32 s14, 0x700000
    s_mov_b32 s15, 0x00020000
    s_mov_b32 s32, 0
    s_mov_b32 s33, 0
    s_mov_b32 s35, 0
    s_mov_b32 s96, 0
    s_add_u32 s42, s35, s36
    s_add_u32 m0, s42, 0
    s_nop 0
    buffer_load_dwordx4 v3, s[8:11], s32 offen lds
    s_add_u32 s42, s35, s36
    s_add_u32 m0, s42, 1024
    s_nop 0
    buffer_load_dwordx4 v4, s[8:11], s32 offen lds
    s_add_u32 s32, s32, 128
    s_add_u32 s35, s35, 16384
    s_add_u32 s42, s96, s37
    s_add_u32 m0, s42, 6144
    s_nop 0
    buffer_load_dwordx4 v5, s[12:15], s33 offen lds
    s_add_u32 s42, s96, s37
    s_add_u32 m0, s42, 7168
    s_nop 0
    buffer_load_dwordx4 v6, s[12:15], s33 offen lds
    s_add_u32 s42, s96, s37
    s_add_u32 m0, s42, 8192
    s_nop 0
    buffer_load_dwordx4 v7, s[12:15], s33 offen lds
    s_add_u32 s42, s96, s97
    s_add_u32 m0, s42, 12288
    s_nop 0
    buffer_load_dwordx4 v8, s[12:15], s33 offen lds
    s_add_u32 s33, s33, 229376
    s_add_u32 s96, s96, 28672
    s_add_u32 s42, s96, s37
    s_add_u32 m0, s42, 6144
    s_nop 0
    buffer_load_dwordx4 v5, s[12:15], s33 offen lds
    s_add_u32 s42, s96, s37
    s_add_u32 m0, s42, 7168
    s_nop 0
    buffer_load_dwordx4 v6, s[12:15], s33 offen lds
    s_add_u32 s42, s96, s37
    s_add_u32 m0, s42, 8192
    s_nop 0
    buffer_load_dwordx4 v7, s[12:15], s33 offen lds
    s_add_u32 s42, s96, s97
    s_add_u32 m0, s42, 12288
    s_nop 0
    buffer_load_dwordx4 v8, s[12:15], s33 offen lds
    s_add_u32 s33, s33, 229376
    s_add_u32 s96, s96, 28672
    s_add_u32 s42, s35, s36
    s_add_u32 m0, s42, 0
    s_nop 0
    buffer_load_dwordx4 v3, s[8:11], s32 offen lds
    s_add_u32 s42, s35, s36
    s_add_u32 m0, s42, 1024
    s_nop 0
    buffer_load_dwordx4 v4, s[8:11], s32 offen lds
    s_add_u32 s32, s32, 128
    s_add_u32 s35, s35, 16384
    s_add_u32 s42, s96, s37
    s_add_u32 m0, s42, 6144
    s_nop 0
    buffer_load_dwordx4 v5, s[12:15], s33 offen lds
    s_add_u32 s42, s96, s37
    s_add_u32 m0, s42, 7168
    s_nop 0
    buffer_load_dwordx4 v6, s[12:15], s33 offen lds
    s_add_u32 s42, s96, s37
    s_add_u32 m0, s42, 8192
    s_nop 0
    buffer_load_dwordx4 v7, s[12:15], s33 offen lds
    s_add_u32 s42, s96, s97
    s_add_u32 m0, s42, 12288
    s_nop 0
    buffer_load_dwordx4 v8, s[12:15], s33 offen lds
    s_add_u32 s33, s33, 229376
    s_add_u32 s96, s96, 28672
    s_add_u32 s16, s4, 0x1500000
    s_addc_u32 s17, s5, 0
    s_mov_b32 s18, 0xe00000
    s_mov_b32 s19, 0x00020000
    v_and_b32 v19, 7, v0
    v_xor_b32 v19, v19, v2
    v_lshlrev_b32 v19, 4, v19
    v_lshl_add_u32 v19, v1, 7, v19
    s_mov_b32 s42, 0
    s_mul_i32 s43, s38, 8192
    s_add_u32 s42, s42, s43
    v_add_u32 v9, s42, v19
    v_xor_b32 v10, 64, v9
    s_mov_b32 s42, 3072
    v_mul_lo_u32 v19, v2, s42
    v_lshrrev_b32 v21, 2, v1
    v_lshl_add_u32 v19, v21, 7, v19
    v_bfe_u32 v20, v0, 3, 2
    s_mov_b32 s42, 0
    s_mul_i32 s43, s39, 1
    s_add_u32 s42, s42, s43
    v_xor_b32 v20, s42, v20
    v_lshl_add_u32 v19, v20, 5, v19
    v_bfe_u32 v21, v0, 1, 1
    v_lshl_add_u32 v19, v21, 4, v19
    v_and_b32 v21, 1, v0
    v_lshl_add_u32 v19, v21, 3, v19
    s_mov_b32 s42, 49152
    v_add_u32 v11, s42, v19
    v_xor_b32 v12, 64, v11
    v_lshrrev_b32 v19, 1, v2
    s_mov_b32 s42, 1024
    v_mul_lo_u32 v19, v19, s42
    v_and_b32 v20, 1, v2
    v_lshrrev_b32 v21, 2, v1
    v_lshl_add_u32 v21, v20, 3, v21
    v_lshl_add_u32 v19, v21, 6, v19
    s_mov_b32 s42, 0
    s_mul_i32 s43, s39, 1
    s_add_u32 s42, s42, s43
    v_xor_b32 v20, s42, v20
    v_lshl_add_u32 v19, v20, 5, v19
    v_bfe_u32 v21, v0, 1, 1
    v_lshl_add_u32 v19, v21, 4, v19
    v_and_b32 v21, 1, v0
    v_lshl_add_u32 v19, v21, 3, v19
    s_mov_b32 s42, 49152
    v_add_u32 v13, s42, v19
    s_mov_b32 s34, 0
    s_mov_b32 s41, 0
    v_add_u32 v14, s34, v9
    v_add_u32 v15, s34, v10
    v_add_u32 v16, s41, v11
    v_add_u32 v17, s41, v12
    v_add_u32 v18, s41, v13
    s_waitcnt vmcnt(10) lgkmcnt(0)
    s_barrier
    ds_read_b128 a[0:3], v14 offset:0
    ds_read_b128 a[4:7], v14 offset:2048
    ds_read_b128 a[8:11], v14 offset:4096
    ds_read_b128 a[12:15], v14 offset:6144
    ds_read_b64_tr_b16 a[16:17], v16 offset:2048
    ds_read_b64_tr_b16 a[18:19], v16 offset:2560
    ds_read_b64_tr_b16 a[20:21], v17 offset:2048
    ds_read_b64_tr_b16 a[22:23], v17 offset:2560
    ds_read_b64_tr_b16 a[24:25], v18 offset:12288
    ds_read_b64_tr_b16 a[26:27], v18 offset:12544
    ds_read_b64_tr_b16 a[28:29], v16 offset:16384
    ds_read_b64_tr_b16 a[30:31], v16 offset:16896
    ds_read_b64_tr_b16 a[32:33], v17 offset:16384
    ds_read_b64_tr_b16 a[34:35], v17 offset:16896
    ds_read_b64_tr_b16 a[36:37], v18 offset:26624
    ds_read_b64_tr_b16 a[38:39], v18 offset:26880
    s_add_u32 s42, s35, s36
    s_add_u32 m0, s42, 0
    s_nop 0
    buffer_load_dwordx4 v3, s[8:11], s32 offen lds
    s_add_u32 s42, s35, s36
    s_add_u32 m0, s42, 1024
    s_nop 0
    buffer_load_dwordx4 v4, s[8:11], s32 offen lds
    s_add_u32 s32, s32, 128
    s_add_u32 s42, s96, s37
    s_add_u32 m0, s42, 6144
    s_nop 0
    buffer_load_dwordx4 v5, s[12:15], s33 offen lds
    s_add_u32 s42, s96, s37
    s_add_u32 m0, s42, 7168
    s_nop 0
    buffer_load_dwordx4 v6, s[12:15], s33 offen lds
    s_add_u32 s42, s96, s37
    s_add_u32 m0, s42, 8192
    s_nop 0
    buffer_load_dwordx4 v7, s[12:15], s33 offen lds
    s_add_u32 s42, s96, s97
    s_add_u32 m0, s42, 12288
    s_nop 0
    buffer_load_dwordx4 v8, s[12:15], s33 offen lds
    s_add_u32 s33, s33, 229376
    s_waitcnt lgkmcnt(0)
    s_mov_b32 s96, s41
    s_add_u32 s41, s41, 28672
    s_cmp_eq_u32 s41, 114688
    s_cselect_b32 s41, 0, s41
    v_add_u32 v16, s41, v11
    v_add_u32 v17, s41, v12
    v_add_u32 v18, s41, v13
    s_waitcnt vmcnt(12)
    s_barrier
    v_mfma_f32_16x16x32_bf16 v[28:31], a[16:19], a[0:3], 0
    ds_read_b128 a[40:43], v15 offset:0
    ds_read_b128 a[44:47], v15 offset:2048
    v_mfma_f32_16x16x32_bf16 v[32:35], a[16:19], a[4:7], 0
    ds_read_b128 a[48:51], v15 offset:4096
    v_mfma_f32_16x16x32_bf16 v[36:39], a[16:19], a[8:11], 0
    ds_read_b128 a[52:55], v15 offset:6144
    v_mfma_f32_16x16x32_bf16 v[40:43], a[16:19], a[12:15], 0
    ds_read_b64_tr_b16 a[56:57], v16 offset:2048
    v_mfma_f32_16x16x32_bf16 v[44:47], a[20:23], a[0:3], 0
    ds_read_b64_tr_b16 a[58:59], v16 offset:2560
    v_mfma_f32_16x16x32_bf16 v[48:51], a[20:23], a[4:7], 0
    ds_read_b64_tr_b16 a[60:61], v17 offset:2048
    v_mfma_f32_16x16x32_bf16 v[52:55], a[20:23], a[8:11], 0
    ds_read_b64_tr_b16 a[62:63], v17 offset:2560
    v_mfma_f32_16x16x32_bf16 v[56:59], a[20:23], a[12:15], 0
    ds_read_b64_tr_b16 a[64:65], v18 offset:12288
    v_mfma_f32_16x16x32_bf16 v[60:63], a[24:27], a[0:3], 0
    ds_read_b64_tr_b16 a[66:67], v18 offset:12544
    v_mfma_f32_16x16x32_bf16 v[64:67], a[24:27], a[4:7], 0
    ds_read_b64_tr_b16 a[68:69], v16 offset:16384
    v_mfma_f32_16x16x32_bf16 v[68:71], a[24:27], a[8:11], 0
    ds_read_b64_tr_b16 a[70:71], v16 offset:16896
    v_mfma_f32_16x16x32_bf16 v[72:75], a[24:27], a[12:15], 0
    ds_read_b64_tr_b16 a[72:73], v17 offset:16384
    v_mfma_f32_16x16x32_bf16 v[76:79], a[28:31], a[0:3], 0
    ds_read_b64_tr_b16 a[74:75], v17 offset:16896
    v_mfma_f32_16x16x32_bf16 v[80:83], a[28:31], a[4:7], 0
    ds_read_b64_tr_b16 a[76:77], v18 offset:26624
    v_mfma_f32_16x16x32_bf16 v[84:87], a[28:31], a[8:11], 0
    ds_read_b64_tr_b16 a[78:79], v18 offset:26880
    v_mfma_f32_16x16x32_bf16 v[88:91], a[28:31], a[12:15], 0
    s_add_u32 s42, s96, s37
    s_add_u32 m0, s42, 6144
    s_nop 0
    buffer_load_dwordx4 v5, s[12:15], s33 offen lds
    v_mfma_f32_16x16x32_bf16 v[92:95], a[32:35], a[0:3], 0
    s_add_u32 s42, s96, s37
    s_add_u32 m0, s42, 7168
    s_nop 0
    buffer_load_dwordx4 v6, s[12:15], s33 offen lds
    v_mfma_f32_16x16x32_bf16 v[96:99], a[32:35], a[4:7], 0
    s_add_u32 s42, s96, s37
    s_add_u32 m0, s42, 8192
    s_nop 0
    buffer_load_dwordx4 v7, s[12:15], s33 offen lds
    v_mfma_f32_16x16x32_bf16 v[100:103], a[32:35], a[8:11], 0
    s_add_u32 s42, s96, s97
    s_add_u32 m0, s42, 12288
    s_nop 0
    buffer_load_dwordx4 v8, s[12:15], s33 offen lds
    v_mfma_f32_16x16x32_bf16 v[104:107], a[32:35], a[12:15], 0
    s_add_u32 s33, s33, 229376
    v_mfma_f32_16x16x32_bf16 v[108:111], a[36:39], a[0:3], 0
    v_mfma_f32_16x16x32_bf16 v[112:115], a[36:39], a[4:7], 0
    v_mfma_f32_16x16x32_bf16 v[116:119], a[36:39], a[8:11], 0
    v_mfma_f32_16x16x32_bf16 v[120:123], a[36:39], a[12:15], 0
    s_waitcnt lgkmcnt(0)
    s_mov_b32 s35, s34
    s_add_u32 s34, s34, 16384
    s_cmp_eq_u32 s34, 49152
    s_cselect_b32 s34, 0, s34
    v_add_u32 v14, s34, v9
    v_add_u32 v15, s34, v10
    s_mov_b32 s96, s41
    s_add_u32 s41, s41, 28672
    s_cmp_eq_u32 s41, 114688
    s_cselect_b32 s41, 0, s41
    v_add_u32 v16, s41, v11
    v_add_u32 v17, s41, v12
    v_add_u32 v18, s41, v13
    s_waitcnt vmcnt(10)
    s_barrier
    v_mfma_f32_16x16x32_bf16 v[28:31], a[56:59], a[40:43], v[28:31]
    ds_read_b128 a[0:3], v14 offset:0
    ds_read_b128 a[4:7], v14 offset:2048
    v_mfma_f32_16x16x32_bf16 v[32:35], a[56:59], a[44:47], v[32:35]
    ds_read_b128 a[8:11], v14 offset:4096
    v_mfma_f32_16x16x32_bf16 v[36:39], a[56:59], a[48:51], v[36:39]
    ds_read_b128 a[12:15], v14 offset:6144
    v_mfma_f32_16x16x32_bf16 v[40:43], a[56:59], a[52:55], v[40:43]
    ds_read_b64_tr_b16 a[16:17], v16 offset:2048
    v_mfma_f32_16x16x32_bf16 v[44:47], a[60:63], a[40:43], v[44:47]
    ds_read_b64_tr_b16 a[18:19], v16 offset:2560
    v_mfma_f32_16x16x32_bf16 v[48:51], a[60:63], a[44:47], v[48:51]
    ds_read_b64_tr_b16 a[20:21], v17 offset:2048
    ds_read_b64_tr_b16 a[22:23], v17 offset:2560
    v_mfma_f32_16x16x32_bf16 v[52:55], a[60:63], a[48:51], v[52:55]
    ds_read_b64_tr_b16 a[24:25], v18 offset:12288
    v_mfma_f32_16x16x32_bf16 v[56:59], a[60:63], a[52:55], v[56:59]
    ds_read_b64_tr_b16 a[26:27], v18 offset:12544
    v_mfma_f32_16x16x32_bf16 v[60:63], a[64:67], a[40:43], v[60:63]
    ds_read_b64_tr_b16 a[28:29], v16 offset:16384
    v_mfma_f32_16x16x32_bf16 v[64:67], a[64:67], a[44:47], v[64:67]
    ds_read_b64_tr_b16 a[30:31], v16 offset:16896
    v_mfma_f32_16x16x32_bf16 v[68:71], a[64:67], a[48:51], v[68:71]
    ds_read_b64_tr_b16 a[32:33], v17 offset:16384
    ds_read_b64_tr_b16 a[34:35], v17 offset:16896
    v_mfma_f32_16x16x32_bf16 v[72:75], a[64:67], a[52:55], v[72:75]
    ds_read_b64_tr_b16 a[36:37], v18 offset:26624
    v_mfma_f32_16x16x32_bf16 v[76:79], a[68:71], a[40:43], v[76:79]
    ds_read_b64_tr_b16 a[38:39], v18 offset:26880
    v_mfma_f32_16x16x32_bf16 v[80:83], a[68:71], a[44:47], v[80:83]
    s_add_u32 s42, s96, s37
    s_add_u32 m0, s42, 6144
    s_nop 0
    buffer_load_dwordx4 v5, s[12:15], s33 offen lds
    v_mfma_f32_16x16x32_bf16 v[84:87], a[68:71], a[48:51], v[84:87]
    s_add_u32 s42, s96, s37
    s_add_u32 m0, s42, 7168
    s_nop 0
    buffer_load_dwordx4 v6, s[12:15], s33 offen lds
    v_mfma_f32_16x16x32_bf16 v[88:91], a[68:71], a[52:55], v[88:91]
    s_add_u32 s42, s96, s37
    s_add_u32 m0, s42, 8192
    s_nop 0
    buffer_load_dwordx4 v7, s[12:15], s33 offen lds
    s_add_u32 s42, s96, s97
    s_add_u32 m0, s42, 12288
    s_nop 0
    buffer_load_dwordx4 v8, s[12:15], s33 offen lds
    v_mfma_f32_16x16x32_bf16 v[92:95], a[72:75], a[40:43], v[92:95]
    s_add_u32 s33, s33, 229376
    v_mfma_f32_16x16x32_bf16 v[96:99], a[72:75], a[44:47], v[96:99]
    s_add_u32 s42, s35, s36
    s_add_u32 m0, s42, 0
    s_nop 0
    buffer_load_dwordx4 v3, s[8:11], s32 offen lds
    v_mfma_f32_16x16x32_bf16 v[100:103], a[72:75], a[48:51], v[100:103]
    s_add_u32 s42, s35, s36
    s_add_u32 m0, s42, 1024
    s_nop 0
    buffer_load_dwordx4 v4, s[8:11], s32 offen lds
    v_mfma_f32_16x16x32_bf16 v[104:107], a[72:75], a[52:55], v[104:107]
    s_add_u32 s32, s32, 128
    v_mfma_f32_16x16x32_bf16 v[108:111], a[76:79], a[40:43], v[108:111]
    v_mfma_f32_16x16x32_bf16 v[112:115], a[76:79], a[44:47], v[112:115]
    v_mfma_f32_16x16x32_bf16 v[116:119], a[76:79], a[48:51], v[116:119]
    v_mfma_f32_16x16x32_bf16 v[120:123], a[76:79], a[52:55], v[120:123]
    s_waitcnt lgkmcnt(0)
    s_mov_b32 s96, s41
    s_add_u32 s41, s41, 28672
    s_cmp_eq_u32 s41, 114688
    s_cselect_b32 s41, 0, s41
    v_add_u32 v16, s41, v11
    v_add_u32 v17, s41, v12
    v_add_u32 v18, s41, v13
    s_waitcnt vmcnt(10)
    s_barrier
    v_mfma_f32_16x16x32_bf16 v[28:31], a[16:19], a[0:3], v[28:31]
    ds_read_b128 a[40:43], v15 offset:0
    ds_read_b128 a[44:47], v15 offset:2048
    v_mfma_f32_16x16x32_bf16 v[32:35], a[16:19], a[4:7], v[32:35]
    ds_read_b128 a[48:51], v15 offset:4096
    v_mfma_f32_16x16x32_bf16 v[36:39], a[16:19], a[8:11], v[36:39]
    ds_read_b128 a[52:55], v15 offset:6144
    v_mfma_f32_16x16x32_bf16 v[40:43], a[16:19], a[12:15], v[40:43]
    ds_read_b64_tr_b16 a[56:57], v16 offset:2048
    v_mfma_f32_16x16x32_bf16 v[44:47], a[20:23], a[0:3], v[44:47]
    ds_read_b64_tr_b16 a[58:59], v16 offset:2560
    v_mfma_f32_16x16x32_bf16 v[48:51], a[20:23], a[4:7], v[48:51]
    ds_read_b64_tr_b16 a[60:61], v17 offset:2048
    v_mfma_f32_16x16x32_bf16 v[52:55], a[20:23], a[8:11], v[52:55]
    ds_read_b64_tr_b16 a[62:63], v17 offset:2560
    v_mfma_f32_16x16x32_bf16 v[56:59], a[20:23], a[12:15], v[56:59]
    ds_read_b64_tr_b16 a[64:65], v18 offset:12288
    v_mfma_f32_16x16x32_bf16 v[60:63], a[24:27], a[0:3], v[60:63]
    ds_read_b64_tr_b16 a[66:67], v18 offset:12544
    v_mfma_f32_16x16x32_bf16 v[64:67], a[24:27], a[4:7], v[64:67]
    ds_read_b64_tr_b16 a[68:69], v16 offset:16384
    v_mfma_f32_16x16x32_bf16 v[68:71], a[24:27], a[8:11], v[68:71]
    ds_read_b64_tr_b16 a[70:71], v16 offset:16896
    v_mfma_f32_16x16x32_bf16 v[72:75], a[24:27], a[12:15], v[72:75]
    ds_read_b64_tr_b16 a[72:73], v17 offset:16384
    v_mfma_f32_16x16x32_bf16 v[76:79], a[28:31], a[0:3], v[76:79]
    ds_read_b64_tr_b16 a[74:75], v17 offset:16896
    v_mfma_f32_16x16x32_bf16 v[80:83], a[28:31], a[4:7], v[80:83]
    ds_read_b64_tr_b16 a[76:77], v18 offset:26624
    v_mfma_f32_16x16x32_bf16 v[84:87], a[28:31], a[8:11], v[84:87]
    ds_read_b64_tr_b16 a[78:79], v18 offset:26880
    v_mfma_f32_16x16x32_bf16 v[88:91], a[28:31], a[12:15], v[88:91]
    s_add_u32 s42, s96, s37
    s_add_u32 m0, s42, 6144
    s_nop 0
    buffer_load_dwordx4 v5, s[12:15], s33 offen lds
    v_mfma_f32_16x16x32_bf16 v[92:95], a[32:35], a[0:3], v[92:95]
    s_add_u32 s42, s96, s37
    s_add_u32 m0, s42, 7168
    s_nop 0
    buffer_load_dwordx4 v6, s[12:15], s33 offen lds
    v_mfma_f32_16x16x32_bf16 v[96:99], a[32:35], a[4:7], v[96:99]
    s_add_u32 s42, s96, s37
    s_add_u32 m0, s42, 8192
    s_nop 0
    buffer_load_dwordx4 v7, s[12:15], s33 offen lds
    v_mfma_f32_16x16x32_bf16 v[100:103], a[32:35], a[8:11], v[100:103]
    s_add_u32 s42, s96, s97
    s_add_u32 m0, s42, 12288
    s_nop 0
    buffer_load_dwordx4 v8, s[12:15], s33 offen lds
    v_mfma_f32_16x16x32_bf16 v[104:107], a[32:35], a[12:15], v[104:107]
    s_add_u32 s33, s33, 229376
    v_mfma_f32_16x16x32_bf16 v[108:111], a[36:39], a[0:3], v[108:111]
    v_mfma_f32_16x16x32_bf16 v[112:115], a[36:39], a[4:7], v[112:115]
    v_mfma_f32_16x16x32_bf16 v[116:119], a[36:39], a[8:11], v[116:119]
    v_mfma_f32_16x16x32_bf16 v[120:123], a[36:39], a[12:15], v[120:123]
    s_waitcnt lgkmcnt(0)
    s_mov_b32 s35, s34
    s_add_u32 s34, s34, 16384
    s_cmp_eq_u32 s34, 49152
    s_cselect_b32 s34, 0, s34
    v_add_u32 v14, s34, v9
    v_add_u32 v15, s34, v10
    s_mov_b32 s96, s41
    s_add_u32 s41, s41, 28672
    s_cmp_eq_u32 s41, 114688
    s_cselect_b32 s41, 0, s41
    v_add_u32 v16, s41, v11
    v_add_u32 v17, s41, v12
    v_add_u32 v18, s41, v13
    s_waitcnt vmcnt(10)
    s_barrier
    v_mfma_f32_16x16x32_bf16 v[28:31], a[56:59], a[40:43], v[28:31]
    ds_read_b128 a[0:3], v14 offset:0
    ds_read_b128 a[4:7], v14 offset:2048
    v_mfma_f32_16x16x32_bf16 v[32:35], a[56:59], a[44:47], v[32:35]
    ds_read_b128 a[8:11], v14 offset:4096
    v_mfma_f32_16x16x32_bf16 v[36:39], a[56:59], a[48:51], v[36:39]
    ds_read_b128 a[12:15], v14 offset:6144
    v_mfma_f32_16x16x32_bf16 v[40:43], a[56:59], a[52:55], v[40:43]
    ds_read_b64_tr_b16 a[16:17], v16 offset:2048
    v_mfma_f32_16x16x32_bf16 v[44:47], a[60:63], a[40:43], v[44:47]
    ds_read_b64_tr_b16 a[18:19], v16 offset:2560
    v_mfma_f32_16x16x32_bf16 v[48:51], a[60:63], a[44:47], v[48:51]
    ds_read_b64_tr_b16 a[20:21], v17 offset:2048
    ds_read_b64_tr_b16 a[22:23], v17 offset:2560
    v_mfma_f32_16x16x32_bf16 v[52:55], a[60:63], a[48:51], v[52:55]
    ds_read_b64_tr_b16 a[24:25], v18 offset:12288
    v_mfma_f32_16x16x32_bf16 v[56:59], a[60:63], a[52:55], v[56:59]
    ds_read_b64_tr_b16 a[26:27], v18 offset:12544
    v_mfma_f32_16x16x32_bf16 v[60:63], a[64:67], a[40:43], v[60:63]
    ds_read_b64_tr_b16 a[28:29], v16 offset:16384
    v_mfma_f32_16x16x32_bf16 v[64:67], a[64:67], a[44:47], v[64:67]
    ds_read_b64_tr_b16 a[30:31], v16 offset:16896
    v_mfma_f32_16x16x32_bf16 v[68:71], a[64:67], a[48:51], v[68:71]
    ds_read_b64_tr_b16 a[32:33], v17 offset:16384
    ds_read_b64_tr_b16 a[34:35], v17 offset:16896
    v_mfma_f32_16x16x32_bf16 v[72:75], a[64:67], a[52:55], v[72:75]
    ds_read_b64_tr_b16 a[36:37], v18 offset:26624
    v_mfma_f32_16x16x32_bf16 v[76:79], a[68:71], a[40:43], v[76:79]
    ds_read_b64_tr_b16 a[38:39], v18 offset:26880
    v_mfma_f32_16x16x32_bf16 v[80:83], a[68:71], a[44:47], v[80:83]
    s_add_u32 s42, s96, s37
    s_add_u32 m0, s42, 6144
    s_nop 0
    buffer_load_dwordx4 v5, s[12:15], s33 offen lds
    v_mfma_f32_16x16x32_bf16 v[84:87], a[68:71], a[48:51], v[84:87]
    s_add_u32 s42, s96, s37
    s_add_u32 m0, s42, 7168
    s_nop 0
    buffer_load_dwordx4 v6, s[12:15], s33 offen lds
    v_mfma_f32_16x16x32_bf16 v[88:91], a[68:71], a[52:55], v[88:91]
    s_add_u32 s42, s96, s37
    s_add_u32 m0, s42, 8192
    s_nop 0
    buffer_load_dwordx4 v7, s[12:15], s33 offen lds
    s_add_u32 s42, s96, s97
    s_add_u32 m0, s42, 12288
    s_nop 0
    buffer_load_dwordx4 v8, s[12:15], s33 offen lds
    v_mfma_f32_16x16x32_bf16 v[92:95], a[72:75], a[40:43], v[92:95]
    s_add_u32 s33, s33, 229376
    v_mfma_f32_16x16x32_bf16 v[96:99], a[72:75], a[44:47], v[96:99]
    s_add_u32 s42, s35, s36
    s_add_u32 m0, s42, 0
    s_nop 0
    buffer_load_dwordx4 v3, s[8:11], s32 offen lds
    v_mfma_f32_16x16x32_bf16 v[100:103], a[72:75], a[48:51], v[100:103]
    s_add_u32 s42, s35, s36
    s_add_u32 m0, s42, 1024
    s_nop 0
    buffer_load_dwordx4 v4, s[8:11], s32 offen lds
    v_mfma_f32_16x16x32_bf16 v[104:107], a[72:75], a[52:55], v[104:107]
    s_add_u32 s32, s32, 128
    v_mfma_f32_16x16x32_bf16 v[108:111], a[76:79], a[40:43], v[108:111]
    v_mfma_f32_16x16x32_bf16 v[112:115], a[76:79], a[44:47], v[112:115]
    v_mfma_f32_16x16x32_bf16 v[116:119], a[76:79], a[48:51], v[116:119]
    v_mfma_f32_16x16x32_bf16 v[120:123], a[76:79], a[52:55], v[120:123]
    s_waitcnt lgkmcnt(0)
    s_mov_b32 s31, 6
L_loop_16:
    s_mov_b32 s96, s41
    s_add_u32 s41, s41, 28672
    s_cmp_eq_u32 s41, 114688
    s_cselect_b32 s41, 0, s41
    v_add_u32 v16, s41, v11
    v_add_u32 v17, s41, v12
    v_add_u32 v18, s41, v13
    s_waitcnt vmcnt(12)
    s_barrier
    v_mfma_f32_16x16x32_bf16 v[28:31], a[16:19], a[0:3], v[28:31]
    ds_read_b128 a[40:43], v15 offset:0
    ds_read_b128 a[44:47], v15 offset:2048
    v_mfma_f32_16x16x32_bf16 v[32:35], a[16:19], a[4:7], v[32:35]
    ds_read_b128 a[48:51], v15 offset:4096
    v_mfma_f32_16x16x32_bf16 v[36:39], a[16:19], a[8:11], v[36:39]
    ds_read_b128 a[52:55], v15 offset:6144
    v_mfma_f32_16x16x32_bf16 v[40:43], a[16:19], a[12:15], v[40:43]
    ds_read_b64_tr_b16 a[56:57], v16 offset:2048
    v_mfma_f32_16x16x32_bf16 v[44:47], a[20:23], a[0:3], v[44:47]
    ds_read_b64_tr_b16 a[58:59], v16 offset:2560
    v_mfma_f32_16x16x32_bf16 v[48:51], a[20:23], a[4:7], v[48:51]
    ds_read_b64_tr_b16 a[60:61], v17 offset:2048
    v_mfma_f32_16x16x32_bf16 v[52:55], a[20:23], a[8:11], v[52:55]
    ds_read_b64_tr_b16 a[62:63], v17 offset:2560
    v_mfma_f32_16x16x32_bf16 v[56:59], a[20:23], a[12:15], v[56:59]
    ds_read_b64_tr_b16 a[64:65], v18 offset:12288
    v_mfma_f32_16x16x32_bf16 v[60:63], a[24:27], a[0:3], v[60:63]
    ds_read_b64_tr_b16 a[66:67], v18 offset:12544
    v_mfma_f32_16x16x32_bf16 v[64:67], a[24:27], a[4:7], v[64:67]
    ds_read_b64_tr_b16 a[68:69], v16 offset:16384
    v_mfma_f32_16x16x32_bf16 v[68:71], a[24:27], a[8:11], v[68:71]
    ds_read_b64_tr_b16 a[70:71], v16 offset:16896
    v_mfma_f32_16x16x32_bf16 v[72:75], a[24:27], a[12:15], v[72:75]
    ds_read_b64_tr_b16 a[72:73], v17 offset:16384
    v_mfma_f32_16x16x32_bf16 v[76:79], a[28:31], a[0:3], v[76:79]
    ds_read_b64_tr_b16 a[74:75], v17 offset:16896
    v_mfma_f32_16x16x32_bf16 v[80:83], a[28:31], a[4:7], v[80:83]
    ds_read_b64_tr_b16 a[76:77], v18 offset:26624
    v_mfma_f32_16x16x32_bf16 v[84:87], a[28:31], a[8:11], v[84:87]
    ds_read_b64_tr_b16 a[78:79], v18 offset:26880
    v_mfma_f32_16x16x32_bf16 v[88:91], a[28:31], a[12:15], v[88:91]
    s_add_u32 s42, s96, s37
    s_add_u32 m0, s42, 6144
    s_nop 0
    buffer_load_dwordx4 v5, s[12:15], s33 offen lds
    v_mfma_f32_16x16x32_bf16 v[92:95], a[32:35], a[0:3], v[92:95]
    s_add_u32 s42, s96, s37
    s_add_u32 m0, s42, 7168
    s_nop 0
    buffer_load_dwordx4 v6, s[12:15], s33 offen lds
    v_mfma_f32_16x16x32_bf16 v[96:99], a[32:35], a[4:7], v[96:99]
    s_add_u32 s42, s96, s37
    s_add_u32 m0, s42, 8192
    s_nop 0
    buffer_load_dwordx4 v7, s[12:15], s33 offen lds
    v_mfma_f32_16x16x32_bf16 v[100:103], a[32:35], a[8:11], v[100:103]
    s_add_u32 s42, s96, s97
    s_add_u32 m0, s42, 12288
    s_nop 0
    buffer_load_dwordx4 v8, s[12:15], s33 offen lds
    v_mfma_f32_16x16x32_bf16 v[104:107], a[32:35], a[12:15], v[104:107]
    s_add_u32 s33, s33, 229376
    v_mfma_f32_16x16x32_bf16 v[108:111], a[36:39], a[0:3], v[108:111]
    v_mfma_f32_16x16x32_bf16 v[112:115], a[36:39], a[4:7], v[112:115]
    v_mfma_f32_16x16x32_bf16 v[116:119], a[36:39], a[8:11], v[116:119]
    v_mfma_f32_16x16x32_bf16 v[120:123], a[36:39], a[12:15], v[120:123]
    s_waitcnt lgkmcnt(0)
    s_mov_b32 s35, s34
    s_add_u32 s34, s34, 16384
    s_cmp_eq_u32 s34, 49152
    s_cselect_b32 s34, 0, s34
    v_add_u32 v14, s34, v9
    v_add_u32 v15, s34, v10
    s_mov_b32 s96, s41
    s_add_u32 s41, s41, 28672
    s_cmp_eq_u32 s41, 114688
    s_cselect_b32 s41, 0, s41
    v_add_u32 v16, s41, v11
    v_add_u32 v17, s41, v12
    v_add_u32 v18, s41, v13
    s_waitcnt vmcnt(10)
    s_barrier
    v_mfma_f32_16x16x32_bf16 v[28:31], a[56:59], a[40:43], v[28:31]
    ds_read_b128 a[0:3], v14 offset:0
    ds_read_b128 a[4:7], v14 offset:2048
    v_mfma_f32_16x16x32_bf16 v[32:35], a[56:59], a[44:47], v[32:35]
    ds_read_b128 a[8:11], v14 offset:4096
    v_mfma_f32_16x16x32_bf16 v[36:39], a[56:59], a[48:51], v[36:39]
    ds_read_b128 a[12:15], v14 offset:6144
    v_mfma_f32_16x16x32_bf16 v[40:43], a[56:59], a[52:55], v[40:43]
    ds_read_b64_tr_b16 a[16:17], v16 offset:2048
    v_mfma_f32_16x16x32_bf16 v[44:47], a[60:63], a[40:43], v[44:47]
    ds_read_b64_tr_b16 a[18:19], v16 offset:2560
    v_mfma_f32_16x16x32_bf16 v[48:51], a[60:63], a[44:47], v[48:51]
    ds_read_b64_tr_b16 a[20:21], v17 offset:2048
    ds_read_b64_tr_b16 a[22:23], v17 offset:2560
    v_mfma_f32_16x16x32_bf16 v[52:55], a[60:63], a[48:51], v[52:55]
    ds_read_b64_tr_b16 a[24:25], v18 offset:12288
    v_mfma_f32_16x16x32_bf16 v[56:59], a[60:63], a[52:55], v[56:59]
    ds_read_b64_tr_b16 a[26:27], v18 offset:12544
    v_mfma_f32_16x16x32_bf16 v[60:63], a[64:67], a[40:43], v[60:63]
    ds_read_b64_tr_b16 a[28:29], v16 offset:16384
    v_mfma_f32_16x16x32_bf16 v[64:67], a[64:67], a[44:47], v[64:67]
    ds_read_b64_tr_b16 a[30:31], v16 offset:16896
    v_mfma_f32_16x16x32_bf16 v[68:71], a[64:67], a[48:51], v[68:71]
    ds_read_b64_tr_b16 a[32:33], v17 offset:16384
    ds_read_b64_tr_b16 a[34:35], v17 offset:16896
    v_mfma_f32_16x16x32_bf16 v[72:75], a[64:67], a[52:55], v[72:75]
    ds_read_b64_tr_b16 a[36:37], v18 offset:26624
    v_mfma_f32_16x16x32_bf16 v[76:79], a[68:71], a[40:43], v[76:79]
    ds_read_b64_tr_b16 a[38:39], v18 offset:26880
    v_mfma_f32_16x16x32_bf16 v[80:83], a[68:71], a[44:47], v[80:83]
    s_add_u32 s42, s96, s37
    s_add_u32 m0, s42, 6144
    s_nop 0
    buffer_load_dwordx4 v5, s[12:15], s33 offen lds
    v_mfma_f32_16x16x32_bf16 v[84:87], a[68:71], a[48:51], v[84:87]
    s_add_u32 s42, s96, s37
    s_add_u32 m0, s42, 7168
    s_nop 0
    buffer_load_dwordx4 v6, s[12:15], s33 offen lds
    v_mfma_f32_16x16x32_bf16 v[88:91], a[68:71], a[52:55], v[88:91]
    s_add_u32 s42, s96, s37
    s_add_u32 m0, s42, 8192
    s_nop 0
    buffer_load_dwordx4 v7, s[12:15], s33 offen lds
    s_add_u32 s42, s96, s97
    s_add_u32 m0, s42, 12288
    s_nop 0
    buffer_load_dwordx4 v8, s[12:15], s33 offen lds
    v_mfma_f32_16x16x32_bf16 v[92:95], a[72:75], a[40:43], v[92:95]
    s_add_u32 s33, s33, 229376
    v_mfma_f32_16x16x32_bf16 v[96:99], a[72:75], a[44:47], v[96:99]
    s_add_u32 s42, s35, s36
    s_add_u32 m0, s42, 0
    s_nop 0
    buffer_load_dwordx4 v3, s[8:11], s32 offen lds
    v_mfma_f32_16x16x32_bf16 v[100:103], a[72:75], a[48:51], v[100:103]
    s_add_u32 s42, s35, s36
    s_add_u32 m0, s42, 1024
    s_nop 0
    buffer_load_dwordx4 v4, s[8:11], s32 offen lds
    v_mfma_f32_16x16x32_bf16 v[104:107], a[72:75], a[52:55], v[104:107]
    s_add_u32 s32, s32, 128
    v_mfma_f32_16x16x32_bf16 v[108:111], a[76:79], a[40:43], v[108:111]
    v_mfma_f32_16x16x32_bf16 v[112:115], a[76:79], a[44:47], v[112:115]
    v_mfma_f32_16x16x32_bf16 v[116:119], a[76:79], a[48:51], v[116:119]
    v_mfma_f32_16x16x32_bf16 v[120:123], a[76:79], a[52:55], v[120:123]
    s_waitcnt lgkmcnt(0)
    s_sub_u32 s31, s31, 1
    s_cmp_lg_u32 s31, 0
    s_cbranch_scc1 L_loop_16
    s_mov_b32 s96, s41
    s_add_u32 s41, s41, 28672
    s_cmp_eq_u32 s41, 114688
    s_cselect_b32 s41, 0, s41
    v_add_u32 v16, s41, v11
    v_add_u32 v17, s41, v12
    v_add_u32 v18, s41, v13
    s_waitcnt vmcnt(12)
    s_barrier
    v_mfma_f32_16x16x32_bf16 v[28:31], a[16:19], a[0:3], v[28:31]
    ds_read_b128 a[40:43], v15 offset:0
    ds_read_b128 a[44:47], v15 offset:2048
    v_mfma_f32_16x16x32_bf16 v[32:35], a[16:19], a[4:7], v[32:35]
    ds_read_b128 a[48:51], v15 offset:4096
    v_mfma_f32_16x16x32_bf16 v[36:39], a[16:19], a[8:11], v[36:39]
    ds_read_b128 a[52:55], v15 offset:6144
    v_mfma_f32_16x16x32_bf16 v[40:43], a[16:19], a[12:15], v[40:43]
    ds_read_b64_tr_b16 a[56:57], v16 offset:2048
    v_mfma_f32_16x16x32_bf16 v[44:47], a[20:23], a[0:3], v[44:47]
    ds_read_b64_tr_b16 a[58:59], v16 offset:2560
    v_mfma_f32_16x16x32_bf16 v[48:51], a[20:23], a[4:7], v[48:51]
    ds_read_b64_tr_b16 a[60:61], v17 offset:2048
    v_mfma_f32_16x16x32_bf16 v[52:55], a[20:23], a[8:11], v[52:55]
    ds_read_b64_tr_b16 a[62:63], v17 offset:2560
    v_mfma_f32_16x16x32_bf16 v[56:59], a[20:23], a[12:15], v[56:59]
    ds_read_b64_tr_b16 a[64:65], v18 offset:12288
    v_mfma_f32_16x16x32_bf16 v[60:63], a[24:27], a[0:3], v[60:63]
    ds_read_b64_tr_b16 a[66:67], v18 offset:12544
    v_mfma_f32_16x16x32_bf16 v[64:67], a[24:27], a[4:7], v[64:67]
    ds_read_b64_tr_b16 a[68:69], v16 offset:16384
    v_mfma_f32_16x16x32_bf16 v[68:71], a[24:27], a[8:11], v[68:71]
    ds_read_b64_tr_b16 a[70:71], v16 offset:16896
    ds_read_b64_tr_b16 a[72:73], v17 offset:16384
    v_mfma_f32_16x16x32_bf16 v[72:75], a[24:27], a[12:15], v[72:75]
    ds_read_b64_tr_b16 a[74:75], v17 offset:16896
    v_mfma_f32_16x16x32_bf16 v[76:79], a[28:31], a[0:3], v[76:79]
    ds_read_b64_tr_b16 a[76:77], v18 offset:26624
    v_mfma_f32_16x16x32_bf16 v[80:83], a[28:31], a[4:7], v[80:83]
    ds_read_b64_tr_b16 a[78:79], v18 offset:26880
    v_mfma_f32_16x16x32_bf16 v[84:87], a[28:31], a[8:11], v[84:87]
    s_add_u32 s42, s96, s37
    s_add_u32 m0, s42, 6144
    s_nop 0
    buffer_load_dwordx4 v5, s[12:15], s33 offen lds
    v_mfma_f32_16x16x32_bf16 v[88:91], a[28:31], a[12:15], v[88:91]
    s_add_u32 s42, s96, s37
    s_add_u32 m0, s42, 7168
    s_nop 0
    buffer_load_dwordx4 v6, s[12:15], s33 offen lds
    v_mfma_f32_16x16x32_bf16 v[92:95], a[32:35], a[0:3], v[92:95]
    s_add_u32 s42, s96, s37
    s_add_u32 m0, s42, 8192
    s_nop 0
    buffer_load_dwordx4 v7, s[12:15], s33 offen lds
    v_mfma_f32_16x16x32_bf16 v[96:99], a[32:35], a[4:7], v[96:99]
    s_add_u32 s42, s96, s97
    s_add_u32 m0, s42, 12288
    s_nop 0
    buffer_load_dwordx4 v8, s[12:15], s33 offen lds
    v_mfma_f32_16x16x32_bf16 v[100:103], a[32:35], a[8:11], v[100:103]
    s_add_u32 s33, s33, 229376
    v_mfma_f32_16x16x32_bf16 v[104:107], a[32:35], a[12:15], v[104:107]
    s_mov_b32 s88, s82
    s_mov_b32 s89, s83
    s_mov_b32 s90, 0x700000
    s_mov_b32 s91, 0x00020000
    s_mul_i32 s98, s2, 8
    s_add_u32 s98, s98, s28
    s_mul_i32 s98, s98, 4096
    v_lshlrev_b32 v19, 6, v0
    buffer_load_dword v20, v19, s[88:91], s98 offen
    s_add_u32 s98, s98, 4096
    v_mfma_f32_16x16x32_bf16 v[108:111], a[36:39], a[0:3], v[108:111]
    v_mfma_f32_16x16x32_bf16 v[112:115], a[36:39], a[4:7], v[112:115]
    v_mfma_f32_16x16x32_bf16 v[116:119], a[36:39], a[8:11], v[116:119]
    v_mfma_f32_16x16x32_bf16 v[120:123], a[36:39], a[12:15], v[120:123]
    s_waitcnt lgkmcnt(0)
    s_mov_b32 s35, s34
    s_add_u32 s34, s34, 16384
    s_cmp_eq_u32 s34, 49152
    s_cselect_b32 s34, 0, s34
    v_add_u32 v14, s34, v9
    v_add_u32 v15, s34, v10
    s_mov_b32 s96, s41
    s_add_u32 s41, s41, 28672
    s_cmp_eq_u32 s41, 114688
    s_cselect_b32 s41, 0, s41
    v_add_u32 v16, s41, v11
    v_add_u32 v17, s41, v12
    v_add_u32 v18, s41, v13
    s_waitcnt vmcnt(11)
    s_barrier
    v_mfma_f32_16x16x32_bf16 v[28:31], a[56:59], a[40:43], v[28:31]
    ds_read_b128 a[0:3], v14 offset:0
    ds_read_b128 a[4:7], v14 offset:2048
    v_mfma_f32_16x16x32_bf16 v[32:35], a[56:59], a[44:47], v[32:35]
    ds_read_b128 a[8:11], v14 offset:4096
    v_mfma_f32_16x16x32_bf16 v[36:39], a[56:59], a[48:51], v[36:39]
    ds_read_b128 a[12:15], v14 offset:6144
    v_mfma_f32_16x16x32_bf16 v[40:43], a[56:59], a[52:55], v[40:43]
    ds_read_b64_tr_b16 a[16:17], v16 offset:2048
    v_mfma_f32_16x16x32_bf16 v[44:47], a[60:63], a[40:43], v[44:47]
    ds_read_b64_tr_b16 a[18:19], v16 offset:2560
    v_mfma_f32_16x16x32_bf16 v[48:51], a[60:63], a[44:47], v[48:51]
    ds_read_b64_tr_b16 a[20:21], v17 offset:2048
    ds_read_b64_tr_b16 a[22:23], v17 offset:2560
    v_mfma_f32_16x16x32_bf16 v[52:55], a[60:63], a[48:51], v[52:55]
    ds_read_b64_tr_b16 a[24:25], v18 offset:12288
    v_mfma_f32_16x16x32_bf16 v[56:59], a[60:63], a[52:55], v[56:59]
    ds_read_b64_tr_b16 a[26:27], v18 offset:12544
    v_mfma_f32_16x16x32_bf16 v[60:63], a[64:67], a[40:43], v[60:63]
    ds_read_b64_tr_b16 a[28:29], v16 offset:16384
    v_mfma_f32_16x16x32_bf16 v[64:67], a[64:67], a[44:47], v[64:67]
    ds_read_b64_tr_b16 a[30:31], v16 offset:16896
    v_mfma_f32_16x16x32_bf16 v[68:71], a[64:67], a[48:51], v[68:71]
    ds_read_b64_tr_b16 a[32:33], v17 offset:16384
    ds_read_b64_tr_b16 a[34:35], v17 offset:16896
    v_mfma_f32_16x16x32_bf16 v[72:75], a[64:67], a[52:55], v[72:75]
    ds_read_b64_tr_b16 a[36:37], v18 offset:26624
    v_mfma_f32_16x16x32_bf16 v[76:79], a[68:71], a[40:43], v[76:79]
    ds_read_b64_tr_b16 a[38:39], v18 offset:26880
    v_mfma_f32_16x16x32_bf16 v[80:83], a[68:71], a[44:47], v[80:83]
    s_add_u32 s42, s96, s37
    s_add_u32 m0, s42, 6144
    s_nop 0
    buffer_load_dwordx4 v5, s[12:15], s33 offen lds
    v_mfma_f32_16x16x32_bf16 v[84:87], a[68:71], a[48:51], v[84:87]
    s_add_u32 s42, s96, s37
    s_add_u32 m0, s42, 7168
    s_nop 0
    buffer_load_dwordx4 v6, s[12:15], s33 offen lds
    v_mfma_f32_16x16x32_bf16 v[88:91], a[68:71], a[52:55], v[88:91]
    s_add_u32 s42, s96, s37
    s_add_u32 m0, s42, 8192
    s_nop 0
    buffer_load_dwordx4 v7, s[12:15], s33 offen lds
    s_add_u32 s42, s96, s97
    s_add_u32 m0, s42, 12288
    s_nop 0
    buffer_load_dwordx4 v8, s[12:15], s33 offen lds
    v_mfma_f32_16x16x32_bf16 v[92:95], a[72:75], a[40:43], v[92:95]
    s_add_u32 s33, s33, 229376
    v_mfma_f32_16x16x32_bf16 v[96:99], a[72:75], a[44:47], v[96:99]
    s_add_u32 s42, s35, s36
    s_add_u32 m0, s42, 0
    s_nop 0
    buffer_load_dwordx4 v3, s[8:11], s32 offen lds
    v_mfma_f32_16x16x32_bf16 v[100:103], a[72:75], a[48:51], v[100:103]
    s_add_u32 s42, s35, s36
    s_add_u32 m0, s42, 1024
    s_nop 0
    buffer_load_dwordx4 v4, s[8:11], s32 offen lds
    v_mfma_f32_16x16x32_bf16 v[104:107], a[72:75], a[52:55], v[104:107]
    s_add_u32 s32, s32, 128
    v_mfma_f32_16x16x32_bf16 v[108:111], a[76:79], a[40:43], v[108:111]
    v_mfma_f32_16x16x32_bf16 v[112:115], a[76:79], a[44:47], v[112:115]
    v_mfma_f32_16x16x32_bf16 v[116:119], a[76:79], a[48:51], v[116:119]
    v_mfma_f32_16x16x32_bf16 v[120:123], a[76:79], a[52:55], v[120:123]
    s_waitcnt lgkmcnt(0)
    s_mov_b32 s96, s41
    s_add_u32 s41, s41, 28672
    s_cmp_eq_u32 s41, 114688
    s_cselect_b32 s41, 0, s41
    v_add_u32 v16, s41, v11
    v_add_u32 v17, s41, v12
    v_add_u32 v18, s41, v13
    s_waitcnt vmcnt(13)
    s_barrier
    v_mfma_f32_16x16x32_bf16 v[28:31], a[16:19], a[0:3], v[28:31]
    ds_read_b128 a[40:43], v15 offset:0
    ds_read_b128 a[44:47], v15 offset:2048
    v_mfma_f32_16x16x32_bf16 v[32:35], a[16:19], a[4:7], v[32:35]
    ds_read_b128 a[48:51], v15 offset:4096
    v_mfma_f32_16x16x32_bf16 v[36:39], a[16:19], a[8:11], v[36:39]
    ds_read_b128 a[52:55], v15 offset:6144
    v_mfma_f32_16x16x32_bf16 v[40:43], a[16:19], a[12:15], v[40:43]
    ds_read_b64_tr_b16 a[56:57], v16 offset:2048
    v_mfma_f32_16x16x32_bf16 v[44:47], a[20:23], a[0:3], v[44:47]
    ds_read_b64_tr_b16 a[58:59], v16 offset:2560
    v_mfma_f32_16x16x32_bf16 v[48:51], a[20:23], a[4:7], v[48:51]
    ds_read_b64_tr_b16 a[60:61], v17 offset:2048
    v_mfma_f32_16x16x32_bf16 v[52:55], a[20:23], a[8:11], v[52:55]
    ds_read_b64_tr_b16 a[62:63], v17 offset:2560
    v_mfma_f32_16x16x32_bf16 v[56:59], a[20:23], a[12:15], v[56:59]
    ds_read_b64_tr_b16 a[64:65], v18 offset:12288
    v_mfma_f32_16x16x32_bf16 v[60:63], a[24:27], a[0:3], v[60:63]
    ds_read_b64_tr_b16 a[66:67], v18 offset:12544
    v_mfma_f32_16x16x32_bf16 v[64:67], a[24:27], a[4:7], v[64:67]
    ds_read_b64_tr_b16 a[68:69], v16 offset:16384
    v_mfma_f32_16x16x32_bf16 v[68:71], a[24:27], a[8:11], v[68:71]
    ds_read_b64_tr_b16 a[70:71], v16 offset:16896
    v_mfma_f32_16x16x32_bf16 v[72:75], a[24:27], a[12:15], v[72:75]
    ds_read_b64_tr_b16 a[72:73], v17 offset:16384
    v_mfma_f32_16x16x32_bf16 v[76:79], a[28:31], a[0:3], v[76:79]
    ds_read_b64_tr_b16 a[74:75], v17 offset:16896
    v_mfma_f32_16x16x32_bf16 v[80:83], a[28:31], a[4:7], v[80:83]
    ds_read_b64_tr_b16 a[76:77], v18 offset:26624
    v_mfma_f32_16x16x32_bf16 v[84:87], a[28:31], a[8:11], v[84:87]
    ds_read_b64_tr_b16 a[78:79], v18 offset:26880
    v_mfma_f32_16x16x32_bf16 v[88:91], a[28:31], a[12:15], v[88:91]
    s_add_u32 s42, s96, s37
    s_add_u32 m0, s42, 6144
    s_nop 0
    buffer_load_dwordx4 v5, s[12:15], s33 offen lds
    v_mfma_f32_16x16x32_bf16 v[92:95], a[32:35], a[0:3], v[92:95]
    s_add_u32 s42, s96, s37
    s_add_u32 m0, s42, 7168
    s_nop 0
    buffer_load_dwordx4 v6, s[12:15], s33 offen lds
    v_mfma_f32_16x16x32_bf16 v[96:99], a[32:35], a[4:7], v[96:99]
    s_add_u32 s42, s96, s37
    s_add_u32 m0, s42, 8192
    s_nop 0
    buffer_load_dwordx4 v7, s[12:15], s33 offen lds
    v_mfma_f32_16x16x32_bf16 v[100:103], a[32:35], a[8:11], v[100:103]
    s_add_u32 s42, s96, s97
    s_add_u32 m0, s42, 12288
    s_nop 0
    buffer_load_dwordx4 v8, s[12:15], s33 offen lds
    v_mfma_f32_16x16x32_bf16 v[104:107], a[32:35], a[12:15], v[104:107]
    s_add_u32 s33, s33, 229376
    v_mfma_f32_16x16x32_bf16 v[108:111], a[36:39], a[0:3], v[108:111]
    v_mfma_f32_16x16x32_bf16 v[112:115], a[36:39], a[4:7], v[112:115]
    v_mfma_f32_16x16x32_bf16 v[116:119], a[36:39], a[8:11], v[116:119]
    v_mfma_f32_16x16x32_bf16 v[120:123], a[36:39], a[12:15], v[120:123]
    s_waitcnt lgkmcnt(0)
    s_mov_b32 s35, s34
    s_add_u32 s34, s34, 16384
    s_cmp_eq_u32 s34, 49152
    s_cselect_b32 s34, 0, s34
    v_add_u32 v14, s34, v9
    v_add_u32 v15, s34, v10
    s_mov_b32 s96, s41
    s_add_u32 s41, s41, 28672
    s_cmp_eq_u32 s41, 114688
    s_cselect_b32 s41, 0, s41
    v_add_u32 v16, s41, v11
    v_add_u32 v17, s41, v12
    v_add_u32 v18, s41, v13
    s_waitcnt vmcnt(11)
    s_barrier
    v_mfma_f32_16x16x32_bf16 v[28:31], a[56:59], a[40:43], v[28:31]
    ds_read_b128 a[0:3], v14 offset:0
    ds_read_b128 a[4:7], v14 offset:2048
    v_mfma_f32_16x16x32_bf16 v[32:35], a[56:59], a[44:47], v[32:35]
    ds_read_b128 a[8:11], v14 offset:4096
    v_mfma_f32_16x16x32_bf16 v[36:39], a[56:59], a[48:51], v[36:39]
    ds_read_b128 a[12:15], v14 offset:6144
    v_mfma_f32_16x16x32_bf16 v[40:43], a[56:59], a[52:55], v[40:43]
    ds_read_b64_tr_b16 a[16:17], v16 offset:2048
    v_mfma_f32_16x16x32_bf16 v[44:47], a[60:63], a[40:43], v[44:47]
    ds_read_b64_tr_b16 a[18:19], v16 offset:2560
    v_mfma_f32_16x16x32_bf16 v[48:51], a[60:63], a[44:47], v[48:51]
    ds_read_b64_tr_b16 a[20:21], v17 offset:2048
    ds_read_b64_tr_b16 a[22:23], v17 offset:2560
    v_mfma_f32_16x16x32_bf16 v[52:55], a[60:63], a[48:51], v[52:55]
    ds_read_b64_tr_b16 a[24:25], v18 offset:12288
    v_mfma_f32_16x16x32_bf16 v[56:59], a[60:63], a[52:55], v[56:59]
    ds_read_b64_tr_b16 a[26:27], v18 offset:12544
    v_mfma_f32_16x16x32_bf16 v[60:63], a[64:67], a[40:43], v[60:63]
    ds_read_b64_tr_b16 a[28:29], v16 offset:16384
    v_mfma_f32_16x16x32_bf16 v[64:67], a[64:67], a[44:47], v[64:67]
    ds_read_b64_tr_b16 a[30:31], v16 offset:16896
    v_mfma_f32_16x16x32_bf16 v[68:71], a[64:67], a[48:51], v[68:71]
    ds_read_b64_tr_b16 a[32:33], v17 offset:16384
    ds_read_b64_tr_b16 a[34:35], v17 offset:16896
    v_mfma_f32_16x16x32_bf16 v[72:75], a[64:67], a[52:55], v[72:75]
    ds_read_b64_tr_b16 a[36:37], v18 offset:26624
    v_mfma_f32_16x16x32_bf16 v[76:79], a[68:71], a[40:43], v[76:79]
    ds_read_b64_tr_b16 a[38:39], v18 offset:26880
    v_mfma_f32_16x16x32_bf16 v[80:83], a[68:71], a[44:47], v[80:83]
    s_add_u32 s42, s96, s37
    s_add_u32 m0, s42, 6144
    s_nop 0
    buffer_load_dwordx4 v5, s[12:15], s33 offen lds
    v_mfma_f32_16x16x32_bf16 v[84:87], a[68:71], a[48:51], v[84:87]
    s_add_u32 s42, s96, s37
    s_add_u32 m0, s42, 7168
    s_nop 0
    buffer_load_dwordx4 v6, s[12:15], s33 offen lds
    v_mfma_f32_16x16x32_bf16 v[88:91], a[68:71], a[52:55], v[88:91]
    s_add_u32 s42, s96, s37
    s_add_u32 m0, s42, 8192
    s_nop 0
    buffer_load_dwordx4 v7, s[12:15], s33 offen lds
    s_add_u32 s42, s96, s97
    s_add_u32 m0, s42, 12288
    s_nop 0
    buffer_load_dwordx4 v8, s[12:15], s33 offen lds
    v_mfma_f32_16x16x32_bf16 v[92:95], a[72:75], a[40:43], v[92:95]
    s_add_u32 s33, s33, 229376
    v_mfma_f32_16x16x32_bf16 v[96:99], a[72:75], a[44:47], v[96:99]
    s_add_u32 s42, s35, s36
    s_add_u32 m0, s42, 0
    s_nop 0
    buffer_load_dwordx4 v3, s[8:11], s32 offen lds
    v_mfma_f32_16x16x32_bf16 v[100:103], a[72:75], a[48:51], v[100:103]
    s_add_u32 s42, s35, s36
    s_add_u32 m0, s42, 1024
    s_nop 0
    buffer_load_dwordx4 v4, s[8:11], s32 offen lds
    v_mfma_f32_16x16x32_bf16 v[104:107], a[72:75], a[52:55], v[104:107]
    s_add_u32 s32, s32, 128
    v_mfma_f32_16x16x32_bf16 v[108:111], a[76:79], a[40:43], v[108:111]
    v_mfma_f32_16x16x32_bf16 v[112:115], a[76:79], a[44:47], v[112:115]
    v_mfma_f32_16x16x32_bf16 v[116:119], a[76:79], a[48:51], v[116:119]
    v_mfma_f32_16x16x32_bf16 v[120:123], a[76:79], a[52:55], v[120:123]
    s_waitcnt lgkmcnt(0)
    s_mov_b32 s31, 3
L_loop_17:
    s_mov_b32 s96, s41
    s_add_u32 s41, s41, 28672
    s_cmp_eq_u32 s41, 114688
    s_cselect_b32 s41, 0, s41
    v_add_u32 v16, s41, v11
    v_add_u32 v17, s41, v12
    v_add_u32 v18, s41, v13
    s_waitcnt vmcnt(12)
    s_barrier
    v_mfma_f32_16x16x32_bf16 v[28:31], a[16:19], a[0:3], v[28:31]
    ds_read_b128 a[40:43], v15 offset:0
    ds_read_b128 a[44:47], v15 offset:2048
    v_mfma_f32_16x16x32_bf16 v[32:35], a[16:19], a[4:7], v[32:35]
    ds_read_b128 a[48:51], v15 offset:4096
    v_mfma_f32_16x16x32_bf16 v[36:39], a[16:19], a[8:11], v[36:39]
    ds_read_b128 a[52:55], v15 offset:6144
    v_mfma_f32_16x16x32_bf16 v[40:43], a[16:19], a[12:15], v[40:43]
    ds_read_b64_tr_b16 a[56:57], v16 offset:2048
    v_mfma_f32_16x16x32_bf16 v[44:47], a[20:23], a[0:3], v[44:47]
    ds_read_b64_tr_b16 a[58:59], v16 offset:2560
    v_mfma_f32_16x16x32_bf16 v[48:51], a[20:23], a[4:7], v[48:51]
    ds_read_b64_tr_b16 a[60:61], v17 offset:2048
    v_mfma_f32_16x16x32_bf16 v[52:55], a[20:23], a[8:11], v[52:55]
    ds_read_b64_tr_b16 a[62:63], v17 offset:2560
    v_mfma_f32_16x16x32_bf16 v[56:59], a[20:23], a[12:15], v[56:59]
    ds_read_b64_tr_b16 a[64:65], v18 offset:12288
    v_mfma_f32_16x16x32_bf16 v[60:63], a[24:27], a[0:3], v[60:63]
    ds_read_b64_tr_b16 a[66:67], v18 offset:12544
    v_mfma_f32_16x16x32_bf16 v[64:67], a[24:27], a[4:7], v[64:67]
    ds_read_b64_tr_b16 a[68:69], v16 offset:16384
    v_mfma_f32_16x16x32_bf16 v[68:71], a[24:27], a[8:11], v[68:71]
    ds_read_b64_tr_b16 a[70:71], v16 offset:16896
    v_mfma_f32_16x16x32_bf16 v[72:75], a[24:27], a[12:15], v[72:75]
    ds_read_b64_tr_b16 a[72:73], v17 offset:16384
    v_mfma_f32_16x16x32_bf16 v[76:79], a[28:31], a[0:3], v[76:79]
    ds_read_b64_tr_b16 a[74:75], v17 offset:16896
    v_mfma_f32_16x16x32_bf16 v[80:83], a[28:31], a[4:7], v[80:83]
    ds_read_b64_tr_b16 a[76:77], v18 offset:26624
    v_mfma_f32_16x16x32_bf16 v[84:87], a[28:31], a[8:11], v[84:87]
    ds_read_b64_tr_b16 a[78:79], v18 offset:26880
    v_mfma_f32_16x16x32_bf16 v[88:91], a[28:31], a[12:15], v[88:91]
    s_add_u32 s42, s96, s37
    s_add_u32 m0, s42, 6144
    s_nop 0
    buffer_load_dwordx4 v5, s[12:15], s33 offen lds
    v_mfma_f32_16x16x32_bf16 v[92:95], a[32:35], a[0:3], v[92:95]
    s_add_u32 s42, s96, s37
    s_add_u32 m0, s42, 7168
    s_nop 0
    buffer_load_dwordx4 v6, s[12:15], s33 offen lds
    v_mfma_f32_16x16x32_bf16 v[96:99], a[32:35], a[4:7], v[96:99]
    s_add_u32 s42, s96, s37
    s_add_u32 m0, s42, 8192
    s_nop 0
    buffer_load_dwordx4 v7, s[12:15], s33 offen lds
    v_mfma_f32_16x16x32_bf16 v[100:103], a[32:35], a[8:11], v[100:103]
    s_add_u32 s42, s96, s97
    s_add_u32 m0, s42, 12288
    s_nop 0
    buffer_load_dwordx4 v8, s[12:15], s33 offen lds
    v_mfma_f32_16x16x32_bf16 v[104:107], a[32:35], a[12:15], v[104:107]
    s_add_u32 s33, s33, 229376
    v_mfma_f32_16x16x32_bf16 v[108:111], a[36:39], a[0:3], v[108:111]
    v_mfma_f32_16x16x32_bf16 v[112:115], a[36:39], a[4:7], v[112:115]
    v_mfma_f32_16x16x32_bf16 v[116:119], a[36:39], a[8:11], v[116:119]
    v_mfma_f32_16x16x32_bf16 v[120:123], a[36:39], a[12:15], v[120:123]
    s_waitcnt lgkmcnt(0)
    s_mov_b32 s35, s34
    s_add_u32 s34, s34, 16384
    s_cmp_eq_u32 s34, 49152
    s_cselect_b32 s34, 0, s34
    v_add_u32 v14, s34, v9
    v_add_u32 v15, s34, v10
    s_mov_b32 s96, s41
    s_add_u32 s41, s41, 28672
    s_cmp_eq_u32 s41, 114688
    s_cselect_b32 s41, 0, s41
    v_add_u32 v16, s41, v11
    v_add_u32 v17, s41, v12
    v_add_u32 v18, s41, v13
    s_waitcnt vmcnt(10)
    s_barrier
    v_mfma_f32_16x16x32_bf16 v[28:31], a[56:59], a[40:43], v[28:31]
    ds_read_b128 a[0:3], v14 offset:0
    ds_read_b128 a[4:7], v14 offset:2048
    v_mfma_f32_16x16x32_bf16 v[32:35], a[56:59], a[44:47], v[32:35]
    ds_read_b128 a[8:11], v14 offset:4096
    v_mfma_f32_16x16x32_bf16 v[36:39], a[56:59], a[48:51], v[36:39]
    ds_read_b128 a[12:15], v14 offset:6144
    v_mfma_f32_16x16x32_bf16 v[40:43], a[56:59], a[52:55], v[40:43]
    ds_read_b64_tr_b16 a[16:17], v16 offset:2048
    v_mfma_f32_16x16x32_bf16 v[44:47], a[60:63], a[40:43], v[44:47]
    ds_read_b64_tr_b16 a[18:19], v16 offset:2560
    v_mfma_f32_16x16x32_bf16 v[48:51], a[60:63], a[44:47], v[48:51]
    ds_read_b64_tr_b16 a[20:21], v17 offset:2048
    ds_read_b64_tr_b16 a[22:23], v17 offset:2560
    v_mfma_f32_16x16x32_bf16 v[52:55], a[60:63], a[48:51], v[52:55]
    ds_read_b64_tr_b16 a[24:25], v18 offset:12288
    v_mfma_f32_16x16x32_bf16 v[56:59], a[60:63], a[52:55], v[56:59]
    ds_read_b64_tr_b16 a[26:27], v18 offset:12544
    v_mfma_f32_16x16x32_bf16 v[60:63], a[64:67], a[40:43], v[60:63]
    ds_read_b64_tr_b16 a[28:29], v16 offset:16384
    v_mfma_f32_16x16x32_bf16 v[64:67], a[64:67], a[44:47], v[64:67]
    ds_read_b64_tr_b16 a[30:31], v16 offset:16896
    v_mfma_f32_16x16x32_bf16 v[68:71], a[64:67], a[48:51], v[68:71]
    ds_read_b64_tr_b16 a[32:33], v17 offset:16384
    ds_read_b64_tr_b16 a[34:35], v17 offset:16896
    v_mfma_f32_16x16x32_bf16 v[72:75], a[64:67], a[52:55], v[72:75]
    ds_read_b64_tr_b16 a[36:37], v18 offset:26624
    v_mfma_f32_16x16x32_bf16 v[76:79], a[68:71], a[40:43], v[76:79]
    ds_read_b64_tr_b16 a[38:39], v18 offset:26880
    v_mfma_f32_16x16x32_bf16 v[80:83], a[68:71], a[44:47], v[80:83]
    s_add_u32 s42, s96, s37
    s_add_u32 m0, s42, 6144
    s_nop 0
    buffer_load_dwordx4 v5, s[12:15], s33 offen lds
    v_mfma_f32_16x16x32_bf16 v[84:87], a[68:71], a[48:51], v[84:87]
    s_add_u32 s42, s96, s37
    s_add_u32 m0, s42, 7168
    s_nop 0
    buffer_load_dwordx4 v6, s[12:15], s33 offen lds
    v_mfma_f32_16x16x32_bf16 v[88:91], a[68:71], a[52:55], v[88:91]
    s_add_u32 s42, s96, s37
    s_add_u32 m0, s42, 8192
    s_nop 0
    buffer_load_dwordx4 v7, s[12:15], s33 offen lds
    s_add_u32 s42, s96, s97
    s_add_u32 m0, s42, 12288
    s_nop 0
    buffer_load_dwordx4 v8, s[12:15], s33 offen lds
    v_mfma_f32_16x16x32_bf16 v[92:95], a[72:75], a[40:43], v[92:95]
    s_add_u32 s33, s33, 229376
    v_mfma_f32_16x16x32_bf16 v[96:99], a[72:75], a[44:47], v[96:99]
    s_add_u32 s42, s35, s36
    s_add_u32 m0, s42, 0
    s_nop 0
    buffer_load_dwordx4 v3, s[8:11], s32 offen lds
    v_mfma_f32_16x16x32_bf16 v[100:103], a[72:75], a[48:51], v[100:103]
    s_add_u32 s42, s35, s36
    s_add_u32 m0, s42, 1024
    s_nop 0
    buffer_load_dwordx4 v4, s[8:11], s32 offen lds
    v_mfma_f32_16x16x32_bf16 v[104:107], a[72:75], a[52:55], v[104:107]
    s_add_u32 s32, s32, 128
    v_mfma_f32_16x16x32_bf16 v[108:111], a[76:79], a[40:43], v[108:111]
    v_mfma_f32_16x16x32_bf16 v[112:115], a[76:79], a[44:47], v[112:115]
    v_mfma_f32_16x16x32_bf16 v[116:119], a[76:79], a[48:51], v[116:119]
    v_mfma_f32_16x16x32_bf16 v[120:123], a[76:79], a[52:55], v[120:123]
    s_waitcnt lgkmcnt(0)
    s_sub_u32 s31, s31, 1
    s_cmp_lg_u32 s31, 0
    s_cbranch_scc1 L_loop_17
    s_mov_b32 s96, s41
    s_add_u32 s41, s41, 28672
    s_cmp_eq_u32 s41, 114688
    s_cselect_b32 s41, 0, s41
    v_add_u32 v16, s41, v11
    v_add_u32 v17, s41, v12
    v_add_u32 v18, s41, v13
    s_waitcnt vmcnt(12)
    s_barrier
    v_mfma_f32_16x16x32_bf16 v[28:31], a[16:19], a[0:3], v[28:31]
    ds_read_b128 a[40:43], v15 offset:0
    ds_read_b128 a[44:47], v15 offset:2048
    v_mfma_f32_16x16x32_bf16 v[32:35], a[16:19], a[4:7], v[32:35]
    ds_read_b128 a[48:51], v15 offset:4096
    v_mfma_f32_16x16x32_bf16 v[36:39], a[16:19], a[8:11], v[36:39]
    ds_read_b128 a[52:55], v15 offset:6144
    v_mfma_f32_16x16x32_bf16 v[40:43], a[16:19], a[12:15], v[40:43]
    ds_read_b64_tr_b16 a[56:57], v16 offset:2048
    v_mfma_f32_16x16x32_bf16 v[44:47], a[20:23], a[0:3], v[44:47]
    ds_read_b64_tr_b16 a[58:59], v16 offset:2560
    v_mfma_f32_16x16x32_bf16 v[48:51], a[20:23], a[4:7], v[48:51]
    ds_read_b64_tr_b16 a[60:61], v17 offset:2048
    v_mfma_f32_16x16x32_bf16 v[52:55], a[20:23], a[8:11], v[52:55]
    ds_read_b64_tr_b16 a[62:63], v17 offset:2560
    v_mfma_f32_16x16x32_bf16 v[56:59], a[20:23], a[12:15], v[56:59]
    ds_read_b64_tr_b16 a[64:65], v18 offset:12288
    v_mfma_f32_16x16x32_bf16 v[60:63], a[24:27], a[0:3], v[60:63]
    ds_read_b64_tr_b16 a[66:67], v18 offset:12544
    v_mfma_f32_16x16x32_bf16 v[64:67], a[24:27], a[4:7], v[64:67]
    ds_read_b64_tr_b16 a[68:69], v16 offset:16384
    v_mfma_f32_16x16x32_bf16 v[68:71], a[24:27], a[8:11], v[68:71]
    ds_read_b64_tr_b16 a[70:71], v16 offset:16896
    v_mfma_f32_16x16x32_bf16 v[72:75], a[24:27], a[12:15], v[72:75]
    ds_read_b64_tr_b16 a[72:73], v17 offset:16384
    v_mfma_f32_16x16x32_bf16 v[76:79], a[28:31], a[0:3], v[76:79]
    ds_read_b64_tr_b16 a[74:75], v17 offset:16896
    v_mfma_f32_16x16x32_bf16 v[80:83], a[28:31], a[4:7], v[80:83]
    ds_read_b64_tr_b16 a[76:77], v18 offset:26624
    v_mfma_f32_16x16x32_bf16 v[84:87], a[28:31], a[8:11], v[84:87]
    ds_read_b64_tr_b16 a[78:79], v18 offset:26880
    v_mfma_f32_16x16x32_bf16 v[88:91], a[28:31], a[12:15], v[88:91]
    s_add_u32 s42, s96, s37
    s_add_u32 m0, s42, 6144
    s_nop 0
    buffer_load_dwordx4 v5, s[12:15], s33 offen lds
    v_mfma_f32_16x16x32_bf16 v[92:95], a[32:35], a[0:3], v[92:95]
    s_add_u32 s42, s96, s37
    s_add_u32 m0, s42, 7168
    s_nop 0
    buffer_load_dwordx4 v6, s[12:15], s33 offen lds
    v_mfma_f32_16x16x32_bf16 v[96:99], a[32:35], a[4:7], v[96:99]
    s_add_u32 s42, s96, s37
    s_add_u32 m0, s42, 8192
    s_nop 0
    buffer_load_dwordx4 v7, s[12:15], s33 offen lds
    v_mfma_f32_16x16x32_bf16 v[100:103], a[32:35], a[8:11], v[100:103]
    s_add_u32 s42, s96, s97
    s_add_u32 m0, s42, 12288
    s_nop 0
    buffer_load_dwordx4 v8, s[12:15], s33 offen lds
    v_mfma_f32_16x16x32_bf16 v[104:107], a[32:35], a[12:15], v[104:107]
    s_add_u32 s33, s33, 229376
    v_mfma_f32_16x16x32_bf16 v[108:111], a[36:39], a[0:3], v[108:111]
    v_mfma_f32_16x16x32_bf16 v[112:115], a[36:39], a[4:7], v[112:115]
    v_mfma_f32_16x16x32_bf16 v[116:119], a[36:39], a[8:11], v[116:119]
    v_mfma_f32_16x16x32_bf16 v[120:123], a[36:39], a[12:15], v[120:123]
    s_waitcnt lgkmcnt(0)
    s_mov_b32 s35, s34
    s_add_u32 s34, s34, 16384
    s_cmp_eq_u32 s34, 49152
    s_cselect_b32 s34, 0, s34
    v_add_u32 v14, s34, v9
    v_add_u32 v15, s34, v10
    s_mov_b32 s96, s41
    s_add_u32 s41, s41, 28672
    s_cmp_eq_u32 s41, 114688
    s_cselect_b32 s41, 0, s41
    v_add_u32 v16, s41, v11
    v_add_u32 v17, s41, v12
    v_add_u32 v18, s41, v13
    s_waitcnt vmcnt(10)
    s_barrier
    v_mfma_f32_16x16x32_bf16 v[28:31], a[56:59], a[40:43], v[28:31]
    ds_read_b128 a[0:3], v14 offset:0
    ds_read_b128 a[4:7], v14 offset:2048
    v_mfma_f32_16x16x32_bf16 v[32:35], a[56:59], a[44:47], v[32:35]
    ds_read_b128 a[8:11], v14 offset:4096
    v_mfma_f32_16x16x32_bf16 v[36:39], a[56:59], a[48:51], v[36:39]
    ds_read_b128 a[12:15], v14 offset:6144
    v_mfma_f32_16x16x32_bf16 v[40:43], a[56:59], a[52:55], v[40:43]
    ds_read_b64_tr_b16 a[16:17], v16 offset:2048
    v_mfma_f32_16x16x32_bf16 v[44:47], a[60:63], a[40:43], v[44:47]
    ds_read_b64_tr_b16 a[18:19], v16 offset:2560
    v_mfma_f32_16x16x32_bf16 v[48:51], a[60:63], a[44:47], v[48:51]
    ds_read_b64_tr_b16 a[20:21], v17 offset:2048
    v_mfma_f32_16x16x32_bf16 v[52:55], a[60:63], a[48:51], v[52:55]
    ds_read_b64_tr_b16 a[22:23], v17 offset:2560
    v_mfma_f32_16x16x32_bf16 v[56:59], a[60:63], a[52:55], v[56:59]
    ds_read_b64_tr_b16 a[24:25], v18 offset:12288
    v_mfma_f32_16x16x32_bf16 v[60:63], a[64:67], a[40:43], v[60:63]
    ds_read_b64_tr_b16 a[26:27], v18 offset:12544
    v_mfma_f32_16x16x32_bf16 v[64:67], a[64:67], a[44:47], v[64:67]
    ds_read_b64_tr_b16 a[28:29], v16 offset:16384
    v_mfma_f32_16x16x32_bf16 v[68:71], a[64:67], a[48:51], v[68:71]
    ds_read_b64_tr_b16 a[30:31], v16 offset:16896
    v_mfma_f32_16x16x32_bf16 v[72:75], a[64:67], a[52:55], v[72:75]
    ds_read_b64_tr_b16 a[32:33], v17 offset:16384
    v_mfma_f32_16x16x32_bf16 v[76:79], a[68:71], a[40:43], v[76:79]
    ds_read_b64_tr_b16 a[34:35], v17 offset:16896
    v_mfma_f32_16x16x32_bf16 v[80:83], a[68:71], a[44:47], v[80:83]
    ds_read_b64_tr_b16 a[36:37], v18 offset:26624
    v_mfma_f32_16x16x32_bf16 v[84:87], a[68:71], a[48:51], v[84:87]
    ds_read_b64_tr_b16 a[38:39], v18 offset:26880
    v_mfma_f32_16x16x32_bf16 v[88:91], a[68:71], a[52:55], v[88:91]
    s_add_u32 s42, s96, s37
    s_add_u32 m0, s42, 6144
    s_nop 0
    buffer_load_dwordx4 v5, s[12:15], s33 offen lds
    v_mfma_f32_16x16x32_bf16 v[92:95], a[72:75], a[40:43], v[92:95]
    s_add_u32 s42, s96, s37
    s_add_u32 m0, s42, 7168
    s_nop 0
    buffer_load_dwordx4 v6, s[12:15], s33 offen lds
    v_mfma_f32_16x16x32_bf16 v[96:99], a[72:75], a[44:47], v[96:99]
    s_add_u32 s42, s96, s37
    s_add_u32 m0, s42, 8192
    s_nop 0
    buffer_load_dwordx4 v7, s[12:15], s33 offen lds
    v_mfma_f32_16x16x32_bf16 v[100:103], a[72:75], a[48:51], v[100:103]
    s_add_u32 s42, s96, s97
    s_add_u32 m0, s42, 12288
    s_nop 0
    buffer_load_dwordx4 v8, s[12:15], s33 offen lds
    v_mfma_f32_16x16x32_bf16 v[104:107], a[72:75], a[52:55], v[104:107]
    s_add_u32 s33, s33, 229376
    v_mfma_f32_16x16x32_bf16 v[108:111], a[76:79], a[40:43], v[108:111]
    v_mfma_f32_16x16x32_bf16 v[112:115], a[76:79], a[44:47], v[112:115]
    v_mfma_f32_16x16x32_bf16 v[116:119], a[76:79], a[48:51], v[116:119]
    v_mfma_f32_16x16x32_bf16 v[120:123], a[76:79], a[52:55], v[120:123]
    s_waitcnt lgkmcnt(0)
    s_mov_b32 s96, s41
    s_add_u32 s41, s41, 28672
    s_cmp_eq_u32 s41, 114688
    s_cselect_b32 s41, 0, s41
    v_add_u32 v16, s41, v11
    v_add_u32 v17, s41, v12
    v_add_u32 v18, s41, v13
    s_waitcnt vmcnt(10)
    s_barrier
    v_mfma_f32_16x16x32_bf16 v[28:31], a[16:19], a[0:3], v[28:31]
    ds_read_b128 a[40:43], v15 offset:0
    v_mfma_f32_16x16x32_bf16 v[32:35], a[16:19], a[4:7], v[32:35]
    ds_read_b128 a[44:47], v15 offset:2048
    v_mfma_f32_16x16x32_bf16 v[36:39], a[16:19], a[8:11], v[36:39]
    ds_read_b128 a[48:51], v15 offset:4096
    v_mfma_f32_16x16x32_bf16 v[40:43], a[16:19], a[12:15], v[40:43]
    ds_read_b128 a[52:55], v15 offset:6144
    v_mfma_f32_16x16x32_bf16 v[44:47], a[20:23], a[0:3], v[44:47]
    v_mfma_f32_16x16x32_bf16 v[48:51], a[20:23], a[4:7], v[48:51]
    ds_read_b64_tr_b16 a[56:57], v16 offset:2048
    v_mfma_f32_16x16x32_bf16 v[52:55], a[20:23], a[8:11], v[52:55]
    ds_read_b64_tr_b16 a[58:59], v16 offset:2560
    v_mfma_f32_16x16x32_bf16 v[56:59], a[20:23], a[12:15], v[56:59]
    ds_read_b64_tr_b16 a[60:61], v17 offset:2048
    v_mfma_f32_16x16x32_bf16 v[60:63], a[24:27], a[0:3], v[60:63]
    ds_read_b64_tr_b16 a[62:63], v17 offset:2560
    v_mfma_f32_16x16x32_bf16 v[64:67], a[24:27], a[4:7], v[64:67]
    v_mfma_f32_16x16x32_bf16 v[68:71], a[24:27], a[8:11], v[68:71]
    ds_read_b64_tr_b16 a[64:65], v18 offset:12288
    v_mfma_f32_16x16x32_bf16 v[72:75], a[24:27], a[12:15], v[72:75]
    ds_read_b64_tr_b16 a[66:67], v18 offset:12544
    v_mfma_f32_16x16x32_bf16 v[76:79], a[28:31], a[0:3], v[76:79]
    ds_read_b64_tr_b16 a[68:69], v16 offset:16384
    v_mfma_f32_16x16x32_bf16 v[80:83], a[28:31], a[4:7], v[80:83]
    ds_read_b64_tr_b16 a[70:71], v16 offset:16896
    v_mfma_f32_16x16x32_bf16 v[84:87], a[28:31], a[8:11], v[84:87]
    v_mfma_f32_16x16x32_bf16 v[88:91], a[28:31], a[12:15], v[88:91]
    ds_read_b64_tr_b16 a[72:73], v17 offset:16384
    v_mfma_f32_16x16x32_bf16 v[92:95], a[32:35], a[0:3], v[92:95]
    ds_read_b64_tr_b16 a[74:75], v17 offset:16896
    v_mfma_f32_16x16x32_bf16 v[96:99], a[32:35], a[4:7], v[96:99]
    ds_read_b64_tr_b16 a[76:77], v18 offset:26624
    v_mfma_f32_16x16x32_bf16 v[100:103], a[32:35], a[8:11], v[100:103]
    ds_read_b64_tr_b16 a[78:79], v18 offset:26880
    v_mfma_f32_16x16x32_bf16 v[104:107], a[32:35], a[12:15], v[104:107]
    v_mfma_f32_16x16x32_bf16 v[108:111], a[36:39], a[0:3], v[108:111]
    v_mfma_f32_16x16x32_bf16 v[112:115], a[36:39], a[4:7], v[112:115]
    v_mfma_f32_16x16x32_bf16 v[116:119], a[36:39], a[8:11], v[116:119]
    v_mfma_f32_16x16x32_bf16 v[120:123], a[36:39], a[12:15], v[120:123]
    s_waitcnt lgkmcnt(0)
    s_mov_b32 s35, s34
    s_add_u32 s34, s34, 16384
    s_cmp_eq_u32 s34, 49152
    s_cselect_b32 s34, 0, s34
    v_add_u32 v14, s34, v9
    v_add_u32 v15, s34, v10
    s_mov_b32 s96, s41
    s_add_u32 s41, s41, 28672
    s_cmp_eq_u32 s41, 114688
    s_cselect_b32 s41, 0, s41
    v_add_u32 v16, s41, v11
    v_add_u32 v17, s41, v12
    v_add_u32 v18, s41, v13
    s_waitcnt vmcnt(4)
    s_barrier
    v_mfma_f32_16x16x32_bf16 v[28:31], a[56:59], a[40:43], v[28:31]
    ds_read_b128 a[0:3], v14 offset:0
    v_mfma_f32_16x16x32_bf16 v[32:35], a[56:59], a[44:47], v[32:35]
    ds_read_b128 a[4:7], v14 offset:2048
    v_mfma_f32_16x16x32_bf16 v[36:39], a[56:59], a[48:51], v[36:39]
    ds_read_b128 a[8:11], v14 offset:4096
    v_mfma_f32_16x16x32_bf16 v[40:43], a[56:59], a[52:55], v[40:43]
    ds_read_b128 a[12:15], v14 offset:6144
    v_mfma_f32_16x16x32_bf16 v[44:47], a[60:63], a[40:43], v[44:47]
    v_mfma_f32_16x16x32_bf16 v[48:51], a[60:63], a[44:47], v[48:51]
    ds_read_b64_tr_b16 a[16:17], v16 offset:2048
    v_mfma_f32_16x16x32_bf16 v[52:55], a[60:63], a[48:51], v[52:55]
    ds_read_b64_tr_b16 a[18:19], v16 offset:2560
    v_mfma_f32_16x16x32_bf16 v[56:59], a[60:63], a[52:55], v[56:59]
    ds_read_b64_tr_b16 a[20:21], v17 offset:2048
    v_mfma_f32_16x16x32_bf16 v[60:63], a[64:67], a[40:43], v[60:63]
    ds_read_b64_tr_b16 a[22:23], v17 offset:2560
    v_mfma_f32_16x16x32_bf16 v[64:67], a[64:67], a[44:47], v[64:67]
    v_mfma_f32_16x16x32_bf16 v[68:71], a[64:67], a[48:51], v[68:71]
    ds_read_b64_tr_b16 a[24:25], v18 offset:12288
    v_mfma_f32_16x16x32_bf16 v[72:75], a[64:67], a[52:55], v[72:75]
    ds_read_b64_tr_b16 a[26:27], v18 offset:12544
    v_mfma_f32_16x16x32_bf16 v[76:79], a[68:71], a[40:43], v[76:79]
    ds_read_b64_tr_b16 a[28:29], v16 offset:16384
    v_mfma_f32_16x16x32_bf16 v[80:83], a[68:71], a[44:47], v[80:83]
    ds_read_b64_tr_b16 a[30:31], v16 offset:16896
    v_mfma_f32_16x16x32_bf16 v[84:87], a[68:71], a[48:51], v[84:87]
    v_mfma_f32_16x16x32_bf16 v[88:91], a[68:71], a[52:55], v[88:91]
    ds_read_b64_tr_b16 a[32:33], v17 offset:16384
    v_mfma_f32_16x16x32_bf16 v[92:95], a[72:75], a[40:43], v[92:95]
    ds_read_b64_tr_b16 a[34:35], v17 offset:16896
    v_mfma_f32_16x16x32_bf16 v[96:99], a[72:75], a[44:47], v[96:99]
    ds_read_b64_tr_b16 a[36:37], v18 offset:26624
    v_mfma_f32_16x16x32_bf16 v[100:103], a[72:75], a[48:51], v[100:103]
    ds_read_b64_tr_b16 a[38:39], v18 offset:26880
    v_mfma_f32_16x16x32_bf16 v[104:107], a[72:75], a[52:55], v[104:107]
    v_mfma_f32_16x16x32_bf16 v[108:111], a[76:79], a[40:43], v[108:111]
    v_mfma_f32_16x16x32_bf16 v[112:115], a[76:79], a[44:47], v[112:115]
    v_mfma_f32_16x16x32_bf16 v[116:119], a[76:79], a[48:51], v[116:119]
    v_mfma_f32_16x16x32_bf16 v[120:123], a[76:79], a[52:55], v[120:123]
    s_waitcnt lgkmcnt(0)
    s_mov_b32 s96, s41
    s_add_u32 s41, s41, 28672
    s_cmp_eq_u32 s41, 114688
    s_cselect_b32 s41, 0, s41
    v_add_u32 v16, s41, v11
    v_add_u32 v17, s41, v12
    v_add_u32 v18, s41, v13
    s_waitcnt vmcnt(0)
    s_barrier
    v_mfma_f32_16x16x32_bf16 v[28:31], a[16:19], a[0:3], v[28:31]
    ds_read_b128 a[40:43], v15 offset:0
    v_mfma_f32_16x16x32_bf16 v[32:35], a[16:19], a[4:7], v[32:35]
    ds_read_b128 a[44:47], v15 offset:2048
    v_mfma_f32_16x16x32_bf16 v[36:39], a[16:19], a[8:11], v[36:39]
    ds_read_b128 a[48:51], v15 offset:4096
    v_mfma_f32_16x16x32_bf16 v[40:43], a[16:19], a[12:15], v[40:43]
    ds_read_b128 a[52:55], v15 offset:6144
    v_mfma_f32_16x16x32_bf16 v[44:47], a[20:23], a[0:3], v[44:47]
    v_mfma_f32_16x16x32_bf16 v[48:51], a[20:23], a[4:7], v[48:51]
    ds_read_b64_tr_b16 a[56:57], v16 offset:2048
    v_mfma_f32_16x16x32_bf16 v[52:55], a[20:23], a[8:11], v[52:55]
    ds_read_b64_tr_b16 a[58:59], v16 offset:2560
    v_mfma_f32_16x16x32_bf16 v[56:59], a[20:23], a[12:15], v[56:59]
    ds_read_b64_tr_b16 a[60:61], v17 offset:2048
    v_mfma_f32_16x16x32_bf16 v[60:63], a[24:27], a[0:3], v[60:63]
    ds_read_b64_tr_b16 a[62:63], v17 offset:2560
    v_mfma_f32_16x16x32_bf16 v[64:67], a[24:27], a[4:7], v[64:67]
    v_mfma_f32_16x16x32_bf16 v[68:71], a[24:27], a[8:11], v[68:71]
    ds_read_b64_tr_b16 a[64:65], v18 offset:12288
    v_mfma_f32_16x16x32_bf16 v[72:75], a[24:27], a[12:15], v[72:75]
    ds_read_b64_tr_b16 a[66:67], v18 offset:12544
    v_mfma_f32_16x16x32_bf16 v[76:79], a[28:31], a[0:3], v[76:79]
    ds_read_b64_tr_b16 a[68:69], v16 offset:16384
    v_mfma_f32_16x16x32_bf16 v[80:83], a[28:31], a[4:7], v[80:83]
    ds_read_b64_tr_b16 a[70:71], v16 offset:16896
    v_mfma_f32_16x16x32_bf16 v[84:87], a[28:31], a[8:11], v[84:87]
    v_mfma_f32_16x16x32_bf16 v[88:91], a[28:31], a[12:15], v[88:91]
    ds_read_b64_tr_b16 a[72:73], v17 offset:16384
    v_mfma_f32_16x16x32_bf16 v[92:95], a[32:35], a[0:3], v[92:95]
    ds_read_b64_tr_b16 a[74:75], v17 offset:16896
    v_mfma_f32_16x16x32_bf16 v[96:99], a[32:35], a[4:7], v[96:99]
    ds_read_b64_tr_b16 a[76:77], v18 offset:26624
    v_mfma_f32_16x16x32_bf16 v[100:103], a[32:35], a[8:11], v[100:103]
    ds_read_b64_tr_b16 a[78:79], v18 offset:26880
    v_mfma_f32_16x16x32_bf16 v[104:107], a[32:35], a[12:15], v[104:107]
    v_mfma_f32_16x16x32_bf16 v[108:111], a[36:39], a[0:3], v[108:111]
    v_mfma_f32_16x16x32_bf16 v[112:115], a[36:39], a[4:7], v[112:115]
    v_mfma_f32_16x16x32_bf16 v[116:119], a[36:39], a[8:11], v[116:119]
    v_mfma_f32_16x16x32_bf16 v[120:123], a[36:39], a[12:15], v[120:123]
    s_waitcnt lgkmcnt(0)
    v_mfma_f32_16x16x32_bf16 v[28:31], a[56:59], a[40:43], v[28:31]
    s_add_u32 s88, s4, 0x830000
    s_addc_u32 s89, s5, 0
    s_mov_b32 s90, 28672
    s_mov_b32 s91, 0x00020000
    s_mul_i32 s42, s30, 896
    s_lshl_b32 s43, s39, 6
    s_add_u32 s42, s42, s43
    s_and_b32 s43, s30, 1
    s_cmp_lg_u32 s43, 0
    s_cselect_b32 s44, 0, 768
    s_cselect_b32 s43, 128, 0
    s_add_u32 s44, s44, s42
    s_add_u32 s43, s43, s42
    s_add_u32 s45, s43, 14336
    s_add_u32 s46, s44, 14336
    v_lshlrev_b32 v3, 4, v2
    s_add_u32 s20, s4, 0x840000
    s_addc_u32 s21, s5, 0
    s_mov_b32 s22, 131072
    s_mov_b32 s23, 0x00020000
    s_lshl_b32 s47, s29, 7
    s_lshl_b32 s48, s38, 6
    s_add_u32 s47, s47, s48
    s_lshl_b32 s47, s47, 6
    v_lshl_add_u32 v4, v1, 6, v3
    buffer_load_dwordx4 a[24:27], v4, s[20:23], s47 offen offset:0
    buffer_load_dwordx4 a[28:31], v4, s[20:23], s47 offen offset:1024
    buffer_load_dwordx4 a[32:35], v4, s[20:23], s47 offen offset:2048
    buffer_load_dwordx4 a[36:39], v4, s[20:23], s47 offen offset:3072
    buffer_load_dwordx4 a[0:3], v3, s[88:91], s43 offen offset:512
    buffer_load_dwordx4 a[4:7], v3, s[88:91], s43 offen offset:640
    buffer_load_dwordx4 a[8:11], v3, s[88:91], s44 offen offset:0
    buffer_load_dwordx4 a[12:15], v3, s[88:91], s45 offen offset:512
    buffer_load_dwordx4 a[16:19], v3, s[88:91], s45 offen offset:640
    buffer_load_dwordx4 a[20:23], v3, s[88:91], s46 offen offset:0
    v_mfma_f32_16x16x32_bf16 v[32:35], a[56:59], a[44:47], v[32:35]
    v_mfma_f32_16x16x32_bf16 v[36:39], a[56:59], a[48:51], v[36:39]
    v_mfma_f32_16x16x32_bf16 v[40:43], a[56:59], a[52:55], v[40:43]
    v_mfma_f32_16x16x32_bf16 v[44:47], a[60:63], a[40:43], v[44:47]
    v_mfma_f32_16x16x32_bf16 v[48:51], a[60:63], a[44:47], v[48:51]
    v_mfma_f32_16x16x32_bf16 v[52:55], a[60:63], a[48:51], v[52:55]
    v_mfma_f32_16x16x32_bf16 v[56:59], a[60:63], a[52:55], v[56:59]
    v_mfma_f32_16x16x32_bf16 v[60:63], a[64:67], a[40:43], v[60:63]
    v_mfma_f32_16x16x32_bf16 v[64:67], a[64:67], a[44:47], v[64:67]
    v_mfma_f32_16x16x32_bf16 v[68:71], a[64:67], a[48:51], v[68:71]
    v_mfma_f32_16x16x32_bf16 v[72:75], a[64:67], a[52:55], v[72:75]
    v_mfma_f32_16x16x32_bf16 v[76:79], a[68:71], a[40:43], v[76:79]
    v_mfma_f32_16x16x32_bf16 v[80:83], a[68:71], a[44:47], v[80:83]
    v_mfma_f32_16x16x32_bf16 v[84:87], a[68:71], a[48:51], v[84:87]
    v_mfma_f32_16x16x32_bf16 v[88:91], a[68:71], a[52:55], v[88:91]
    v_mfma_f32_16x16x32_bf16 v[92:95], a[72:75], a[40:43], v[92:95]
    v_mfma_f32_16x16x32_bf16 v[96:99], a[72:75], a[44:47], v[96:99]
    v_mfma_f32_16x16x32_bf16 v[100:103], a[72:75], a[48:51], v[100:103]
    v_mfma_f32_16x16x32_bf16 v[104:107], a[72:75], a[52:55], v[104:107]
    v_mfma_f32_16x16x32_bf16 v[108:111], a[76:79], a[40:43], v[108:111]
    v_mfma_f32_16x16x32_bf16 v[112:115], a[76:79], a[44:47], v[112:115]
    v_mfma_f32_16x16x32_bf16 v[116:119], a[76:79], a[48:51], v[116:119]
    v_mfma_f32_16x16x32_bf16 v[120:123], a[76:79], a[52:55], v[120:123]
    s_nop 7
    s_lshl_b32 s42, s29, 7
    s_lshl_b32 s43, s38, 6
    s_add_u32 s42, s42, s43
    s_mul_i32 s42, s42, 7168
    s_mul_i32 s43, s30, 448
    s_add_u32 s42, s42, s43
    s_lshl_b32 s43, s39, 5
    s_add_u32 s42, s42, s43
    s_add_u32 s43, s42, 114688
    s_add_u32 s44, s42, 229376
    s_add_u32 s45, s42, 344064
    s_mov_b32 s46, 7168
    v_mul_lo_u32 v3, v1, s46
    v_lshl_add_u32 v3, v2, 3, v3
    s_and_b32 s47, s30, 1
    s_cmp_lg_u32 s47, 0
    s_cselect_b32 s48, 0, 384
    s_cselect_b32 s47, 64, 0
    s_mov_b32 s50, 0xbdd2d3e8
    s_mov_b32 s51, 0xbdd2d3e8
    v_mov_b32 v4, 0xc0135761
    v_mov_b32 v5, 0xc0135761
    s_waitcnt vmcnt(0)
    v_accvgpr_read_b32 v6, a24
    v_accvgpr_read_b32 v7, a25
    v_accvgpr_read_b32 v8, a26
    v_accvgpr_read_b32 v9, a27
    v_accvgpr_read_b32 v10, a28
    v_accvgpr_read_b32 v11, a29
    v_accvgpr_read_b32 v12, a30
    v_accvgpr_read_b32 v13, a31
    v_add_f32 v14, v6, v8
    v_add_f32 v17, v10, v12
    v_add_f32 v15, v7, v9
    v_add_f32 v18, v11, v13
    s_nop 0
    v_mov_b32 v16, v14
    v_mov_b32 v19, v17
    s_nop 0
    v_permlane16_swap_b32 v14, v16
    v_permlane16_swap_b32 v17, v19
    s_nop 0
    v_add_f32 v14, v14, v16
    v_add_f32 v17, v17, v19
    v_mov_b32 v16, v14
    v_mov_b32 v19, v17
    s_nop 1
    v_permlane32_swap_b32 v14, v16
    v_permlane32_swap_b32 v17, v19
    s_nop 0
    v_add_f32 v14, v14, v16
    v_add_f32 v17, v17, v19
    v_mul_f32 v14, 0x3e000000, v14
    v_mul_f32 v17, 0x3e000000, v17
    v_sub_f32 v6, v6, v14
    v_sub_f32 v10, v10, v17
    v_sub_f32 v8, v8, v14
    v_sub_f32 v12, v12, v17
    v_mul_f32 v6, v6, v6
    v_mul_f32 v10, v10, v10
    v_fmac_f32 v6, v8, v8
    v_fmac_f32 v10, v12, v12
    v_fmac_f32 v15, 0x43000000, v6
    v_fmac_f32 v18, 0x43000000, v10
    s_nop 0
    v_mov_b32 v16, v15
    v_mov_b32 v19, v18
    s_nop 0
    v_permlane16_swap_b32 v15, v16
    v_permlane16_swap_b32 v18, v19
    s_nop 0
    v_add_f32 v15, v15, v16
    v_add_f32 v18, v18, v19
    v_mov_b32 v16, v15
    v_mov_b32 v19, v18
    s_nop 1
    v_permlane32_swap_b32 v15, v16
    v_permlane32_swap_b32 v18, v19
    s_nop 0
    v_add_f32 v15, v15, v16
    v_add_f32 v18, v18, v19
    v_mul_f32 v15, 0x3a800000, v15
    v_mul_f32 v18, 0x3a800000, v18
    v_cvt_pk_bf16_f32 v16, v14, v15
    v_cvt_pk_bf16_f32 v19, v17, v18
    v_lshlrev_b32 v14, 16, v16
    v_lshlrev_b32 v17, 16, v19
    v_and_b32 v15, 0xffff0000, v16
    v_and_b32 v18, 0xffff0000, v19
    v_add_f32 v15, 0x3727c5ac, v15
    v_add_f32 v18, 0x3727c5ac, v18
    v_cvt_pk_bf16_f32 v16, v15, v15
    v_cvt_pk_bf16_f32 v19, v18, v18
    v_lshlrev_b32 v15, 16, v16
    v_lshlrev_b32 v18, 16, v19
    v_sqrt_f32 v15, v15
    v_sqrt_f32 v18, v18
    s_nop 0
    v_cvt_pk_bf16_f32 v16, v15, v15
    v_cvt_pk_bf16_f32 v19, v18, v18
    v_lshlrev_b32 v15, 16, v16
    v_lshlrev_b32 v18, 16, v19
    v_rcp_f32 v20, v15
    v_rcp_f32 v22, v18
    s_nop 0
    v_mul_f32 v21, v14, v20
    v_mul_f32 v23, v17, v22
    v_sub_f32 v21, 0, v21
    v_sub_f32 v23, 0, v23
    v_accvgpr_read_b32 v6, a32
    v_accvgpr_read_b32 v7, a33
    v_accvgpr_read_b32 v8, a34
    v_accvgpr_read_b32 v9, a35
    v_accvgpr_read_b32 v10, a36
    v_accvgpr_read_b32 v11, a37
    v_accvgpr_read_b32 v12, a38
    v_accvgpr_read_b32 v13, a39
    v_add_f32 v14, v6, v8
    v_add_f32 v17, v10, v12
    v_add_f32 v15, v7, v9
    v_add_f32 v18, v11, v13
    s_nop 0
    v_mov_b32 v16, v14
    v_mov_b32 v19, v17
    s_nop 0
    v_permlane16_swap_b32 v14, v16
    v_permlane16_swap_b32 v17, v19
    s_nop 0
    v_add_f32 v14, v14, v16
    v_add_f32 v17, v17, v19
    v_mov_b32 v16, v14
    v_mov_b32 v19, v17
    s_nop 1
    v_permlane32_swap_b32 v14, v16
    v_permlane32_swap_b32 v17, v19
    s_nop 0
    v_add_f32 v14, v14, v16
    v_add_f32 v17, v17, v19
    v_mul_f32 v14, 0x3e000000, v14
    v_mul_f32 v17, 0x3e000000, v17
    v_sub_f32 v6, v6, v14
    v_sub_f32 v10, v10, v17
    v_sub_f32 v8, v8, v14
    v_sub_f32 v12, v12, v17
    v_mul_f32 v6, v6, v6
    v_mul_f32 v10, v10, v10
    v_fmac_f32 v6, v8, v8
    v_fmac_f32 v10, v12, v12
    v_fmac_f32 v15, 0x43000000, v6
    v_fmac_f32 v18, 0x43000000, v10
    s_nop 0
    v_mov_b32 v16, v15
    v_mov_b32 v19, v18
    s_nop 0
    v_permlane16_swap_b32 v15, v16
    v_permlane16_swap_b32 v18, v19
    s_nop 0
    v_add_f32 v15, v15, v16
    v_add_f32 v18, v18, v19
    v_mov_b32 v16, v15
    v_mov_b32 v19, v18
    s_nop 1
    v_permlane32_swap_b32 v15, v16
    v_permlane32_swap_b32 v18, v19
    s_nop 0
    v_add_f32 v15, v15, v16
    v_add_f32 v18, v18, v19
    v_mul_f32 v15, 0x3a800000, v15
    v_mul_f32 v18, 0x3a800000, v18
    v_cvt_pk_bf16_f32 v16, v14, v15
    v_cvt_pk_bf16_f32 v19, v17, v18
    v_lshlrev_b32 v14, 16, v16
    v_lshlrev_b32 v17, 16, v19
    v_and_b32 v15, 0xffff0000, v16
    v_and_b32 v18, 0xffff0000, v19
    v_add_f32 v15, 0x3727c5ac, v15
    v_add_f32 v18, 0x3727c5ac, v18
    v_cvt_pk_bf16_f32 v16, v15, v15
    v_cvt_pk_bf16_f32 v19, v18, v18
    v_lshlrev_b32 v15, 16, v16
    v_lshlrev_b32 v18, 16, v19
    v_sqrt_f32 v15, v15
    v_sqrt_f32 v18, v18
    s_nop 0
    v_cvt_pk_bf16_f32 v16, v15, v15
    v_cvt_pk_bf16_f32 v19, v18, v18
    v_lshlrev_b32 v15, 16, v16
    v_lshlrev_b32 v18, 16, v19
    v_rcp_f32 v24, v15
    v_rcp_f32 v26, v18
    s_nop 0
    v_mul_f32 v25, v14, v24
    v_mul_f32 v27, v17, v26
    v_sub_f32 v25, 0, v25
    v_sub_f32 v27, 0, v27
    v_add_u32 v10, s48, v3
    v_add_u32 v3, s47, v3
    v_accvgpr_read_b32 v12, a0
    v_accvgpr_read_b32 v13, a1
    v_accvgpr_read_b32 v14, a2
    v_accvgpr_read_b32 v15, a3
    v_pk_mul_f32 v[16:17], v[12:13], v[20:21] op_sel:[0,1] op_sel_hi:[1,1]
    v_pk_fma_f32 v[28:29], v[28:29], v[20:21], v[16:17] op_sel:[0,0,0] op_sel_hi:[1,0,1]
    v_pk_mul_f32 v[16:17], v[14:15], v[20:21] op_sel:[0,1] op_sel_hi:[1,1]
    v_pk_fma_f32 v[30:31], v[30:31], v[20:21], v[16:17] op_sel:[0,0,0] op_sel_hi:[1,0,1]
    v_pk_mul_f32 v[16:17], v[12:13], v[22:23] op_sel:[0,1] op_sel_hi:[1,1]
    v_pk_fma_f32 v[32:33], v[32:33], v[22:23], v[16:17] op_sel:[0,0,0] op_sel_hi:[1,0,1]
    v_pk_mul_f32 v[16:17], v[14:15], v[22:23] op_sel:[0,1] op_sel_hi:[1,1]
    v_pk_fma_f32 v[34:35], v[34:35], v[22:23], v[16:17] op_sel:[0,0,0] op_sel_hi:[1,0,1]
    v_pk_mul_f32 v[16:17], v[12:13], v[24:25] op_sel:[0,1] op_sel_hi:[1,1]
    v_pk_fma_f32 v[36:37], v[36:37], v[24:25], v[16:17] op_sel:[0,0,0] op_sel_hi:[1,0,1]
    v_pk_mul_f32 v[16:17], v[14:15], v[24:25] op_sel:[0,1] op_sel_hi:[1,1]
    v_pk_fma_f32 v[38:39], v[38:39], v[24:25], v[16:17] op_sel:[0,0,0] op_sel_hi:[1,0,1]
    v_pk_mul_f32 v[16:17], v[12:13], v[26:27] op_sel:[0,1] op_sel_hi:[1,1]
    v_pk_fma_f32 v[40:41], v[40:41], v[26:27], v[16:17] op_sel:[0,0,0] op_sel_hi:[1,0,1]
    v_pk_mul_f32 v[16:17], v[14:15], v[26:27] op_sel:[0,1] op_sel_hi:[1,1]
    v_pk_fma_f32 v[42:43], v[42:43], v[26:27], v[16:17] op_sel:[0,0,0] op_sel_hi:[1,0,1]
    v_accvgpr_read_b32 v12, a12
    v_accvgpr_read_b32 v13, a13
    v_accvgpr_read_b32 v14, a14
    v_accvgpr_read_b32 v15, a15
    v_pk_mul_f32 v[16:17], v[12:13], v[20:21] op_sel:[0,1] op_sel_hi:[1,1]
    v_pk_fma_f32 v[76:77], v[76:77], v[20:21], v[16:17] op_sel:[0,0,0] op_sel_hi:[1,0,1]
    v_pk_mul_f32 v[16:17], v[14:15], v[20:21] op_sel:[0,1] op_sel_hi:[1,1]
    v_pk_fma_f32 v[78:79], v[78:79], v[20:21], v[16:17] op_sel:[0,0,0] op_sel_hi:[1,0,1]
    v_pk_mul_f32 v[16:17], v[12:13], v[22:23] op_sel:[0,1] op_sel_hi:[1,1]
    v_pk_fma_f32 v[80:81], v[80:81], v[22:23], v[16:17] op_sel:[0,0,0] op_sel_hi:[1,0,1]
    v_pk_mul_f32 v[16:17], v[14:15], v[22:23] op_sel:[0,1] op_sel_hi:[1,1]
    v_pk_fma_f32 v[82:83], v[82:83], v[22:23], v[16:17] op_sel:[0,0,0] op_sel_hi:[1,0,1]
    v_pk_mul_f32 v[16:17], v[12:13], v[24:25] op_sel:[0,1] op_sel_hi:[1,1]
    v_pk_fma_f32 v[84:85], v[84:85], v[24:25], v[16:17] op_sel:[0,0,0] op_sel_hi:[1,0,1]
    v_pk_mul_f32 v[16:17], v[14:15], v[24:25] op_sel:[0,1] op_sel_hi:[1,1]
    v_pk_fma_f32 v[86:87], v[86:87], v[24:25], v[16:17] op_sel:[0,0,0] op_sel_hi:[1,0,1]
    v_pk_mul_f32 v[16:17], v[12:13], v[26:27] op_sel:[0,1] op_sel_hi:[1,1]
    v_pk_fma_f32 v[88:89], v[88:89], v[26:27], v[16:17] op_sel:[0,0,0] op_sel_hi:[1,0,1]
    v_pk_mul_f32 v[16:17], v[14:15], v[26:27] op_sel:[0,1] op_sel_hi:[1,1]
    v_pk_fma_f32 v[90:91], v[90:91], v[26:27], v[16:17] op_sel:[0,0,0] op_sel_hi:[1,0,1]
    v_accvgpr_read_b32 v12, a4
    v_accvgpr_read_b32 v13, a5
    v_accvgpr_read_b32 v14, a6
    v_accvgpr_read_b32 v15, a7
    v_pk_mul_f32 v[16:17], v[12:13], v[20:21] op_sel:[0,1] op_sel_hi:[1,1]
    v_pk_fma_f32 v[44:45], v[44:45], v[20:21], v[16:17] op_sel:[0,0,0] op_sel_hi:[1,0,1]
    v_pk_mul_f32 v[16:17], v[14:15], v[20:21] op_sel:[0,1] op_sel_hi:[1,1]
    v_pk_fma_f32 v[46:47], v[46:47], v[20:21], v[16:17] op_sel:[0,0,0] op_sel_hi:[1,0,1]
    v_pk_mul_f32 v[16:17], v[12:13], v[22:23] op_sel:[0,1] op_sel_hi:[1,1]
    v_pk_fma_f32 v[48:49], v[48:49], v[22:23], v[16:17] op_sel:[0,0,0] op_sel_hi:[1,0,1]
    v_pk_mul_f32 v[16:17], v[14:15], v[22:23] op_sel:[0,1] op_sel_hi:[1,1]
    v_pk_fma_f32 v[50:51], v[50:51], v[22:23], v[16:17] op_sel:[0,0,0] op_sel_hi:[1,0,1]
    v_pk_mul_f32 v[16:17], v[12:13], v[24:25] op_sel:[0,1] op_sel_hi:[1,1]
    v_pk_fma_f32 v[52:53], v[52:53], v[24:25], v[16:17] op_sel:[0,0,0] op_sel_hi:[1,0,1]
    v_pk_mul_f32 v[16:17], v[14:15], v[24:25] op_sel:[0,1] op_sel_hi:[1,1]
    v_pk_fma_f32 v[54:55], v[54:55], v[24:25], v[16:17] op_sel:[0,0,0] op_sel_hi:[1,0,1]
    v_pk_mul_f32 v[16:17], v[12:13], v[26:27] op_sel:[0,1] op_sel_hi:[1,1]
    v_pk_fma_f32 v[56:57], v[56:57], v[26:27], v[16:17] op_sel:[0,0,0] op_sel_hi:[1,0,1]
    v_pk_mul_f32 v[16:17], v[14:15], v[26:27] op_sel:[0,1] op_sel_hi:[1,1]
    v_pk_fma_f32 v[58:59], v[58:59], v[26:27], v[16:17] op_sel:[0,0,0] op_sel_hi:[1,0,1]
    v_accvgpr_read_b32 v12, a16
    v_accvgpr_read_b32 v13, a17
    v_accvgpr_read_b32 v14, a18
    v_accvgpr_read_b32 v15, a19
    v_pk_mul_f32 v[16:17], v[12:13], v[20:21] op_sel:[0,1] op_sel_hi:[1,1]
    v_pk_fma_f32 v[92:93], v[92:93], v[20:21], v[16:17] op_sel:[0,0,0] op_sel_hi:[1,0,1]
    v_pk_mul_f32 v[16:17], v[14:15], v[20:21] op_sel:[0,1] op_sel_hi:[1,1]
    v_pk_fma_f32 v[94:95], v[94:95], v[20:21], v[16:17] op_sel:[0,0,0] op_sel_hi:[1,0,1]
    v_pk_mul_f32 v[16:17], v[12:13], v[22:23] op_sel:[0,1] op_sel_hi:[1,1]
    v_pk_fma_f32 v[96:97], v[96:97], v[22:23], v[16:17] op_sel:[0,0,0] op_sel_hi:[1,0,1]
    v_pk_mul_f32 v[16:17], v[14:15], v[22:23] op_sel:[0,1] op_sel_hi:[1,1]
    v_pk_fma_f32 v[98:99], v[98:99], v[22:23], v[16:17] op_sel:[0,0,0] op_sel_hi:[1,0,1]
    v_pk_mul_f32 v[16:17], v[12:13], v[24:25] op_sel:[0,1] op_sel_hi:[1,1]
    v_pk_fma_f32 v[100:101], v[100:101], v[24:25], v[16:17] op_sel:[0,0,0] op_sel_hi:[1,0,1]
    v_pk_mul_f32 v[16:17], v[14:15], v[24:25] op_sel:[0,1] op_sel_hi:[1,1]
    v_pk_fma_f32 v[102:103], v[102:103], v[24:25], v[16:17] op_sel:[0,0,0] op_sel_hi:[1,0,1]
    v_pk_mul_f32 v[16:17], v[12:13], v[26:27] op_sel:[0,1] op_sel_hi:[1,1]
    v_pk_fma_f32 v[104:105], v[104:105], v[26:27], v[16:17] op_sel:[0,0,0] op_sel_hi:[1,0,1]
    v_pk_mul_f32 v[16:17], v[14:15], v[26:27] op_sel:[0,1] op_sel_hi:[1,1]
    v_pk_fma_f32 v[106:107], v[106:107], v[26:27], v[16:17] op_sel:[0,0,0] op_sel_hi:[1,0,1]
    v_accvgpr_read_b32 v12, a8
    v_accvgpr_read_b32 v13, a9
    v_accvgpr_read_b32 v14, a10
    v_accvgpr_read_b32 v15, a11
    v_pk_mul_f32 v[16:17], v[12:13], v[20:21] op_sel:[0,1] op_sel_hi:[1,1]
    v_pk_fma_f32 v[60:61], v[60:61], v[20:21], v[16:17] op_sel:[0,0,0] op_sel_hi:[1,0,1]
    v_pk_mul_f32 v[16:17], v[14:15], v[20:21] op_sel:[0,1] op_sel_hi:[1,1]
    v_pk_fma_f32 v[62:63], v[62:63], v[20:21], v[16:17] op_sel:[0,0,0] op_sel_hi:[1,0,1]
    v_pk_mul_f32 v[16:17], v[12:13], v[22:23] op_sel:[0,1] op_sel_hi:[1,1]
    v_pk_fma_f32 v[64:65], v[64:65], v[22:23], v[16:17] op_sel:[0,0,0] op_sel_hi:[1,0,1]
    v_pk_mul_f32 v[16:17], v[14:15], v[22:23] op_sel:[0,1] op_sel_hi:[1,1]
    v_pk_fma_f32 v[66:67], v[66:67], v[22:23], v[16:17] op_sel:[0,0,0] op_sel_hi:[1,0,1]
    v_pk_mul_f32 v[16:17], v[12:13], v[24:25] op_sel:[0,1] op_sel_hi:[1,1]
    v_pk_fma_f32 v[68:69], v[68:69], v[24:25], v[16:17] op_sel:[0,0,0] op_sel_hi:[1,0,1]
    v_pk_mul_f32 v[16:17], v[14:15], v[24:25] op_sel:[0,1] op_sel_hi:[1,1]
    v_pk_fma_f32 v[70:71], v[70:71], v[24:25], v[16:17] op_sel:[0,0,0] op_sel_hi:[1,0,1]
    v_pk_mul_f32 v[16:17], v[12:13], v[26:27] op_sel:[0,1] op_sel_hi:[1,1]
    v_pk_fma_f32 v[72:73], v[72:73], v[26:27], v[16:17] op_sel:[0,0,0] op_sel_hi:[1,0,1]
    v_pk_mul_f32 v[16:17], v[14:15], v[26:27] op_sel:[0,1] op_sel_hi:[1,1]
    v_pk_fma_f32 v[74:75], v[74:75], v[26:27], v[16:17] op_sel:[0,0,0] op_sel_hi:[1,0,1]
    v_accvgpr_read_b32 v12, a20
    v_accvgpr_read_b32 v13, a21
    v_accvgpr_read_b32 v14, a22
    v_accvgpr_read_b32 v15, a23
    v_pk_mul_f32 v[16:17], v[12:13], v[20:21] op_sel:[0,1] op_sel_hi:[1,1]
    v_pk_fma_f32 v[108:109], v[108:109], v[20:21], v[16:17] op_sel:[0,0,0] op_sel_hi:[1,0,1]
    v_pk_mul_f32 v[16:17], v[14:15], v[20:21] op_sel:[0,1] op_sel_hi:[1,1]
    v_pk_fma_f32 v[110:111], v[110:111], v[20:21], v[16:17] op_sel:[0,0,0] op_sel_hi:[1,0,1]
    v_pk_mul_f32 v[16:17], v[12:13], v[22:23] op_sel:[0,1] op_sel_hi:[1,1]
    v_pk_fma_f32 v[112:113], v[112:113], v[22:23], v[16:17] op_sel:[0,0,0] op_sel_hi:[1,0,1]
    v_pk_mul_f32 v[16:17], v[14:15], v[22:23] op_sel:[0,1] op_sel_hi:[1,1]
    v_pk_fma_f32 v[114:115], v[114:115], v[22:23], v[16:17] op_sel:[0,0,0] op_sel_hi:[1,0,1]
    v_pk_mul_f32 v[16:17], v[12:13], v[24:25] op_sel:[0,1] op_sel_hi:[1,1]
    v_pk_fma_f32 v[116:117], v[116:117], v[24:25], v[16:17] op_sel:[0,0,0] op_sel_hi:[1,0,1]
    v_pk_mul_f32 v[16:17], v[14:15], v[24:25] op_sel:[0,1] op_sel_hi:[1,1]
    v_pk_fma_f32 v[118:119], v[118:119], v[24:25], v[16:17] op_sel:[0,0,0] op_sel_hi:[1,0,1]
    v_pk_mul_f32 v[16:17], v[12:13], v[26:27] op_sel:[0,1] op_sel_hi:[1,1]
    v_pk_fma_f32 v[120:121], v[120:121], v[26:27], v[16:17] op_sel:[0,0,0] op_sel_hi:[1,0,1]
    v_pk_mul_f32 v[16:17], v[14:15], v[26:27] op_sel:[0,1] op_sel_hi:[1,1]
    v_pk_fma_f32 v[122:123], v[122:123], v[26:27], v[16:17] op_sel:[0,0,0] op_sel_hi:[1,0,1]
    v_pk_mul_f32 v[6:7], v[28:29], v[28:29]
    v_pk_mul_f32 v[8:9], v[30:31], v[30:31]
    v_pk_fma_f32 v[6:7], v[6:7], s[50:51], v[4:5]
    v_pk_fma_f32 v[8:9], v[8:9], s[50:51], v[4:5]
    v_pk_mul_f32 v[6:7], v[6:7], v[28:29]
    v_pk_mul_f32 v[8:9], v[8:9], v[30:31]
    v_exp_f32 v6, v6
    v_exp_f32 v7, v7
    v_exp_f32 v8, v8
    v_exp_f32 v9, v9
    v_pk_mul_f32 v[28:29], v[28:29], v[76:77]
    v_pk_mul_f32 v[30:31], v[30:31], v[78:79]
    v_add_f32 v6, 1.0, v6
    v_add_f32 v7, 1.0, v7
    v_add_f32 v8, 1.0, v8
    v_add_f32 v9, 1.0, v9
    v_rcp_f32 v6, v6
    v_rcp_f32 v7, v7
    v_rcp_f32 v8, v8
    v_rcp_f32 v9, v9
    s_nop 0
    v_pk_mul_f32 v[28:29], v[28:29], v[6:7]
    v_pk_mul_f32 v[30:31], v[30:31], v[8:9]
    v_cvt_pk_bf16_f32 v28, v28, v29
    v_cvt_pk_bf16_f32 v29, v30, v31
    buffer_store_dwordx2 v[28:29], v3, s[16:19], s42 offen offset:256
    v_pk_mul_f32 v[6:7], v[44:45], v[44:45]
    v_pk_mul_f32 v[8:9], v[46:47], v[46:47]
    v_pk_fma_f32 v[6:7], v[6:7], s[50:51], v[4:5]
    v_pk_fma_f32 v[8:9], v[8:9], s[50:51], v[4:5]
    v_pk_mul_f32 v[6:7], v[6:7], v[44:45]
    v_pk_mul_f32 v[8:9], v[8:9], v[46:47]
    v_exp_f32 v6, v6
    v_exp_f32 v7, v7
    v_exp_f32 v8, v8
    v_exp_f32 v9, v9
    v_pk_mul_f32 v[44:45], v[44:45], v[92:93]
    v_pk_mul_f32 v[46:47], v[46:47], v[94:95]
    v_add_f32 v6, 1.0, v6
    v_add_f32 v7, 1.0, v7
    v_add_f32 v8, 1.0, v8
    v_add_f32 v9, 1.0, v9
    v_rcp_f32 v6, v6
    v_rcp_f32 v7, v7
    v_rcp_f32 v8, v8
    v_rcp_f32 v9, v9
    s_nop 0
    v_pk_mul_f32 v[44:45], v[44:45], v[6:7]
    v_pk_mul_f32 v[46:47], v[46:47], v[8:9]
    v_cvt_pk_bf16_f32 v44, v44, v45
    v_cvt_pk_bf16_f32 v45, v46, v47
    buffer_store_dwordx2 v[44:45], v3, s[16:19], s42 offen offset:320
    v_pk_mul_f32 v[6:7], v[60:61], v[60:61]
    v_pk_mul_f32 v[8:9], v[62:63], v[62:63]
    v_pk_fma_f32 v[6:7], v[6:7], s[50:51], v[4:5]
    v_pk_fma_f32 v[8:9], v[8:9], s[50:51], v[4:5]
    v_pk_mul_f32 v[6:7], v[6:7], v[60:61]
    v_pk_mul_f32 v[8:9], v[8:9], v[62:63]
    v_exp_f32 v6, v6
    v_exp_f32 v7, v7
    v_exp_f32 v8, v8
    v_exp_f32 v9, v9
    v_pk_mul_f32 v[60:61], v[60:61], v[108:109]
    v_pk_mul_f32 v[62:63], v[62:63], v[110:111]
    v_add_f32 v6, 1.0, v6
    v_add_f32 v7, 1.0, v7
    v_add_f32 v8, 1.0, v8
    v_add_f32 v9, 1.0, v9
    v_rcp_f32 v6, v6
    v_rcp_f32 v7, v7
    v_rcp_f32 v8, v8
    v_rcp_f32 v9, v9
    s_nop 0
    v_pk_mul_f32 v[60:61], v[60:61], v[6:7]
    v_pk_mul_f32 v[62:63], v[62:63], v[8:9]
    v_cvt_pk_bf16_f32 v60, v60, v61
    v_cvt_pk_bf16_f32 v61, v62, v63
    buffer_store_dwordx2 v[60:61], v10, s[16:19], s42 offen offset:0
    v_pk_mul_f32 v[6:7], v[32:33], v[32:33]
    v_pk_mul_f32 v[8:9], v[34:35], v[34:35]
    v_pk_fma_f32 v[6:7], v[6:7], s[50:51], v[4:5]
    v_pk_fma_f32 v[8:9], v[8:9], s[50:51], v[4:5]
    v_pk_mul_f32 v[6:7], v[6:7], v[32:33]
    v_pk_mul_f32 v[8:9], v[8:9], v[34:35]
    v_exp_f32 v6, v6
    v_exp_f32 v7, v7
    v_exp_f32 v8, v8
    v_exp_f32 v9, v9
    v_pk_mul_f32 v[32:33], v[32:33], v[80:81]
    v_pk_mul_f32 v[34:35], v[34:35], v[82:83]
    v_add_f32 v6, 1.0, v6
    v_add_f32 v7, 1.0, v7
    v_add_f32 v8, 1.0, v8
    v_add_f32 v9, 1.0, v9
    v_rcp_f32 v6, v6
    v_rcp_f32 v7, v7
    v_rcp_f32 v8, v8
    v_rcp_f32 v9, v9
    s_nop 0
    v_pk_mul_f32 v[32:33], v[32:33], v[6:7]
    v_pk_mul_f32 v[34:35], v[34:35], v[8:9]
    v_cvt_pk_bf16_f32 v32, v32, v33
    v_cvt_pk_bf16_f32 v33, v34, v35
    buffer_store_dwordx2 v[32:33], v3, s[16:19], s43 offen offset:256
    v_pk_mul_f32 v[6:7], v[48:49], v[48:49]
    v_pk_mul_f32 v[8:9], v[50:51], v[50:51]
    v_pk_fma_f32 v[6:7], v[6:7], s[50:51], v[4:5]
    v_pk_fma_f32 v[8:9], v[8:9], s[50:51], v[4:5]
    v_pk_mul_f32 v[6:7], v[6:7], v[48:49]
    v_pk_mul_f32 v[8:9], v[8:9], v[50:51]
    v_exp_f32 v6, v6
    v_exp_f32 v7, v7
    v_exp_f32 v8, v8
    v_exp_f32 v9, v9
    v_pk_mul_f32 v[48:49], v[48:49], v[96:97]
    v_pk_mul_f32 v[50:51], v[50:51], v[98:99]
    v_add_f32 v6, 1.0, v6
    v_add_f32 v7, 1.0, v7
    v_add_f32 v8, 1.0, v8
    v_add_f32 v9, 1.0, v9
    v_rcp_f32 v6, v6
    v_rcp_f32 v7, v7
    v_rcp_f32 v8, v8
    v_rcp_f32 v9, v9
    s_nop 0
    v_pk_mul_f32 v[48:49], v[48:49], v[6:7]
    v_pk_mul_f32 v[50:51], v[50:51], v[8:9]
    v_cvt_pk_bf16_f32 v48, v48, v49
    v_cvt_pk_bf16_f32 v49, v50, v51
    buffer_store_dwordx2 v[48:49], v3, s[16:19], s43 offen offset:320
    v_pk_mul_f32 v[6:7], v[64:65], v[64:65]
    v_pk_mul_f32 v[8:9], v[66:67], v[66:67]
    v_pk_fma_f32 v[6:7], v[6:7], s[50:51], v[4:5]
    v_pk_fma_f32 v[8:9], v[8:9], s[50:51], v[4:5]
    v_pk_mul_f32 v[6:7], v[6:7], v[64:65]
    v_pk_mul_f32 v[8:9], v[8:9], v[66:67]
    v_exp_f32 v6, v6
    v_exp_f32 v7, v7
    v_exp_f32 v8, v8
    v_exp_f32 v9, v9
    v_pk_mul_f32 v[64:65], v[64:65], v[112:113]
    v_pk_mul_f32 v[66:67], v[66:67], v[114:115]
    v_add_f32 v6, 1.0, v6
    v_add_f32 v7, 1.0, v7
    v_add_f32 v8, 1.0, v8
    v_add_f32 v9, 1.0, v9
    v_rcp_f32 v6, v6
    v_rcp_f32 v7, v7
    v_rcp_f32 v8, v8
    v_rcp_f32 v9, v9
    s_nop 0
    v_pk_mul_f32 v[64:65], v[64:65], v[6:7]
    v_pk_mul_f32 v[66:67], v[66:67], v[8:9]
    v_cvt_pk_bf16_f32 v64, v64, v65
    v_cvt_pk_bf16_f32 v65, v66, v67
    buffer_store_dwordx2 v[64:65], v10, s[16:19], s43 offen offset:0
    v_pk_mul_f32 v[6:7], v[36:37], v[36:37]
    v_pk_mul_f32 v[8:9], v[38:39], v[38:39]
    v_pk_fma_f32 v[6:7], v[6:7], s[50:51], v[4:5]
    v_pk_fma_f32 v[8:9], v[8:9], s[50:51], v[4:5]
    v_pk_mul_f32 v[6:7], v[6:7], v[36:37]
    v_pk_mul_f32 v[8:9], v[8:9], v[38:39]
    v_exp_f32 v6, v6
    v_exp_f32 v7, v7
    v_exp_f32 v8, v8
    v_exp_f32 v9, v9
    v_pk_mul_f32 v[36:37], v[36:37], v[84:85]
    v_pk_mul_f32 v[38:39], v[38:39], v[86:87]
    v_add_f32 v6, 1.0, v6
    v_add_f32 v7, 1.0, v7
    v_add_f32 v8, 1.0, v8
    v_add_f32 v9, 1.0, v9
    v_rcp_f32 v6, v6
    v_rcp_f32 v7, v7
    v_rcp_f32 v8, v8
    v_rcp_f32 v9, v9
    s_nop 0
    v_pk_mul_f32 v[36:37], v[36:37], v[6:7]
    v_pk_mul_f32 v[38:39], v[38:39], v[8:9]
    v_cvt_pk_bf16_f32 v36, v36, v37
    v_cvt_pk_bf16_f32 v37, v38, v39
    buffer_store_dwordx2 v[36:37], v3, s[16:19], s44 offen offset:256
    v_pk_mul_f32 v[6:7], v[52:53], v[52:53]
    v_pk_mul_f32 v[8:9], v[54:55], v[54:55]
    v_pk_fma_f32 v[6:7], v[6:7], s[50:51], v[4:5]
    v_pk_fma_f32 v[8:9], v[8:9], s[50:51], v[4:5]
    v_pk_mul_f32 v[6:7], v[6:7], v[52:53]
    v_pk_mul_f32 v[8:9], v[8:9], v[54:55]
    v_exp_f32 v6, v6
    v_exp_f32 v7, v7
    v_exp_f32 v8, v8
    v_exp_f32 v9, v9
    v_pk_mul_f32 v[52:53], v[52:53], v[100:101]
    v_pk_mul_f32 v[54:55], v[54:55], v[102:103]
    v_add_f32 v6, 1.0, v6
    v_add_f32 v7, 1.0, v7
    v_add_f32 v8, 1.0, v8
    v_add_f32 v9, 1.0, v9
    v_rcp_f32 v6, v6
    v_rcp_f32 v7, v7
    v_rcp_f32 v8, v8
    v_rcp_f32 v9, v9
    s_nop 0
    v_pk_mul_f32 v[52:53], v[52:53], v[6:7]
    v_pk_mul_f32 v[54:55], v[54:55], v[8:9]
    v_cvt_pk_bf16_f32 v52, v52, v53
    v_cvt_pk_bf16_f32 v53, v54, v55
    buffer_store_dwordx2 v[52:53], v3, s[16:19], s44 offen offset:320
    v_pk_mul_f32 v[6:7], v[68:69], v[68:69]
    v_pk_mul_f32 v[8:9], v[70:71], v[70:71]
    v_pk_fma_f32 v[6:7], v[6:7], s[50:51], v[4:5]
    v_pk_fma_f32 v[8:9], v[8:9], s[50:51], v[4:5]
    v_pk_mul_f32 v[6:7], v[6:7], v[68:69]
    v_pk_mul_f32 v[8:9], v[8:9], v[70:71]
    v_exp_f32 v6, v6
    v_exp_f32 v7, v7
    v_exp_f32 v8, v8
    v_exp_f32 v9, v9
    v_pk_mul_f32 v[68:69], v[68:69], v[116:117]
    v_pk_mul_f32 v[70:71], v[70:71], v[118:119]
    v_add_f32 v6, 1.0, v6
    v_add_f32 v7, 1.0, v7
    v_add_f32 v8, 1.0, v8
    v_add_f32 v9, 1.0, v9
    v_rcp_f32 v6, v6
    v_rcp_f32 v7, v7
    v_rcp_f32 v8, v8
    v_rcp_f32 v9, v9
    s_nop 0
    v_pk_mul_f32 v[68:69], v[68:69], v[6:7]
    v_pk_mul_f32 v[70:71], v[70:71], v[8:9]
    v_cvt_pk_bf16_f32 v68, v68, v69
    v_cvt_pk_bf16_f32 v69, v70, v71
    buffer_store_dwordx2 v[68:69], v10, s[16:19], s44 offen offset:0
    v_pk_mul_f32 v[6:7], v[40:41], v[40:41]
    v_pk_mul_f32 v[8:9], v[42:43], v[42:43]
    v_pk_fma_f32 v[6:7], v[6:7], s[50:51], v[4:5]
    v_pk_fma_f32 v[8:9], v[8:9], s[50:51], v[4:5]
    v_pk_mul_f32 v[6:7], v[6:7], v[40:41]
    v_pk_mul_f32 v[8:9], v[8:9], v[42:43]
    v_exp_f32 v6, v6
    v_exp_f32 v7, v7
    v_exp_f32 v8, v8
    v_exp_f32 v9, v9
    v_pk_mul_f32 v[40:41], v[40:41], v[88:89]
    v_pk_mul_f32 v[42:43], v[42:43], v[90:91]
    v_add_f32 v6, 1.0, v6
    v_add_f32 v7, 1.0, v7
    v_add_f32 v8, 1.0, v8
    v_add_f32 v9, 1.0, v9
    v_rcp_f32 v6, v6
    v_rcp_f32 v7, v7
    v_rcp_f32 v8, v8
    v_rcp_f32 v9, v9
    s_nop 0
    v_pk_mul_f32 v[40:41], v[40:41], v[6:7]
    v_pk_mul_f32 v[42:43], v[42:43], v[8:9]
    v_cvt_pk_bf16_f32 v40, v40, v41
    v_cvt_pk_bf16_f32 v41, v42, v43
    buffer_store_dwordx2 v[40:41], v3, s[16:19], s45 offen offset:256
    v_pk_mul_f32 v[6:7], v[56:57], v[56:57]
    v_pk_mul_f32 v[8:9], v[58:59], v[58:59]
    v_pk_fma_f32 v[6:7], v[6:7], s[50:51], v[4:5]
    v_pk_fma_f32 v[8:9], v[8:9], s[50:51], v[4:5]
    v_pk_mul_f32 v[6:7], v[6:7], v[56:57]
    v_pk_mul_f32 v[8:9], v[8:9], v[58:59]
    v_exp_f32 v6, v6
    v_exp_f32 v7, v7
    v_exp_f32 v8, v8
    v_exp_f32 v9, v9
    v_pk_mul_f32 v[56:57], v[56:57], v[104:105]
    v_pk_mul_f32 v[58:59], v[58:59], v[106:107]
    v_add_f32 v6, 1.0, v6
    v_add_f32 v7, 1.0, v7
    v_add_f32 v8, 1.0, v8
    v_add_f32 v9, 1.0, v9
    v_rcp_f32 v6, v6
    v_rcp_f32 v7, v7
    v_rcp_f32 v8, v8
    v_rcp_f32 v9, v9
    s_nop 0
    v_pk_mul_f32 v[56:57], v[56:57], v[6:7]
    v_pk_mul_f32 v[58:59], v[58:59], v[8:9]
    v_cvt_pk_bf16_f32 v56, v56, v57
    v_cvt_pk_bf16_f32 v57, v58, v59
    buffer_store_dwordx2 v[56:57], v3, s[16:19], s45 offen offset:320
    v_pk_mul_f32 v[6:7], v[72:73], v[72:73]
    v_pk_mul_f32 v[8:9], v[74:75], v[74:75]
    v_pk_fma_f32 v[6:7], v[6:7], s[50:51], v[4:5]
    v_pk_fma_f32 v[8:9], v[8:9], s[50:51], v[4:5]
    v_pk_mul_f32 v[6:7], v[6:7], v[72:73]
    v_pk_mul_f32 v[8:9], v[8:9], v[74:75]
    v_exp_f32 v6, v6
    v_exp_f32 v7, v7
    v_exp_f32 v8, v8
    v_exp_f32 v9, v9
    v_pk_mul_f32 v[72:73], v[72:73], v[120:121]
    v_pk_mul_f32 v[74:75], v[74:75], v[122:123]
    v_add_f32 v6, 1.0, v6
    v_add_f32 v7, 1.0, v7
    v_add_f32 v8, 1.0, v8
    v_add_f32 v9, 1.0, v9
    v_rcp_f32 v6, v6
    v_rcp_f32 v7, v7
    v_rcp_f32 v8, v8
    v_rcp_f32 v9, v9
    s_nop 0
    v_pk_mul_f32 v[72:73], v[72:73], v[6:7]
    v_pk_mul_f32 v[74:75], v[74:75], v[8:9]
    v_cvt_pk_bf16_f32 v72, v72, v73
    v_cvt_pk_bf16_f32 v73, v74, v75
    buffer_store_dwordx2 v[72:73], v10, s[16:19], s45 offen offset:0
L_end_12:
    s_endpgm
.globl gemm4_kernel
.p2align 8
.type gemm4_kernel,@function
gemm4_kernel:
    s_cmp_ge_u32 s2, 256
    s_cbranch_scc1 L_end_18
    s_load_dwordx2 s[4:5], s[0:1], 72
    s_load_dwordx2 s[6:7], s[0:1], 48
    s_load_dwordx2 s[62:63], s[0:1], 56
    v_lshrrev_b32 v1, 6, v0
    v_and_b32 v0, 63, v0
    s_nop 0
    v_readfirstlane_b32 s28, v1
    v_and_b32 v1, 15, v0
    v_lshrrev_b32 v2, 4, v0
    s_and_b32 s42, s2, 7
    s_lshr_b32 s43, s2, 3
    s_and_b32 s29, s42, 3
    s_lshl_b32 s29, s29, 3
    s_and_b32 s44, s43, 7
    s_add_u32 s29, s29, s44
    s_lshr_b32 s30, s42, 2
    s_lshl_b32 s30, s30, 2
    s_lshr_b32 s44, s43, 3
    s_add_u32 s30, s30, s44
    s_and_b32 s38, s28, 1
    s_bfe_u32 s39, s28, 0x10001
    s_lshr_b32 s40, s28, 2
    v_lshrrev_b32 v14, 3, v0
    v_and_b32 v15, 7, v0
    v_xor_b32 v15, v15, v14
    s_mov_b32 s42, 0
    s_mul_i32 s43, s38, 8
    s_add_u32 s42, s42, s43
    s_mul_i32 s43, s39, 16
    s_add_u32 s42, s42, s43
    s_mul_i32 s43, s40, 32
    s_add_u32 s42, s42, s43
    s_mul_i32 s43, s29, 64
    s_add_u32 s42, s42, s43
    v_add_u32 v14, s42, v14
    s_mov_b32 s43, 7168
    v_mul_lo_u32 v14, v14, s43
    v_lshl_add_u32 v3, v15, 4, v14
    s_mov_b32 s36, 0
    s_mul_i32 s42, s38, 1024
    s_add_u32 s36, s36, s42
    s_mul_i32 s42, s39, 2048
    s_add_u32 s36, s36, s42
    s_mul_i32 s42, s40, 4096
    s_add_u32 s36, s36, s42
    s_mul_i32 s44, s30, 256
    s_mov_b32 s45, 2048
    v_lshrrev_b32 v14, 3, v0
    v_bfe_u32 v16, v0, 4, 1
    v_lshlrev_b32 v16, 1, v16
    v_and_b32 v15, 7, v0
    v_xor_b32 v15, v15, v16
    v_mul_lo_u32 v14, v14, s45
    s_mov_b32 s42, 0
    s_mul_i32 s43, s38, 16384
    s_add_u32 s42, s42, s43
    s_mul_i32 s43, s39, 32768
    s_add_u32 s42, s42, s43
    s_mul_i32 s43, s40, 65536
    s_add_u32 s42, s42, s43
    s_add_u32 s42, s42, s44
    v_add_u32 v14, s42, v14
    s_lshl_b32 s43, s38, 2
    s_xor_b32 s43, s43, 0
    v_xor_b32 v16, s43, v15
    v_lshl_add_u32 v16, v16, 4, v14
    v_add_u32 v4, 0x0, v16
    s_lshl_b32 s43, s38, 2
    s_xor_b32 s43, s43, 0
    v_xor_b32 v16, s43, v15
    v_lshl_add_u32 v16, v16, 4, v14
    v_add_u32 v5, 0x80, v16
    s_mov_b32 s37, 49152
    s_mul_i32 s42, s38, 2048
    s_add_u32 s37, s37, s42
    s_mul_i32 s42, s39, 4096
    s_add_u32 s37, s37, s42
    s_mul_i32 s42, s40, 8192
    s_add_u32 s37, s37, s42
    s_waitcnt lgkmcnt(0)
    s_add_u32 s8, s4, 0x1500000
    s_addc_u32 s9, s5, 0
    s_mov_b32 s10, 0xe00000
    s_mov_b32 s11, 0x00020000
    s_mov_b32 s12, s6
    s_mov_b32 s13, s7
    s_mov_b32 s14, 0x700000
    s_mov_b32 s15, 0x00020000
    s_mov_b32 s32, 0
    s_mov_b32 s33, 0
    s_mov_b32 s35, 0
    s_mov_b32 s96, 0
    s_add_u32 s42, s35, s36
    s_add_u32 m0, s42, 0
    s_nop 0
    buffer_load_dwordx4 v3, s[8:11], s32 offen lds
    s_add_u32 s32, s32, 128
    s_add_u32 s35, s35, 8192
    s_add_u32 s42, s96, s37
    s_add_u32 m0, s42, 0
    s_nop 0
    buffer_load_dwordx4 v4, s[12:15], s33 offen lds
    s_add_u32 s42, s96, s37
    s_add_u32 m0, s42, 1024
    s_nop 0
    buffer_load_dwordx4 v5, s[12:15], s33 offen lds
    s_add_u32 s33, s33, 131072
    s_add_u32 s96, s96, 16384
    s_add_u32 s42, s35, s36
    s_add_u32 m0, s42, 0
    s_nop 0
    buffer_load_dwordx4 v3, s[8:11], s32 offen lds
    s_add_u32 s32, s32, 128
    s_add_u32 s35, s35, 8192
    s_add_u32 s42, s96, s37
    s_add_u32 m0, s42, 0
    s_nop 0
    buffer_load_dwordx4 v4, s[12:15], s33 offen lds
    s_add_u32 s42, s96, s37
    s_add_u32 m0, s42, 1024
    s_nop 0
    buffer_load_dwordx4 v5, s[12:15], s33 offen lds
    s_add_u32 s33, s33, 131072
    s_add_u32 s96, s96, 16384
    s_add_u32 s42, s35, s36
    s_add_u32 m0, s42, 0
    s_nop 0
    buffer_load_dwordx4 v3, s[8:11], s32 offen lds
    s_add_u32 s32, s32, 128
    s_add_u32 s35, s35, 8192
    s_add_u32 s42, s96, s37
    s_add_u32 m0, s42, 0
    s_nop 0
    buffer_load_dwordx4 v4, s[12:15], s33 offen lds
    s_add_u32 s42, s96, s37
    s_add_u32 m0, s42, 1024
    s_nop 0
    buffer_load_dwordx4 v5, s[12:15], s33 offen lds
    s_add_u32 s33, s33, 131072
    s_add_u32 s96, s96, 16384
    s_add_u32 s42, s35, s36
    s_add_u32 m0, s42, 0
    s_nop 0
    buffer_load_dwordx4 v3, s[8:11], s32 offen lds
    s_add_u32 s32, s32, 128
    s_add_u32 s35, s35, 8192
    s_add_u32 s42, s96, s37
    s_add_u32 m0, s42, 0
    s_nop 0
    buffer_load_dwordx4 v4, s[12:15], s33 offen lds
    s_add_u32 s42, s96, s37
    s_add_u32 m0, s42, 1024
    s_nop 0
    buffer_load_dwordx4 v5, s[12:15], s33 offen lds
    s_add_u32 s33, s33, 131072
    s_add_u32 s96, s96, 16384
    s_add_u32 s42, s35, s36
    s_add_u32 m0, s42, 0
    s_nop 0
    buffer_load_dwordx4 v3, s[8:11], s32 offen lds
    s_add_u32 s32, s32, 128
    s_add_u32 s35, s35, 8192
    s_add_u32 s42, s96, s37
    s_add_u32 m0, s42, 0
    s_nop 0
    buffer_load_dwordx4 v4, s[12:15], s33 offen lds
    s_add_u32 s42, s96, s37
    s_add_u32 m0, s42, 1024
    s_nop 0
    buffer_load_dwordx4 v5, s[12:15], s33 offen lds
    s_add_u32 s33, s33, 131072
    s_add_u32 s96, s96, 16384
    s_mov_b32 s16, s62
    s_mov_b32 s17, s63
    s_mov_b32 s18, 0x400000
    s_mov_b32 s19, 0x00020000
    s_add_u32 s20, s4, 0xd00000
    s_addc_u32 s21, s5, 0
    s_mov_b32 s22, 0x400000
    s_mov_b32 s23, 0x00020000
    v_and_b32 v14, 7, v0
    v_xor_b32 v14, v14, v2
    v_lshlrev_b32 v14, 4, v14
    v_lshl_add_u32 v14, v1, 7, v14
    s_mov_b32 s42, 0
    s_mul_i32 s43, s38, 4096
    s_add_u32 s42, s42, s43
    v_add_u32 v6, s42, v14
    v_xor_b32 v7, 64, v6
    s_mov_b32 s42, 2048
    v_mul_lo_u32 v14, v2, s42
    v_lshrrev_b32 v16, 2, v1
    v_lshl_add_u32 v14, v16, 7, v14
    v_bfe_u32 v15, v0, 3, 2
    s_mov_b32 s42, 0
    s_mul_i32 s43, s39, 1
    s_add_u32 s42, s42, s43
    v_xor_b32 v15, s42, v15
    v_lshl_add_u32 v14, v15, 5, v14
    v_bfe_u32 v16, v0, 1, 1
    v_lshl_add_u32 v14, v16, 4, v14
    v_and_b32 v16, 1, v0
    v_lshl_add_u32 v14, v16, 3, v14
    s_mov_b32 s42, 49152
    s_mul_i32 s43, s40, 1024
    s_add_u32 s42, s42, s43
    v_add_u32 v8, s42, v14
    v_xor_b32 v9, 64, v8
    s_mov_b32 s34, 0
    s_mov_b32 s41, 0
    v_add_u32 v10, s34, v6
    v_add_u32 v11, s34, v7
    v_add_u32 v12, s41, v8
    v_add_u32 v13, s41, v9
    s_waitcnt vmcnt(12) lgkmcnt(0)
    s_barrier
    ds_read_b128 a[0:3], v10 offset:0
    ds_read_b128 a[4:7], v10 offset:2048
    ds_read_b64_tr_b16 a[8:9], v12 offset:0
    ds_read_b64_tr_b16 a[10:11], v12 offset:512
    ds_read_b64_tr_b16 a[12:13], v13 offset:0
    ds_read_b64_tr_b16 a[14:15], v13 offset:512
    s_add_u32 s42, s35, s36
    s_add_u32 m0, s42, 0
    s_nop 0
    buffer_load_dwordx4 v3, s[8:11], s32 offen lds
    s_add_u32 s32, s32, 128
    s_add_u32 s42, s96, s37
    s_add_u32 m0, s42, 0
    s_nop 0
    buffer_load_dwordx4 v4, s[12:15], s33 offen lds
    s_add_u32 s42, s96, s37
    s_add_u32 m0, s42, 1024
    s_nop 0
    buffer_load_dwordx4 v5, s[12:15], s33 offen lds
    s_add_u32 s33, s33, 131072
    s_waitcnt lgkmcnt(0)
    v_mfma_f32_16x16x32_bf16 v[28:31], a[8:11], a[0:3], 0
    ds_read_b128 a[16:19], v11 offset:0
    ds_read_b128 a[20:23], v11 offset:2048
    v_mfma_f32_16x16x32_bf16 v[32:35], a[8:11], a[4:7], 0
    ds_read_b64_tr_b16 a[24:25], v12 offset:8192
    ds_read_b64_tr_b16 a[26:27], v12 offset:8704
    v_mfma_f32_16x16x32_bf16 v[36:39], a[12:15], a[0:3], 0
    ds_read_b64_tr_b16 a[28:29], v13 offset:8192
    ds_read_b64_tr_b16 a[30:31], v13 offset:8704
    v_mfma_f32_16x16x32_bf16 v[40:43], a[12:15], a[4:7], 0
    s_waitcnt lgkmcnt(0)
    s_mov_b32 s35, s34
    s_add_u32 s34, s34, 8192
    s_cmp_eq_u32 s34, 49152
    s_cselect_b32 s34, 0, s34
    v_add_u32 v10, s34, v6
    v_add_u32 v11, s34, v7
    s_mov_b32 s96, s41
    s_add_u32 s41, s41, 16384
    s_cmp_eq_u32 s41, 98304
    s_cselect_b32 s41, 0, s41
    v_add_u32 v12, s41, v8
    v_add_u32 v13, s41, v9
    s_waitcnt vmcnt(12)
    s_barrier
    v_mfma_f32_16x16x32_bf16 v[28:31], a[24:27], a[16:19], v[28:31]
    ds_read_b128 a[0:3], v10 offset:0
    ds_read_b128 a[4:7], v10 offset:2048
    ds_read_b64_tr_b16 a[8:9], v12 offset:0
    ds_read_b64_tr_b16 a[10:11], v12 offset:512
    v_mfma_f32_16x16x32_bf16 v[32:35], a[24:27], a[20:23], v[32:35]
    ds_read_b64_tr_b16 a[12:13], v13 offset:0
    ds_read_b64_tr_b16 a[14:15], v13 offset:512
    s_add_u32 s42, s96, s37
    s_add_u32 m0, s42, 0
    s_nop 0
    buffer_load_dwordx4 v4, s[12:15], s33 offen lds
    s_add_u32 s42, s96, s37
    s_add_u32 m0, s42, 1024
    s_nop 0
    buffer_load_dwordx4 v5, s[12:15], s33 offen lds
    v_mfma_f32_16x16x32_bf16 v[36:39], a[28:31], a[16:19], v[36:39]
    s_add_u32 s33, s33, 131072
    s_add_u32 s42, s35, s36
    s_add_u32 m0, s42, 0
    s_nop 0
    buffer_load_dwordx4 v3, s[8:11], s32 offen lds
    s_add_u32 s32, s32, 128
    v_mfma_f32_16x16x32_bf16 v[40:43], a[28:31], a[20:23], v[40:43]
    s_waitcnt lgkmcnt(0)
    s_mov_b32 s31, 49
L_loop_19:
    v_mfma_f32_16x16x32_bf16 v[28:31], a[8:11], a[0:3], v[28:31]
    ds_read_b128 a[16:19], v11 offset:0
    ds_read_b128 a[20:23], v11 offset:2048
    v_mfma_f32_16x16x32_bf16 v[32:35], a[8:11], a[4:7], v[32:35]
    ds_read_b64_tr_b16 a[24:25], v12 offset:8192
    ds_read_b64_tr_b16 a[26:27], v12 offset:8704
    v_mfma_f32_16x16x32_bf16 v[36:39], a[12:15], a[0:3], v[36:39]
    ds_read_b64_tr_b16 a[28:29], v13 offset:8192
    ds_read_b64_tr_b16 a[30:31], v13 offset:8704
    v_mfma_f32_16x16x32_bf16 v[40:43], a[12:15], a[4:7], v[40:43]
    s_waitcnt lgkmcnt(0)
    s_mov_b32 s35, s34
    s_add_u32 s34, s34, 8192
    s_cmp_eq_u32 s34, 49152
    s_cselect_b32 s34, 0, s34
    v_add_u32 v10, s34, v6
    v_add_u32 v11, s34, v7
    s_mov_b32 s96, s41
    s_add_u32 s41, s41, 16384
    s_cmp_eq_u32 s41, 98304
    s_cselect_b32 s41, 0, s41
    v_add_u32 v12, s41, v8
    v_add_u32 v13, s41, v9
    s_waitcnt vmcnt(12)
    s_barrier
    v_mfma_f32_16x16x32_bf16 v[28:31], a[24:27], a[16:19], v[28:31]
    ds_read_b128 a[0:3], v10 offset:0
    ds_read_b128 a[4:7], v10 offset:2048
    ds_read_b64_tr_b16 a[8:9], v12 offset:0
    ds_read_b64_tr_b16 a[10:11], v12 offset:512
    v_mfma_f32_16x16x32_bf16 v[32:35], a[24:27], a[20:23], v[32:35]
    ds_read_b64_tr_b16 a[12:13], v13 offset:0
    ds_read_b64_tr_b16 a[14:15], v13 offset:512
    s_add_u32 s42, s96, s37
    s_add_u32 m0, s42, 0
    s_nop 0
    buffer_load_dwordx4 v4, s[12:15], s33 offen lds
    s_add_u32 s42, s96, s37
    s_add_u32 m0, s42, 1024
    s_nop 0
    buffer_load_dwordx4 v5, s[12:15], s33 offen lds
    v_mfma_f32_16x16x32_bf16 v[36:39], a[28:31], a[16:19], v[36:39]
    s_add_u32 s33, s33, 131072
    s_add_u32 s42, s35, s36
    s_add_u32 m0, s42, 0
    s_nop 0
    buffer_load_dwordx4 v3, s[8:11], s32 offen lds
    s_add_u32 s32, s32, 128
    v_mfma_f32_16x16x32_bf16 v[40:43], a[28:31], a[20:23], v[40:43]
    s_waitcnt lgkmcnt(0)
    s_sub_u32 s31, s31, 1
    s_cmp_lg_u32 s31, 0
    s_cbranch_scc1 L_loop_19
    v_mfma_f32_16x16x32_bf16 v[28:31], a[8:11], a[0:3], v[28:31]
    ds_read_b128 a[16:19], v11 offset:0
    ds_read_b128 a[20:23], v11 offset:2048
    v_mfma_f32_16x16x32_bf16 v[32:35], a[8:11], a[4:7], v[32:35]
    ds_read_b64_tr_b16 a[24:25], v12 offset:8192
    ds_read_b64_tr_b16 a[26:27], v12 offset:8704
    v_mfma_f32_16x16x32_bf16 v[36:39], a[12:15], a[0:3], v[36:39]
    ds_read_b64_tr_b16 a[28:29], v13 offset:8192
    ds_read_b64_tr_b16 a[30:31], v13 offset:8704
    v_mfma_f32_16x16x32_bf16 v[40:43], a[12:15], a[4:7], v[40:43]
    s_waitcnt lgkmcnt(0)
    s_mov_b32 s35, s34
    s_add_u32 s34, s34, 8192
    s_cmp_eq_u32 s34, 49152
    s_cselect_b32 s34, 0, s34
    v_add_u32 v10, s34, v6
    v_add_u32 v11, s34, v7
    s_mov_b32 s96, s41
    s_add_u32 s41, s41, 16384
    s_cmp_eq_u32 s41, 98304
    s_cselect_b32 s41, 0, s41
    v_add_u32 v12, s41, v8
    v_add_u32 v13, s41, v9
    s_waitcnt vmcnt(12)
    s_barrier
    v_mfma_f32_16x16x32_bf16 v[28:31], a[24:27], a[16:19], v[28:31]
    ds_read_b128 a[0:3], v10 offset:0
    ds_read_b128 a[4:7], v10 offset:2048
    v_mfma_f32_16x16x32_bf16 v[32:35], a[24:27], a[20:23], v[32:35]
    ds_read_b64_tr_b16 a[8:9], v12 offset:0
    ds_read_b64_tr_b16 a[10:11], v12 offset:512
    v_mfma_f32_16x16x32_bf16 v[36:39], a[28:31], a[16:19], v[36:39]
    ds_read_b64_tr_b16 a[12:13], v13 offset:0
    ds_read_b64_tr_b16 a[14:15], v13 offset:512
    v_mfma_f32_16x16x32_bf16 v[40:43], a[28:31], a[20:23], v[40:43]
    s_waitcnt lgkmcnt(0)
    v_mfma_f32_16x16x32_bf16 v[28:31], a[8:11], a[0:3], v[28:31]
    ds_read_b128 a[16:19], v11 offset:0
    ds_read_b128 a[20:23], v11 offset:2048
    v_mfma_f32_16x16x32_bf16 v[32:35], a[8:11], a[4:7], v[32:35]
    ds_read_b64_tr_b16 a[24:25], v12 offset:8192
    ds_read_b64_tr_b16 a[26:27], v12 offset:8704
    v_mfma_f32_16x16x32_bf16 v[36:39], a[12:15], a[0:3], v[36:39]
    ds_read_b64_tr_b16 a[28:29], v13 offset:8192
    ds_read_b64_tr_b16 a[30:31], v13 offset:8704
    v_mfma_f32_16x16x32_bf16 v[40:43], a[12:15], a[4:7], v[40:43]
    s_waitcnt lgkmcnt(0)
    s_mov_b32 s35, s34
    s_add_u32 s34, s34, 8192
    s_cmp_eq_u32 s34, 49152
    s_cselect_b32 s34, 0, s34
    v_add_u32 v10, s34, v6
    v_add_u32 v11, s34, v7
    s_mov_b32 s96, s41
    s_add_u32 s41, s41, 16384
    s_cmp_eq_u32 s41, 98304
    s_cselect_b32 s41, 0, s41
    v_add_u32 v12, s41, v8
    v_add_u32 v13, s41, v9
    s_waitcnt vmcnt(9)
    s_barrier
    v_mfma_f32_16x16x32_bf16 v[28:31], a[24:27], a[16:19], v[28:31]
    ds_read_b128 a[0:3], v10 offset:0
    ds_read_b128 a[4:7], v10 offset:2048
    v_mfma_f32_16x16x32_bf16 v[32:35], a[24:27], a[20:23], v[32:35]
    ds_read_b64_tr_b16 a[8:9], v12 offset:0
    ds_read_b64_tr_b16 a[10:11], v12 offset:512
    v_mfma_f32_16x16x32_bf16 v[36:39], a[28:31], a[16:19], v[36:39]
    ds_read_b64_tr_b16 a[12:13], v13 offset:0
    ds_read_b64_tr_b16 a[14:15], v13 offset:512
    v_mfma_f32_16x16x32_bf16 v[40:43], a[28:31], a[20:23], v[40:43]
    s_waitcnt lgkmcnt(0)
    v_mfma_f32_16x16x32_bf16 v[28:31], a[8:11], a[0:3], v[28:31]
    ds_read_b128 a[16:19], v11 offset:0
    ds_read_b128 a[20:23], v11 offset:2048
    v_mfma_f32_16x16x32_bf16 v[32:35], a[8:11], a[4:7], v[32:35]
    ds_read_b64_tr_b16 a[24:25], v12 offset:8192
    ds_read_b64_tr_b16 a[26:27], v12 offset:8704
    v_mfma_f32_16x16x32_bf16 v[36:39], a[12:15], a[0:3], v[36:39]
    ds_read_b64_tr_b16 a[28:29], v13 offset:8192
    ds_read_b64_tr_b16 a[30:31], v13 offset:8704
    v_mfma_f32_16x16x32_bf16 v[40:43], a[12:15], a[4:7], v[40:43]
    s_waitcnt lgkmcnt(0)
    s_mov_b32 s35, s34
    s_add_u32 s34, s34, 8192
    s_cmp_eq_u32 s34, 49152
    s_cselect_b32 s34, 0, s34
    v_add_u32 v10, s34, v6
    v_add_u32 v11, s34, v7
    s_mov_b32 s96, s41
    s_add_u32 s41, s41, 16384
    s_cmp_eq_u32 s41, 98304
    s_cselect_b32 s41, 0, s41
    v_add_u32 v12, s41, v8
    v_add_u32 v13, s41, v9
    s_waitcnt vmcnt(6)
    s_barrier
    v_mfma_f32_16x16x32_bf16 v[28:31], a[24:27], a[16:19], v[28:31]
    ds_read_b128 a[0:3], v10 offset:0
    ds_read_b128 a[4:7], v10 offset:2048
    v_mfma_f32_16x16x32_bf16 v[32:35], a[24:27], a[20:23], v[32:35]
    ds_read_b64_tr_b16 a[8:9], v12 offset:0
    ds_read_b64_tr_b16 a[10:11], v12 offset:512
    v_mfma_f32_16x16x32_bf16 v[36:39], a[28:31], a[16:19], v[36:39]
    ds_read_b64_tr_b16 a[12:13], v13 offset:0
    ds_read_b64_tr_b16 a[14:15], v13 offset:512
    v_mfma_f32_16x16x32_bf16 v[40:43], a[28:31], a[20:23], v[40:43]
    s_waitcnt lgkmcnt(0)
    v_mfma_f32_16x16x32_bf16 v[28:31], a[8:11], a[0:3], v[28:31]
    ds_read_b128 a[16:19], v11 offset:0
    ds_read_b128 a[20:23], v11 offset:2048
    v_mfma_f32_16x16x32_bf16 v[32:35], a[8:11], a[4:7], v[32:35]
    ds_read_b64_tr_b16 a[24:25], v12 offset:8192
    ds_read_b64_tr_b16 a[26:27], v12 offset:8704
    v_mfma_f32_16x16x32_bf16 v[36:39], a[12:15], a[0:3], v[36:39]
    ds_read_b64_tr_b16 a[28:29], v13 offset:8192
    ds_read_b64_tr_b16 a[30:31], v13 offset:8704
    v_mfma_f32_16x16x32_bf16 v[40:43], a[12:15], a[4:7], v[40:43]
    s_waitcnt lgkmcnt(0)
    s_mov_b32 s35, s34
    s_add_u32 s34, s34, 8192
    s_cmp_eq_u32 s34, 49152
    s_cselect_b32 s34, 0, s34
    v_add_u32 v10, s34, v6
    v_add_u32 v11, s34, v7
    s_mov_b32 s96, s41
    s_add_u32 s41, s41, 16384
    s_cmp_eq_u32 s41, 98304
    s_cselect_b32 s41, 0, s41
    v_add_u32 v12, s41, v8
    v_add_u32 v13, s41, v9
    s_waitcnt vmcnt(3)
    s_barrier
    v_mfma_f32_16x16x32_bf16 v[28:31], a[24:27], a[16:19], v[28:31]
    ds_read_b128 a[0:3], v10 offset:0
    ds_read_b128 a[4:7], v10 offset:2048
    v_mfma_f32_16x16x32_bf16 v[32:35], a[24:27], a[20:23], v[32:35]
    ds_read_b64_tr_b16 a[8:9], v12 offset:0
    ds_read_b64_tr_b16 a[10:11], v12 offset:512
    v_mfma_f32_16x16x32_bf16 v[36:39], a[28:31], a[16:19], v[36:39]
    ds_read_b64_tr_b16 a[12:13], v13 offset:0
    ds_read_b64_tr_b16 a[14:15], v13 offset:512
    v_mfma_f32_16x16x32_bf16 v[40:43], a[28:31], a[20:23], v[40:43]
    s_waitcnt lgkmcnt(0)
    v_mfma_f32_16x16x32_bf16 v[28:31], a[8:11], a[0:3], v[28:31]
    ds_read_b128 a[16:19], v11 offset:0
    ds_read_b128 a[20:23], v11 offset:2048
    v_mfma_f32_16x16x32_bf16 v[32:35], a[8:11], a[4:7], v[32:35]
    ds_read_b64_tr_b16 a[24:25], v12 offset:8192
    ds_read_b64_tr_b16 a[26:27], v12 offset:8704
    v_mfma_f32_16x16x32_bf16 v[36:39], a[12:15], a[0:3], v[36:39]
    ds_read_b64_tr_b16 a[28:29], v13 offset:8192
    ds_read_b64_tr_b16 a[30:31], v13 offset:8704
    v_mfma_f32_16x16x32_bf16 v[40:43], a[12:15], a[4:7], v[40:43]
    s_waitcnt lgkmcnt(0)
    s_mov_b32 s35, s34
    s_add_u32 s34, s34, 8192
    s_cmp_eq_u32 s34, 49152
    s_cselect_b32 s34, 0, s34
    v_add_u32 v10, s34, v6
    v_add_u32 v11, s34, v7
    s_mov_b32 s96, s41
    s_add_u32 s41, s41, 16384
    s_cmp_eq_u32 s41, 98304
    s_cselect_b32 s41, 0, s41
    v_add_u32 v12, s41, v8
    v_add_u32 v13, s41, v9
    s_waitcnt vmcnt(0)
    s_barrier
    v_mfma_f32_16x16x32_bf16 v[28:31], a[24:27], a[16:19], v[28:31]
    ds_read_b128 a[0:3], v10 offset:0
    ds_read_b128 a[4:7], v10 offset:2048
    ds_read_b64_tr_b16 a[8:9], v12 offset:0
    v_mfma_f32_16x16x32_bf16 v[32:35], a[24:27], a[20:23], v[32:35]
    ds_read_b64_tr_b16 a[10:11], v12 offset:512
    ds_read_b64_tr_b16 a[12:13], v13 offset:0
    v_mfma_f32_16x16x32_bf16 v[36:39], a[28:31], a[16:19], v[36:39]
    ds_read_b64_tr_b16 a[14:15], v13 offset:512
    s_lshl_b32 s50, s29, 6
    s_lshl_b32 s51, s38, 5
    s_add_u32 s50, s50, s51
    s_lshl_b32 s50, s50, 11
    s_lshl_b32 s51, s30, 8
    s_add_u32 s50, s50, s51
    s_lshl_b32 s51, s39, 5
    s_add_u32 s50, s50, s51
    s_lshl_b32 s51, s40, 7
    s_add_u32 s50, s50, s51
    s_add_u32 s51, s50, 32768
    v_lshlrev_b32 v44, 11, v1
    v_lshl_add_u32 v44, v2, 3, v44
    buffer_load_dwordx2 v[46:47], v44, s[20:23], s50 offen offset:0
    buffer_load_dwordx2 v[48:49], v44, s[20:23], s50 offen offset:64
    buffer_load_dwordx2 v[50:51], v44, s[20:23], s51 offen offset:0
    buffer_load_dwordx2 v[52:53], v44, s[20:23], s51 offen offset:64
    v_mfma_f32_16x16x32_bf16 v[40:43], a[28:31], a[20:23], v[40:43]
    s_waitcnt lgkmcnt(0)
    v_mfma_f32_16x16x32_bf16 v[28:31], a[8:11], a[0:3], v[28:31]
    ds_read_b128 a[16:19], v11 offset:0
    ds_read_b128 a[20:23], v11 offset:2048
    v_mfma_f32_16x16x32_bf16 v[32:35], a[8:11], a[4:7], v[32:35]
    ds_read_b64_tr_b16 a[24:25], v12 offset:8192
    ds_read_b64_tr_b16 a[26:27], v12 offset:8704
    v_mfma_f32_16x16x32_bf16 v[36:39], a[12:15], a[0:3], v[36:39]
    ds_read_b64_tr_b16 a[28:29], v13 offset:8192
    ds_read_b64_tr_b16 a[30:31], v13 offset:8704
    v_mfma_f32_16x16x32_bf16 v[40:43], a[12:15], a[4:7], v[40:43]
    s_waitcnt lgkmcnt(0)
    v_mfma_f32_16x16x32_bf16 v[28:31], a[24:27], a[16:19], v[28:31]
    v_mfma_f32_16x16x32_bf16 v[32:35], a[24:27], a[20:23], v[32:35]
    v_mfma_f32_16x16x32_bf16 v[36:39], a[28:31], a[16:19], v[36:39]
    v_mfma_f32_16x16x32_bf16 v[40:43], a[28:31], a[20:23], v[40:43]
    s_nop 7
    v_cvt_pk_bf16_f32 v4, v28, v29
    v_cvt_pk_bf16_f32 v5, v30, v31
    v_lshlrev_b32 v28, 16, v4
    v_and_b32 v29, 0xffff0000, v4
    v_lshlrev_b32 v30, 16, v5
    v_and_b32 v31, 0xffff0000, v5
    v_cvt_pk_bf16_f32 v4, v36, v37
    v_cvt_pk_bf16_f32 v5, v38, v39
    v_lshlrev_b32 v36, 16, v4
    v_and_b32 v37, 0xffff0000, v4
    v_lshlrev_b32 v38, 16, v5
    v_and_b32 v39, 0xffff0000, v5
    v_cvt_pk_bf16_f32 v4, v32, v33
    v_cvt_pk_bf16_f32 v5, v34, v35
    v_lshlrev_b32 v32, 16, v4
    v_and_b32 v33, 0xffff0000, v4
    v_lshlrev_b32 v34, 16, v5
    v_and_b32 v35, 0xffff0000, v5
    v_cvt_pk_bf16_f32 v4, v40, v41
    v_cvt_pk_bf16_f32 v5, v42, v43
    v_lshlrev_b32 v40, 16, v4
    v_and_b32 v41, 0xffff0000, v4
    v_lshlrev_b32 v42, 16, v5
    v_and_b32 v43, 0xffff0000, v5
    s_waitcnt vmcnt(0)
    v_lshlrev_b32 v4, 16, v46
    v_and_b32 v5, 0xffff0000, v46
    v_add_f32 v28, v28, v4
    v_add_f32 v29, v29, v5
    v_lshlrev_b32 v4, 16, v47
    v_and_b32 v5, 0xffff0000, v47
    v_add_f32 v30, v30, v4
    v_add_f32 v31, v31, v5
    v_cvt_pk_bf16_f32 v46, v28, v29
    v_cvt_pk_bf16_f32 v47, v30, v31
    buffer_store_dwordx2 v[46:47], v44, s[16:19], s50 offen offset:0
    v_lshlrev_b32 v4, 16, v48
    v_and_b32 v5, 0xffff0000, v48
    v_add_f32 v36, v36, v4
    v_add_f32 v37, v37, v5
    v_lshlrev_b32 v4, 16, v49
    v_and_b32 v5, 0xffff0000, v49
    v_add_f32 v38, v38, v4
    v_add_f32 v39, v39, v5
    v_cvt_pk_bf16_f32 v48, v36, v37
    v_cvt_pk_bf16_f32 v49, v38, v39
    buffer_store_dwordx2 v[48:49], v44, s[16:19], s50 offen offset:64
    v_lshlrev_b32 v4, 16, v50
    v_and_b32 v5, 0xffff0000, v50
    v_add_f32 v32, v32, v4
    v_add_f32 v33, v33, v5
    v_lshlrev_b32 v4, 16, v51
    v_and_b32 v5, 0xffff0000, v51
    v_add_f32 v34, v34, v4
    v_add_f32 v35, v35, v5
    v_cvt_pk_bf16_f32 v50, v32, v33
    v_cvt_pk_bf16_f32 v51, v34, v35
    buffer_store_dwordx2 v[50:51], v44, s[16:19], s51 offen offset:0
    v_lshlrev_b32 v4, 16, v52
    v_and_b32 v5, 0xffff0000, v52
    v_add_f32 v40, v40, v4
    v_add_f32 v41, v41, v5
    v_lshlrev_b32 v4, 16, v53
    v_and_b32 v5, 0xffff0000, v53
    v_add_f32 v42, v42, v4
    v_add_f32 v43, v43, v5
    v_cvt_pk_bf16_f32 v52, v40, v41
    v_cvt_pk_bf16_f32 v53, v42, v43
    buffer_store_dwordx2 v[52:53], v44, s[16:19], s51 offen offset:64
L_end_18:
    s_endpgm
.section .rodata,"a"
.p2align 6
.amdhsa_kernel ln1_kernel
  .amdhsa_next_free_vgpr 44
  .amdhsa_next_free_sgpr 102
  .amdhsa_accum_offset 44
  .amdhsa_group_segment_fixed_size 0
  .amdhsa_kernarg_size 80
  .amdhsa_user_sgpr_count 2
  .amdhsa_user_sgpr_kernarg_segment_ptr 1
  .amdhsa_system_sgpr_workgroup_id_x 1
.end_amdhsa_kernel
.p2align 6
.amdhsa_kernel gemm1_kernel
  .amdhsa_next_free_vgpr 160
  .amdhsa_next_free_sgpr 102
  .amdhsa_accum_offset 96
  .amdhsa_group_segment_fixed_size 0
  .amdhsa_kernarg_size 80
  .amdhsa_user_sgpr_count 2
  .amdhsa_user_sgpr_kernarg_segment_ptr 1
  .amdhsa_system_sgpr_workgroup_id_x 1
.end_amdhsa_kernel
.p2align 6
.amdhsa_kernel gemm2_kernel
  .amdhsa_next_free_vgpr 192
  .amdhsa_next_free_sgpr 102
  .amdhsa_accum_offset 160
  .amdhsa_group_segment_fixed_size 0
  .amdhsa_kernarg_size 80
  .amdhsa_user_sgpr_count 2
  .amdhsa_user_sgpr_kernarg_segment_ptr 1
  .amdhsa_system_sgpr_workgroup_id_x 1
.end_amdhsa_kernel
.p2align 6
.amdhsa_kernel gemm3_kernel
  .amdhsa_next_free_vgpr 252
  .amdhsa_next_free_sgpr 102
  .amdhsa_accum_offset 156
  .amdhsa_group_segment_fixed_size 0
  .amdhsa_kernarg_size 80
  .amdhsa_user_sgpr_count 2
  .amdhsa_user_sgpr_kernarg_segment_ptr 1
  .amdhsa_system_sgpr_workgroup_id_x 1
.end_amdhsa_kernel
.p2align 6
.amdhsa_kernel gemm4_kernel
  .amdhsa_next_free_vgpr 116
  .amdhsa_next_free_sgpr 102
  .amdhsa_accum_offset 84
  .amdhsa_group_segment_fixed_size 0
  .amdhsa_kernarg_size 80
  .amdhsa_user_sgpr_count 2
  .amdhsa_user_sgpr_kernarg_segment_ptr 1
  .amdhsa_system_sgpr_workgroup_id_x 1
.end_amdhsa_kernel
```
